```python
import torch

def _softmax(x, axis=-1):
    return torch.softmax(x, dim=axis)
def _gelu(x):
    return torch.nn.functional.gelu(x, approximate="tanh")
def _silu(x):
    return torch.nn.functional.silu(x)
def _sigmoid(x):
    return torch.sigmoid(x)
def _layernorm(x, axis=-1, eps=1e-5):
    m = x.mean(dim=axis, keepdim=True)
    v = x.var(dim=axis, keepdim=True, unbiased=False)
    return (x - m) / torch.sqrt(v + eps)
def _scatter_add(tgt, idx, src, axis=0):
    return tgt.clone().index_add_(axis, idx, src)
def _segment_sum(src, seg, n):
    out = torch.zeros((n,) + src.shape[1:], dtype=src.dtype)
    return out.index_add_(0, seg, src)
def _pad(x, pw):
    flat = tuple(v for pair in reversed(pw) for v in pair)
    return torch.nn.functional.pad(x, flat)

kernel_name = 'gated_mix__mha_block__ssm_conv_h3__prompt'

def setup_inputs():

    _w = (lambda a: (lambda t: t.to(torch.bfloat16) if t.is_floating_point() else t)(torch.as_tensor(a)))
    def _A_setup():
        B, S, D, H = 1, 2048, 640, 32
        return {
            "x": _w((lambda *s: torch.randn(*s, dtype=torch.bfloat16) * 0.05)(B, S, D)),
            "wqkv": _w((lambda *s: torch.randn(*s, dtype=torch.bfloat16) * 0.8)(D, 3 * D)),
            "wo": _w((lambda *s: torch.randn(*s, dtype=torch.bfloat16) * 0.05)(D, D)),
        }
    _A_in = _A_setup()

    def _B_setup():
        B, S, D = 1, 2048, 640
        ks = 4
        return {
            "q": _w((lambda *s: torch.randn(*s, dtype=torch.bfloat16) * 0.05)(B, S, D)),
            "k": _w((lambda *s: torch.randn(*s, dtype=torch.bfloat16) * 0.8)(B, S, D)),
            "v": _w((lambda *s: torch.randn(*s, dtype=torch.bfloat16) * 0.4)(B, S, D)),
            "shift_k": _w((lambda *s: torch.randn(*s, dtype=torch.bfloat16) * 0.8)(D, ks) * 0.5),
            "ssm_k": _w((lambda *s: torch.randn(*s, dtype=torch.bfloat16) * 0.8)(D, S) * (1.0 / S ** 0.5)),
            "ssm_D": _w((lambda *s: torch.randn(*s, dtype=torch.bfloat16) * 0.4)(D)),
        }
    _B_in = _B_setup()

    return {
        "A_x": _A_in["x"],
        "A_wqkv": _A_in["wqkv"],
        "A_wo": _A_in["wo"],
        "B_q": _B_in["q"],
        "B_k": _B_in["k"],
        "B_v": _B_in["v"],
        "B_shift_k": _B_in["shift_k"],
        "B_ssm_k": _B_in["ssm_k"],
        "B_ssm_D": _B_in["ssm_D"],
        "gate_w": _w((lambda *s: torch.randn(*s, dtype=torch.bfloat16) * 0.05)(640) * 16.0),
    }

def reference(A_x, A_wqkv, A_wo, B_q, B_k, B_v, B_shift_k, B_ssm_k, B_ssm_D, gate_w):
    def _A_ref(x, wqkv, wo):
        B, S, D = x.shape
        H = 32
        Dh = D // H
        qkv = (lambda x, *d: x.permute(*d))((x @ wqkv).reshape(B, S, 3, H, Dh), 2, 0, 3, 1, 4)
        q, k, v = qkv[0], qkv[1], qkv[2]
        scores = torch.einsum("bhqd,bhkd->bhqk", q, k) * (Dh ** -0.5)
        p = _softmax(scores, axis=-1)
        o = torch.einsum("bhqk,bhkd->bhqd", p, v)
        return (lambda x, *d: x.permute(*d))(o, 0, 2, 1, 3).reshape(B, S, D) @ wo

    def _B_ref(q, k, v, shift_k, ssm_k, ssm_D):
        B, S, D = q.shape
        ks = shift_k.shape[-1]
        k_pad = _pad(k, ((0, 0), (ks - 1, 0), (0, 0)))
        k_shift = torch.zeros_like(k)
        for t in range(ks):
            k_shift = k_shift + k_pad[:, t:t + S, :] * shift_k[:, ks - 1 - t][None, None, :]
        kv = k_shift * v
        L = 2 * S
        kv_pad = _pad(kv, ((0, 0), (0, S), (0, 0)))
        kf_pad = _pad(ssm_k, ((0, 0), (0, S)))
        kv_f = (lambda x, axes=(-2,-1): torch.fft.rfft2(x.float(), dim=axes))(kv_pad[:, None, :, :], axes=(1, 2))
        kf_f = (lambda x, axes=(-2,-1): torch.fft.rfft2(x.float(), dim=axes))(kf_pad[:, None, :], axes=(1, 2))
        kf_f = (lambda x, *d: x.permute(*d))(kf_f, 1, 2, 0)
        y_f = kv_f * kf_f[None, :, :, :]
        y = (lambda x, s, axes=(-2,-1): torch.fft.irfft2(x, s=s, dim=axes).to(torch.bfloat16))(y_f, (1, L), axes=(1, 2))[:, 0, :S, :]
        y = y + kv * ssm_D[None, None, :]
        return q * y

    x = A_x
    g = _sigmoid((x * gate_w).sum(-1, keepdims=True))
    a = _A_ref(x, A_wqkv, A_wo)
    b = _B_ref(x, B_k, B_v, B_shift_k, B_ssm_k, B_ssm_D)
    return g * a + (1 - g) * b
```

```asm
; @launch grid=(256,1,1) block=(512,1,1) lds=163840
.amdgcn_target "amdgcn-amd-amdhsa--gfx950"
.text
.globl gated_mix__mha_block__ssm_conv_h3__prompt_kernel
.p2align 8
.type gated_mix__mha_block__ssm_conv_h3__prompt_kernel,@function
gated_mix__mha_block__ssm_conv_h3__prompt_kernel:
    s_cmp_ge_u32 s2, 256
    s_cbranch_scc1 L_END
    s_load_dwordx4 s[4:7], s[0:1], 0
    s_load_dwordx16 s[12:27], s[0:1], 32
    s_load_dwordx2 s[10:11], s[0:1], 96
    s_load_dwordx2 s[8:9], s[0:1], 16
    v_lshrrev_b32 v1, 6, v0
    v_and_b32 v0, 63, v0
    s_and_b32 s48, s2, 7
    v_readfirstlane_b32 s3, v1
    s_lshr_b32 s49, s2, 3
    s_and_b32 s64, s48, 1
    s_mul_i32 s64, s64, 30
    s_add_u32 s64, s64, s49
    s_lshr_b32 s50, s64, 2
    s_and_b32 s64, s64, 3
    s_lshr_b32 s65, s48, 1
    s_lshl_b32 s65, s65, 2
    s_add_u32 s51, s64, s65
    s_sub_u32 s58, s3, 4
    s_mul_i32 s64, s48, 30
    s_add_u32 s100, s64, s49
    s_mul_i32 s95, s100, 171
    s_lshr_b32 s95, s95, 9
    s_mul_i32 s65, s95, 3
    s_sub_u32 s65, s100, s65
    s_lshl_b32 s66, s95, 3
    s_mul_i32 s67, s65, 3
    s_add_u32 s54, s66, s67
    s_lshr_b32 s65, s65, 1
    s_sub_u32 s55, 3, s65
    s_lshl_b32 s64, s48, 1
    s_add_u32 s64, s64, s49
    s_add_u32 s64, s64, 210
    s_cmp_ge_u32 s49, 30
    s_cselect_b32 s100, s64, s100
    s_cselect_b32 s55, 0, s55
    s_cselect_b32 s101, 8, 2
    s_cmp_lt_u32 s3, 4
    s_cbranch_scc1 L_COMPUTE
    s_cmp_gt_u32 s3, 4
    s_cbranch_scc1 L_SIDE
    v_lshrrev_b32 v16, 3, v0
    v_and_b32 v17, 7, v0
    v_lshrrev_b32 v18, 1, v16
    s_lshl_b32 s64, s51, 7
    v_add_u32 v16, s64, v16
    v_mul_u32_u24 v16, 1280, v16
    v_xor_b32 v19, 0, v18
    v_xor_b32 v19, v19, v17
    v_lshl_add_u32 v19, v19, 4, v16
    v_add_u32 v2, 0, v19
    v_xor_b32 v19, 4, v18
    v_xor_b32 v19, v19, v17
    v_lshl_add_u32 v19, v19, 4, v16
    v_add_u32 v3, 9216, v19
    v_xor_b32 v19, 0, v18
    v_xor_b32 v19, v19, v17
    v_lshl_add_u32 v19, v19, 4, v16
    v_add_u32 v4, 18432, v19
    v_xor_b32 v19, 4, v18
    v_xor_b32 v19, v19, v17
    v_lshl_add_u32 v19, v19, 4, v16
    v_add_u32 v5, 27648, v19
    v_lshrrev_b32 v16, 4, v0
    v_and_b32 v17, 15, v0
    v_lshlrev_b32 v18, 2, v16
    v_xor_b32 v17, v17, v18
    v_mul_u32_u24 v16, 3840, v16
    v_lshl_add_u32 v16, v17, 4, v16
    s_lshl_b32 s64, s50, 8
    v_add_u32 v6, s64, v16
    v_add_u32 v7, 14336, v6
    v_add_u32 v8, 28672, v6
    v_add_u32 v9, 43008, v6
    s_add_u32 s64, s50, s51
    s_and_b32 s64, s64, 3
    s_mul_i32 s64, s64, 5
    s_lshr_b32 s96, s64, 1
    s_waitcnt lgkmcnt(0)
    s_mov_b32 s32, s4
    s_mov_b32 s33, s5
    s_mov_b32 s34, 0x280000
    s_mov_b32 s35, 0x20000
    s_mov_b32 s36, s6
    s_mov_b32 s37, s7
    s_mov_b32 s38, 0x258000
    s_mov_b32 s39, 0x20000
    s_cmp_ge_u32 s49, 30
    s_cbranch_scc1 L_D_SKIP
    s_lshl_b32 s64, s96, 7
    s_mul_i32 s65, s96, 245760
    s_mov_b32 m0, 0
    s_add_u32 s66, s64, 0
    buffer_load_dwordx4 v2, s[32:35], s66 offen offset:0 lds
    buffer_load_dwordx4 v3, s[32:35], s66 offen offset:1024 lds
    buffer_load_dwordx4 v4, s[32:35], s66 offen offset:2048 lds
    buffer_load_dwordx4 v5, s[32:35], s66 offen offset:3072 lds
    s_mov_b32 m0, 49152
    s_add_u32 s66, s65, 0
    buffer_load_dwordx4 v6, s[36:39], s66 offen offset:0 lds
    buffer_load_dwordx4 v7, s[36:39], s66 offen offset:1024 lds
    buffer_load_dwordx4 v8, s[36:39], s66 offen offset:2048 lds
    buffer_load_dwordx4 v9, s[36:39], s66 offen offset:3072 lds
    s_mov_b32 m0, 4096
    s_add_u32 s66, s64, 40960
    buffer_load_dwordx4 v2, s[32:35], s66 offen offset:0 lds
    buffer_load_dwordx4 v3, s[32:35], s66 offen offset:1024 lds
    buffer_load_dwordx4 v4, s[32:35], s66 offen offset:2048 lds
    buffer_load_dwordx4 v5, s[32:35], s66 offen offset:3072 lds
    s_mov_b32 m0, 53248
    s_add_u32 s66, s65, 61440
    buffer_load_dwordx4 v6, s[36:39], s66 offen offset:0 lds
    buffer_load_dwordx4 v7, s[36:39], s66 offen offset:1024 lds
    buffer_load_dwordx4 v8, s[36:39], s66 offen offset:2048 lds
    buffer_load_dwordx4 v9, s[36:39], s66 offen offset:3072 lds
    s_mov_b32 m0, 8192
    s_add_u32 s66, s64, 81920
    buffer_load_dwordx4 v2, s[32:35], s66 offen offset:0 lds
    buffer_load_dwordx4 v3, s[32:35], s66 offen offset:1024 lds
    buffer_load_dwordx4 v4, s[32:35], s66 offen offset:2048 lds
    buffer_load_dwordx4 v5, s[32:35], s66 offen offset:3072 lds
    s_mov_b32 m0, 57344
    s_add_u32 s66, s65, 122880
    buffer_load_dwordx4 v6, s[36:39], s66 offen offset:0 lds
    buffer_load_dwordx4 v7, s[36:39], s66 offen offset:1024 lds
    buffer_load_dwordx4 v8, s[36:39], s66 offen offset:2048 lds
    buffer_load_dwordx4 v9, s[36:39], s66 offen offset:3072 lds
    s_mov_b32 m0, 12288
    s_add_u32 s66, s64, 122880
    buffer_load_dwordx4 v2, s[32:35], s66 offen offset:0 lds
    buffer_load_dwordx4 v3, s[32:35], s66 offen offset:1024 lds
    buffer_load_dwordx4 v4, s[32:35], s66 offen offset:2048 lds
    buffer_load_dwordx4 v5, s[32:35], s66 offen offset:3072 lds
    s_mov_b32 m0, 61440
    s_add_u32 s66, s65, 184320
    buffer_load_dwordx4 v6, s[36:39], s66 offen offset:0 lds
    buffer_load_dwordx4 v7, s[36:39], s66 offen offset:1024 lds
    buffer_load_dwordx4 v8, s[36:39], s66 offen offset:2048 lds
    buffer_load_dwordx4 v9, s[36:39], s66 offen offset:3072 lds
    s_add_u32 s96, s96, 1
    s_cmp_eq_u32 s96, 10
    s_cselect_b32 s96, 0, s96
L_D_SKIP:
    s_mov_b32 s28, s10
    s_mov_b32 s29, s11
    s_mov_b32 s30, 0x1000000
    s_mov_b32 s31, 0x20000
    s_call_b64 s[52:53], L_SETUP
    s_cmp_ge_u32 s49, 30
    s_cbranch_scc1 L_D_NT
    s_lshl_b32 s64, s96, 7
    s_mul_i32 s65, s96, 245760
    s_mov_b32 m0, 16384
    s_add_u32 s66, s64, 0
    buffer_load_dwordx4 v2, s[32:35], s66 offen offset:0 lds
    buffer_load_dwordx4 v3, s[32:35], s66 offen offset:1024 lds
    buffer_load_dwordx4 v4, s[32:35], s66 offen offset:2048 lds
    buffer_load_dwordx4 v5, s[32:35], s66 offen offset:3072 lds
    s_mov_b32 m0, 65536
    s_add_u32 s66, s65, 0
    buffer_load_dwordx4 v6, s[36:39], s66 offen offset:0 lds
    buffer_load_dwordx4 v7, s[36:39], s66 offen offset:1024 lds
    buffer_load_dwordx4 v8, s[36:39], s66 offen offset:2048 lds
    buffer_load_dwordx4 v9, s[36:39], s66 offen offset:3072 lds
    s_mov_b32 m0, 20480
    s_add_u32 s66, s64, 40960
    buffer_load_dwordx4 v2, s[32:35], s66 offen offset:0 lds
    buffer_load_dwordx4 v3, s[32:35], s66 offen offset:1024 lds
    buffer_load_dwordx4 v4, s[32:35], s66 offen offset:2048 lds
    buffer_load_dwordx4 v5, s[32:35], s66 offen offset:3072 lds
    s_mov_b32 m0, 69632
    s_add_u32 s66, s65, 61440
    buffer_load_dwordx4 v6, s[36:39], s66 offen offset:0 lds
    buffer_load_dwordx4 v7, s[36:39], s66 offen offset:1024 lds
    buffer_load_dwordx4 v8, s[36:39], s66 offen offset:2048 lds
    buffer_load_dwordx4 v9, s[36:39], s66 offen offset:3072 lds
    s_mov_b32 m0, 24576
    s_add_u32 s66, s64, 81920
    buffer_load_dwordx4 v2, s[32:35], s66 offen offset:0 lds
    buffer_load_dwordx4 v3, s[32:35], s66 offen offset:1024 lds
    buffer_load_dwordx4 v4, s[32:35], s66 offen offset:2048 lds
    buffer_load_dwordx4 v5, s[32:35], s66 offen offset:3072 lds
    s_mov_b32 m0, 73728
    s_add_u32 s66, s65, 122880
    buffer_load_dwordx4 v6, s[36:39], s66 offen offset:0 lds
    buffer_load_dwordx4 v7, s[36:39], s66 offen offset:1024 lds
    buffer_load_dwordx4 v8, s[36:39], s66 offen offset:2048 lds
    buffer_load_dwordx4 v9, s[36:39], s66 offen offset:3072 lds
    s_mov_b32 m0, 28672
    s_add_u32 s66, s64, 122880
    buffer_load_dwordx4 v2, s[32:35], s66 offen offset:0 lds
    buffer_load_dwordx4 v3, s[32:35], s66 offen offset:1024 lds
    buffer_load_dwordx4 v4, s[32:35], s66 offen offset:2048 lds
    buffer_load_dwordx4 v5, s[32:35], s66 offen offset:3072 lds
    s_mov_b32 m0, 77824
    s_add_u32 s66, s65, 184320
    buffer_load_dwordx4 v6, s[36:39], s66 offen offset:0 lds
    buffer_load_dwordx4 v7, s[36:39], s66 offen offset:1024 lds
    s_waitcnt vmcnt(54)
    buffer_load_dwordx4 v8, s[36:39], s66 offen offset:2048 lds
    buffer_load_dwordx4 v9, s[36:39], s66 offen offset:3072 lds
    s_add_u32 s96, s96, 1
    s_cmp_eq_u32 s96, 10
    s_cselect_b32 s96, 0, s96
    s_min_u32 s64, s58, 2
    s_add_u32 s59, s54, s64
    s_min_u32 s59, s59, 639
    s_mul_i32 s64, s64, 21248
    s_add_u32 s70, s64, 98304
    s_lshl_b32 s65, s59, 1
    v_mov_b32 v156, s65
    s_lshl_b32 s65, s59, 12
    v_lshl_add_u32 v14, v0, 4, s65
    v_lshl_add_u32 v15, v0, 4, s70
    s_mov_b32 s44, s18
    s_mov_b32 s45, s19
    s_mov_b32 s46, 0x280000
    s_mov_b32 s47, 0x20000
    s_mov_b32 m0, s70
    s_nop 0
    buffer_load_dwordx4 v14, s[44:47], 0 offen offset:0 nt lds
    buffer_load_dwordx4 v14, s[44:47], 0 offen offset:1024 nt lds
    buffer_load_dwordx4 v14, s[44:47], 0 offen offset:2048 nt lds
    buffer_load_dwordx4 v14, s[44:47], 0 offen offset:3072 nt lds
    s_mov_b32 s40, s20
    s_mov_b32 s41, s21
    s_mov_b32 s42, 0x500
    s_mov_b32 s43, 0x20000
    buffer_load_ushort v156, v156, s[40:43], 0 offen
    s_waitcnt vmcnt(37)
    s_barrier
    s_lshl_b32 s64, s96, 7
    s_mul_i32 s65, s96, 245760
    s_mov_b32 m0, 32768
    s_add_u32 s66, s64, 0
    buffer_load_dwordx4 v2, s[32:35], s66 offen offset:0 lds
    buffer_load_dwordx4 v3, s[32:35], s66 offen offset:1024 lds
    buffer_load_dwordx4 v4, s[32:35], s66 offen offset:2048 lds
    buffer_load_dwordx4 v5, s[32:35], s66 offen offset:3072 lds
    s_mov_b32 m0, 81920
    s_add_u32 s66, s65, 0
    buffer_load_dwordx4 v6, s[36:39], s66 offen offset:0 lds
    buffer_load_dwordx4 v7, s[36:39], s66 offen offset:1024 lds
    buffer_load_dwordx4 v8, s[36:39], s66 offen offset:2048 lds
    buffer_load_dwordx4 v9, s[36:39], s66 offen offset:3072 lds
    s_mov_b32 m0, 36864
    s_add_u32 s66, s64, 40960
    buffer_load_dwordx4 v2, s[32:35], s66 offen offset:0 lds
    buffer_load_dwordx4 v3, s[32:35], s66 offen offset:1024 lds
    buffer_load_dwordx4 v4, s[32:35], s66 offen offset:2048 lds
    buffer_load_dwordx4 v5, s[32:35], s66 offen offset:3072 lds
    s_mov_b32 m0, 86016
    s_add_u32 s66, s65, 61440
    buffer_load_dwordx4 v6, s[36:39], s66 offen offset:0 lds
    buffer_load_dwordx4 v7, s[36:39], s66 offen offset:1024 lds
    buffer_load_dwordx4 v8, s[36:39], s66 offen offset:2048 lds
    buffer_load_dwordx4 v9, s[36:39], s66 offen offset:3072 lds
    s_mov_b32 m0, 40960
    s_add_u32 s66, s64, 81920
    buffer_load_dwordx4 v2, s[32:35], s66 offen offset:0 lds
    buffer_load_dwordx4 v3, s[32:35], s66 offen offset:1024 lds
    buffer_load_dwordx4 v4, s[32:35], s66 offen offset:2048 lds
    buffer_load_dwordx4 v5, s[32:35], s66 offen offset:3072 lds
    s_mov_b32 m0, 90112
    s_add_u32 s66, s65, 122880
    buffer_load_dwordx4 v6, s[36:39], s66 offen offset:0 lds
    buffer_load_dwordx4 v7, s[36:39], s66 offen offset:1024 lds
    buffer_load_dwordx4 v8, s[36:39], s66 offen offset:2048 lds
    buffer_load_dwordx4 v9, s[36:39], s66 offen offset:3072 lds
    s_mov_b32 m0, 45056
    s_add_u32 s66, s64, 122880
    buffer_load_dwordx4 v2, s[32:35], s66 offen offset:0 lds
    s_waitcnt vmcnt(54)
    buffer_load_dwordx4 v3, s[32:35], s66 offen offset:1024 lds
    buffer_load_dwordx4 v4, s[32:35], s66 offen offset:2048 lds
    buffer_load_dwordx4 v5, s[32:35], s66 offen offset:3072 lds
    s_mov_b32 m0, 94208
    s_add_u32 s66, s65, 184320
    buffer_load_dwordx4 v6, s[36:39], s66 offen offset:0 lds
    buffer_load_dwordx4 v7, s[36:39], s66 offen offset:1024 lds
    buffer_load_dwordx4 v8, s[36:39], s66 offen offset:2048 lds
    buffer_load_dwordx4 v9, s[36:39], s66 offen offset:3072 lds
    s_add_u32 s96, s96, 1
    s_cmp_eq_u32 s96, 10
    s_cselect_b32 s96, 0, s96
    s_waitcnt vmcnt(37)
    s_barrier
    s_lshl_b32 s64, s96, 7
    s_mul_i32 s65, s96, 245760
    s_mov_b32 m0, 0
    s_add_u32 s66, s64, 0
    buffer_load_dwordx4 v2, s[32:35], s66 offen offset:0 lds
    buffer_load_dwordx4 v3, s[32:35], s66 offen offset:1024 lds
    buffer_load_dwordx4 v4, s[32:35], s66 offen offset:2048 lds
    buffer_load_dwordx4 v5, s[32:35], s66 offen offset:3072 lds
    s_mov_b32 m0, 49152
    s_add_u32 s66, s65, 0
    buffer_load_dwordx4 v6, s[36:39], s66 offen offset:0 lds
    buffer_load_dwordx4 v7, s[36:39], s66 offen offset:1024 lds
    buffer_load_dwordx4 v8, s[36:39], s66 offen offset:2048 lds
    buffer_load_dwordx4 v9, s[36:39], s66 offen offset:3072 lds
    s_mov_b32 m0, 4096
    s_add_u32 s66, s64, 40960
    buffer_load_dwordx4 v2, s[32:35], s66 offen offset:0 lds
    buffer_load_dwordx4 v3, s[32:35], s66 offen offset:1024 lds
    buffer_load_dwordx4 v4, s[32:35], s66 offen offset:2048 lds
    buffer_load_dwordx4 v5, s[32:35], s66 offen offset:3072 lds
    s_mov_b32 m0, 53248
    s_add_u32 s66, s65, 61440
    buffer_load_dwordx4 v6, s[36:39], s66 offen offset:0 lds
    buffer_load_dwordx4 v7, s[36:39], s66 offen offset:1024 lds
    buffer_load_dwordx4 v8, s[36:39], s66 offen offset:2048 lds
    buffer_load_dwordx4 v9, s[36:39], s66 offen offset:3072 lds
    s_mov_b32 m0, 8192
    s_add_u32 s66, s64, 81920
    buffer_load_dwordx4 v2, s[32:35], s66 offen offset:0 lds
    buffer_load_dwordx4 v3, s[32:35], s66 offen offset:1024 lds
    buffer_load_dwordx4 v4, s[32:35], s66 offen offset:2048 lds
    buffer_load_dwordx4 v5, s[32:35], s66 offen offset:3072 lds
    s_mov_b32 m0, 57344
    s_add_u32 s66, s65, 122880
    buffer_load_dwordx4 v6, s[36:39], s66 offen offset:0 lds
    buffer_load_dwordx4 v7, s[36:39], s66 offen offset:1024 lds
    buffer_load_dwordx4 v8, s[36:39], s66 offen offset:2048 lds
    buffer_load_dwordx4 v9, s[36:39], s66 offen offset:3072 lds
    s_mov_b32 m0, 12288
    s_add_u32 s66, s64, 122880
    buffer_load_dwordx4 v2, s[32:35], s66 offen offset:0 lds
    s_waitcnt vmcnt(54)
    buffer_load_dwordx4 v3, s[32:35], s66 offen offset:1024 lds
    buffer_load_dwordx4 v4, s[32:35], s66 offen offset:2048 lds
    buffer_load_dwordx4 v5, s[32:35], s66 offen offset:3072 lds
    s_mov_b32 m0, 61440
    s_add_u32 s66, s65, 184320
    buffer_load_dwordx4 v6, s[36:39], s66 offen offset:0 lds
    buffer_load_dwordx4 v7, s[36:39], s66 offen offset:1024 lds
    buffer_load_dwordx4 v8, s[36:39], s66 offen offset:2048 lds
    buffer_load_dwordx4 v9, s[36:39], s66 offen offset:3072 lds
    s_add_u32 s96, s96, 1
    s_cmp_eq_u32 s96, 10
    s_cselect_b32 s96, 0, s96
    s_waitcnt vmcnt(32)
    s_barrier
    s_lshl_b32 s64, s96, 7
    s_mul_i32 s65, s96, 245760
    s_mov_b32 m0, 16384
    s_add_u32 s66, s64, 0
    buffer_load_dwordx4 v2, s[32:35], s66 offen offset:0 lds
    buffer_load_dwordx4 v3, s[32:35], s66 offen offset:1024 lds
    buffer_load_dwordx4 v4, s[32:35], s66 offen offset:2048 lds
    buffer_load_dwordx4 v5, s[32:35], s66 offen offset:3072 lds
    s_mov_b32 m0, 65536
    s_add_u32 s66, s65, 0
    buffer_load_dwordx4 v6, s[36:39], s66 offen offset:0 lds
    buffer_load_dwordx4 v7, s[36:39], s66 offen offset:1024 lds
    buffer_load_dwordx4 v8, s[36:39], s66 offen offset:2048 lds
    buffer_load_dwordx4 v9, s[36:39], s66 offen offset:3072 lds
    s_mov_b32 m0, 20480
    s_add_u32 s66, s64, 40960
    buffer_load_dwordx4 v2, s[32:35], s66 offen offset:0 lds
    buffer_load_dwordx4 v3, s[32:35], s66 offen offset:1024 lds
    buffer_load_dwordx4 v4, s[32:35], s66 offen offset:2048 lds
    buffer_load_dwordx4 v5, s[32:35], s66 offen offset:3072 lds
    s_mov_b32 m0, 69632
    s_add_u32 s66, s65, 61440
    buffer_load_dwordx4 v6, s[36:39], s66 offen offset:0 lds
    buffer_load_dwordx4 v7, s[36:39], s66 offen offset:1024 lds
    buffer_load_dwordx4 v8, s[36:39], s66 offen offset:2048 lds
    buffer_load_dwordx4 v9, s[36:39], s66 offen offset:3072 lds
    s_mov_b32 m0, 24576
    s_add_u32 s66, s64, 81920
    buffer_load_dwordx4 v2, s[32:35], s66 offen offset:0 lds
    buffer_load_dwordx4 v3, s[32:35], s66 offen offset:1024 lds
    buffer_load_dwordx4 v4, s[32:35], s66 offen offset:2048 lds
    buffer_load_dwordx4 v5, s[32:35], s66 offen offset:3072 lds
    s_mov_b32 m0, 73728
    s_add_u32 s66, s65, 122880
    buffer_load_dwordx4 v6, s[36:39], s66 offen offset:0 lds
    buffer_load_dwordx4 v7, s[36:39], s66 offen offset:1024 lds
    buffer_load_dwordx4 v8, s[36:39], s66 offen offset:2048 lds
    buffer_load_dwordx4 v9, s[36:39], s66 offen offset:3072 lds
    s_mov_b32 m0, 28672
    s_add_u32 s66, s64, 122880
    buffer_load_dwordx4 v2, s[32:35], s66 offen offset:0 lds
    buffer_load_dwordx4 v3, s[32:35], s66 offen offset:1024 lds
    buffer_load_dwordx4 v4, s[32:35], s66 offen offset:2048 lds
    buffer_load_dwordx4 v5, s[32:35], s66 offen offset:3072 lds
    s_mov_b32 m0, 77824
    s_add_u32 s66, s65, 184320
    buffer_load_dwordx4 v6, s[36:39], s66 offen offset:0 lds
    buffer_load_dwordx4 v7, s[36:39], s66 offen offset:1024 lds
    s_waitcnt vmcnt(54)
    buffer_load_dwordx4 v8, s[36:39], s66 offen offset:2048 lds
    buffer_load_dwordx4 v9, s[36:39], s66 offen offset:3072 lds
    s_add_u32 s96, s96, 1
    s_cmp_eq_u32 s96, 10
    s_cselect_b32 s96, 0, s96
    s_waitcnt vmcnt(32)
    s_barrier
    s_lshl_b32 s64, s96, 7
    s_mul_i32 s65, s96, 245760
    s_mov_b32 m0, 32768
    s_add_u32 s66, s64, 0
    buffer_load_dwordx4 v2, s[32:35], s66 offen offset:0 lds
    buffer_load_dwordx4 v3, s[32:35], s66 offen offset:1024 lds
    buffer_load_dwordx4 v4, s[32:35], s66 offen offset:2048 lds
    buffer_load_dwordx4 v5, s[32:35], s66 offen offset:3072 lds
    s_mov_b32 m0, 81920
    s_add_u32 s66, s65, 0
    buffer_load_dwordx4 v6, s[36:39], s66 offen offset:0 lds
    buffer_load_dwordx4 v7, s[36:39], s66 offen offset:1024 lds
    buffer_load_dwordx4 v8, s[36:39], s66 offen offset:2048 lds
    buffer_load_dwordx4 v9, s[36:39], s66 offen offset:3072 lds
    s_mov_b32 m0, 36864
    s_add_u32 s66, s64, 40960
    buffer_load_dwordx4 v2, s[32:35], s66 offen offset:0 lds
    buffer_load_dwordx4 v3, s[32:35], s66 offen offset:1024 lds
    buffer_load_dwordx4 v4, s[32:35], s66 offen offset:2048 lds
    buffer_load_dwordx4 v5, s[32:35], s66 offen offset:3072 lds
    s_mov_b32 m0, 86016
    s_add_u32 s66, s65, 61440
    buffer_load_dwordx4 v6, s[36:39], s66 offen offset:0 lds
    buffer_load_dwordx4 v7, s[36:39], s66 offen offset:1024 lds
    buffer_load_dwordx4 v8, s[36:39], s66 offen offset:2048 lds
    buffer_load_dwordx4 v9, s[36:39], s66 offen offset:3072 lds
    s_mov_b32 m0, 40960
    s_add_u32 s66, s64, 81920
    buffer_load_dwordx4 v2, s[32:35], s66 offen offset:0 lds
    buffer_load_dwordx4 v3, s[32:35], s66 offen offset:1024 lds
    buffer_load_dwordx4 v4, s[32:35], s66 offen offset:2048 lds
    buffer_load_dwordx4 v5, s[32:35], s66 offen offset:3072 lds
    s_mov_b32 m0, 90112
    s_add_u32 s66, s65, 122880
    buffer_load_dwordx4 v6, s[36:39], s66 offen offset:0 lds
    buffer_load_dwordx4 v7, s[36:39], s66 offen offset:1024 lds
    buffer_load_dwordx4 v8, s[36:39], s66 offen offset:2048 lds
    buffer_load_dwordx4 v9, s[36:39], s66 offen offset:3072 lds
    s_mov_b32 m0, 45056
    s_add_u32 s66, s64, 122880
    buffer_load_dwordx4 v2, s[32:35], s66 offen offset:0 lds
    buffer_load_dwordx4 v3, s[32:35], s66 offen offset:1024 lds
    buffer_load_dwordx4 v4, s[32:35], s66 offen offset:2048 lds
    buffer_load_dwordx4 v5, s[32:35], s66 offen offset:3072 lds
    s_mov_b32 m0, 94208
    s_add_u32 s66, s65, 184320
    buffer_load_dwordx4 v6, s[36:39], s66 offen offset:0 lds
    buffer_load_dwordx4 v7, s[36:39], s66 offen offset:1024 lds
    s_waitcnt vmcnt(54)
    buffer_load_dwordx4 v8, s[36:39], s66 offen offset:2048 lds
    buffer_load_dwordx4 v9, s[36:39], s66 offen offset:3072 lds
    s_add_u32 s96, s96, 1
    s_cmp_eq_u32 s96, 10
    s_cselect_b32 s96, 0, s96
    s_waitcnt vmcnt(32)
    s_barrier
    s_lshl_b32 s64, s96, 7
    s_mul_i32 s65, s96, 245760
    s_mov_b32 m0, 0
    s_add_u32 s66, s64, 0
    buffer_load_dwordx4 v2, s[32:35], s66 offen offset:0 lds
    buffer_load_dwordx4 v3, s[32:35], s66 offen offset:1024 lds
    buffer_load_dwordx4 v4, s[32:35], s66 offen offset:2048 lds
    buffer_load_dwordx4 v5, s[32:35], s66 offen offset:3072 lds
    s_mov_b32 m0, 49152
    s_add_u32 s66, s65, 0
    buffer_load_dwordx4 v6, s[36:39], s66 offen offset:0 lds
    buffer_load_dwordx4 v7, s[36:39], s66 offen offset:1024 lds
    buffer_load_dwordx4 v8, s[36:39], s66 offen offset:2048 lds
    buffer_load_dwordx4 v9, s[36:39], s66 offen offset:3072 lds
    s_mov_b32 m0, 4096
    s_add_u32 s66, s64, 40960
    buffer_load_dwordx4 v2, s[32:35], s66 offen offset:0 lds
    buffer_load_dwordx4 v3, s[32:35], s66 offen offset:1024 lds
    buffer_load_dwordx4 v4, s[32:35], s66 offen offset:2048 lds
    buffer_load_dwordx4 v5, s[32:35], s66 offen offset:3072 lds
    s_mov_b32 m0, 53248
    s_add_u32 s66, s65, 61440
    buffer_load_dwordx4 v6, s[36:39], s66 offen offset:0 lds
    buffer_load_dwordx4 v7, s[36:39], s66 offen offset:1024 lds
    buffer_load_dwordx4 v8, s[36:39], s66 offen offset:2048 lds
    buffer_load_dwordx4 v9, s[36:39], s66 offen offset:3072 lds
    s_mov_b32 m0, 8192
    s_add_u32 s66, s64, 81920
    buffer_load_dwordx4 v2, s[32:35], s66 offen offset:0 lds
    buffer_load_dwordx4 v3, s[32:35], s66 offen offset:1024 lds
    buffer_load_dwordx4 v4, s[32:35], s66 offen offset:2048 lds
    buffer_load_dwordx4 v5, s[32:35], s66 offen offset:3072 lds
    s_mov_b32 m0, 57344
    s_add_u32 s66, s65, 122880
    buffer_load_dwordx4 v6, s[36:39], s66 offen offset:0 lds
    buffer_load_dwordx4 v7, s[36:39], s66 offen offset:1024 lds
    buffer_load_dwordx4 v8, s[36:39], s66 offen offset:2048 lds
    buffer_load_dwordx4 v9, s[36:39], s66 offen offset:3072 lds
    s_mov_b32 m0, 12288
    s_add_u32 s66, s64, 122880
    buffer_load_dwordx4 v2, s[32:35], s66 offen offset:0 lds
    buffer_load_dwordx4 v3, s[32:35], s66 offen offset:1024 lds
    buffer_load_dwordx4 v4, s[32:35], s66 offen offset:2048 lds
    buffer_load_dwordx4 v5, s[32:35], s66 offen offset:3072 lds
    s_mov_b32 m0, 61440
    s_add_u32 s66, s65, 184320
    buffer_load_dwordx4 v6, s[36:39], s66 offen offset:0 lds
    buffer_load_dwordx4 v7, s[36:39], s66 offen offset:1024 lds
    s_waitcnt vmcnt(54)
    buffer_load_dwordx4 v8, s[36:39], s66 offen offset:2048 lds
    buffer_load_dwordx4 v9, s[36:39], s66 offen offset:3072 lds
    s_add_u32 s96, s96, 1
    s_cmp_eq_u32 s96, 10
    s_cselect_b32 s96, 0, s96
    s_waitcnt vmcnt(32)
    s_barrier
    s_lshl_b32 s64, s96, 7
    s_mul_i32 s65, s96, 245760
    s_mov_b32 m0, 16384
    s_add_u32 s66, s64, 0
    buffer_load_dwordx4 v2, s[32:35], s66 offen offset:0 lds
    buffer_load_dwordx4 v3, s[32:35], s66 offen offset:1024 lds
    buffer_load_dwordx4 v4, s[32:35], s66 offen offset:2048 lds
    buffer_load_dwordx4 v5, s[32:35], s66 offen offset:3072 lds
    s_mov_b32 m0, 65536
    s_add_u32 s66, s65, 0
    buffer_load_dwordx4 v6, s[36:39], s66 offen offset:0 lds
    buffer_load_dwordx4 v7, s[36:39], s66 offen offset:1024 lds
    buffer_load_dwordx4 v8, s[36:39], s66 offen offset:2048 lds
    buffer_load_dwordx4 v9, s[36:39], s66 offen offset:3072 lds
    s_mov_b32 m0, 20480
    s_add_u32 s66, s64, 40960
    buffer_load_dwordx4 v2, s[32:35], s66 offen offset:0 lds
    buffer_load_dwordx4 v3, s[32:35], s66 offen offset:1024 lds
    buffer_load_dwordx4 v4, s[32:35], s66 offen offset:2048 lds
    buffer_load_dwordx4 v5, s[32:35], s66 offen offset:3072 lds
    s_mov_b32 m0, 69632
    s_add_u32 s66, s65, 61440
    buffer_load_dwordx4 v6, s[36:39], s66 offen offset:0 lds
    buffer_load_dwordx4 v7, s[36:39], s66 offen offset:1024 lds
    buffer_load_dwordx4 v8, s[36:39], s66 offen offset:2048 lds
    buffer_load_dwordx4 v9, s[36:39], s66 offen offset:3072 lds
    s_mov_b32 m0, 24576
    s_add_u32 s66, s64, 81920
    buffer_load_dwordx4 v2, s[32:35], s66 offen offset:0 lds
    buffer_load_dwordx4 v3, s[32:35], s66 offen offset:1024 lds
    buffer_load_dwordx4 v4, s[32:35], s66 offen offset:2048 lds
    buffer_load_dwordx4 v5, s[32:35], s66 offen offset:3072 lds
    s_mov_b32 m0, 73728
    s_add_u32 s66, s65, 122880
    buffer_load_dwordx4 v6, s[36:39], s66 offen offset:0 lds
    buffer_load_dwordx4 v7, s[36:39], s66 offen offset:1024 lds
    buffer_load_dwordx4 v8, s[36:39], s66 offen offset:2048 lds
    buffer_load_dwordx4 v9, s[36:39], s66 offen offset:3072 lds
    s_mov_b32 m0, 28672
    s_add_u32 s66, s64, 122880
    buffer_load_dwordx4 v2, s[32:35], s66 offen offset:0 lds
    buffer_load_dwordx4 v3, s[32:35], s66 offen offset:1024 lds
    buffer_load_dwordx4 v4, s[32:35], s66 offen offset:2048 lds
    buffer_load_dwordx4 v5, s[32:35], s66 offen offset:3072 lds
    s_mov_b32 m0, 77824
    s_add_u32 s66, s65, 184320
    buffer_load_dwordx4 v6, s[36:39], s66 offen offset:0 lds
    buffer_load_dwordx4 v7, s[36:39], s66 offen offset:1024 lds
    s_waitcnt vmcnt(54)
    buffer_load_dwordx4 v8, s[36:39], s66 offen offset:2048 lds
    buffer_load_dwordx4 v9, s[36:39], s66 offen offset:3072 lds
    s_add_u32 s96, s96, 1
    s_cmp_eq_u32 s96, 10
    s_cselect_b32 s96, 0, s96
    s_waitcnt vmcnt(32)
    s_barrier
    s_lshl_b32 s64, s96, 7
    s_mul_i32 s65, s96, 245760
    s_mov_b32 m0, 32768
    s_add_u32 s66, s64, 0
    buffer_load_dwordx4 v2, s[32:35], s66 offen offset:0 lds
    buffer_load_dwordx4 v3, s[32:35], s66 offen offset:1024 lds
    buffer_load_dwordx4 v4, s[32:35], s66 offen offset:2048 lds
    buffer_load_dwordx4 v5, s[32:35], s66 offen offset:3072 lds
    s_mov_b32 m0, 81920
    s_add_u32 s66, s65, 0
    buffer_load_dwordx4 v6, s[36:39], s66 offen offset:0 lds
    buffer_load_dwordx4 v7, s[36:39], s66 offen offset:1024 lds
    buffer_load_dwordx4 v8, s[36:39], s66 offen offset:2048 lds
    buffer_load_dwordx4 v9, s[36:39], s66 offen offset:3072 lds
    s_mov_b32 m0, 36864
    s_add_u32 s66, s64, 40960
    buffer_load_dwordx4 v2, s[32:35], s66 offen offset:0 lds
    buffer_load_dwordx4 v3, s[32:35], s66 offen offset:1024 lds
    buffer_load_dwordx4 v4, s[32:35], s66 offen offset:2048 lds
    buffer_load_dwordx4 v5, s[32:35], s66 offen offset:3072 lds
    s_mov_b32 m0, 86016
    s_add_u32 s66, s65, 61440
    buffer_load_dwordx4 v6, s[36:39], s66 offen offset:0 lds
    buffer_load_dwordx4 v7, s[36:39], s66 offen offset:1024 lds
    buffer_load_dwordx4 v8, s[36:39], s66 offen offset:2048 lds
    buffer_load_dwordx4 v9, s[36:39], s66 offen offset:3072 lds
    s_mov_b32 m0, 40960
    s_add_u32 s66, s64, 81920
    buffer_load_dwordx4 v2, s[32:35], s66 offen offset:0 lds
    buffer_load_dwordx4 v3, s[32:35], s66 offen offset:1024 lds
    buffer_load_dwordx4 v4, s[32:35], s66 offen offset:2048 lds
    buffer_load_dwordx4 v5, s[32:35], s66 offen offset:3072 lds
    s_mov_b32 m0, 90112
    s_add_u32 s66, s65, 122880
    buffer_load_dwordx4 v6, s[36:39], s66 offen offset:0 lds
    buffer_load_dwordx4 v7, s[36:39], s66 offen offset:1024 lds
    buffer_load_dwordx4 v8, s[36:39], s66 offen offset:2048 lds
    buffer_load_dwordx4 v9, s[36:39], s66 offen offset:3072 lds
    s_mov_b32 m0, 45056
    s_add_u32 s66, s64, 122880
    buffer_load_dwordx4 v2, s[32:35], s66 offen offset:0 lds
    buffer_load_dwordx4 v3, s[32:35], s66 offen offset:1024 lds
    buffer_load_dwordx4 v4, s[32:35], s66 offen offset:2048 lds
    buffer_load_dwordx4 v5, s[32:35], s66 offen offset:3072 lds
    s_mov_b32 m0, 94208
    s_add_u32 s66, s65, 184320
    buffer_load_dwordx4 v6, s[36:39], s66 offen offset:0 lds
    buffer_load_dwordx4 v7, s[36:39], s66 offen offset:1024 lds
    s_waitcnt vmcnt(54)
    buffer_load_dwordx4 v8, s[36:39], s66 offen offset:2048 lds
    buffer_load_dwordx4 v9, s[36:39], s66 offen offset:3072 lds
    s_add_u32 s96, s96, 1
    s_cmp_eq_u32 s96, 10
    s_cselect_b32 s96, 0, s96
    s_waitcnt vmcnt(32)
    s_barrier
    s_lshl_b32 s64, s96, 7
    s_mul_i32 s65, s96, 245760
    s_mov_b32 m0, 0
    s_add_u32 s66, s64, 0
    buffer_load_dwordx4 v2, s[32:35], s66 offen offset:0 lds
    buffer_load_dwordx4 v3, s[32:35], s66 offen offset:1024 lds
    buffer_load_dwordx4 v4, s[32:35], s66 offen offset:2048 lds
    buffer_load_dwordx4 v5, s[32:35], s66 offen offset:3072 lds
    s_mov_b32 m0, 49152
    s_add_u32 s66, s65, 0
    buffer_load_dwordx4 v6, s[36:39], s66 offen offset:0 lds
    buffer_load_dwordx4 v7, s[36:39], s66 offen offset:1024 lds
    buffer_load_dwordx4 v8, s[36:39], s66 offen offset:2048 lds
    buffer_load_dwordx4 v9, s[36:39], s66 offen offset:3072 lds
    s_mov_b32 m0, 4096
    s_add_u32 s66, s64, 40960
    buffer_load_dwordx4 v2, s[32:35], s66 offen offset:0 lds
    buffer_load_dwordx4 v3, s[32:35], s66 offen offset:1024 lds
    buffer_load_dwordx4 v4, s[32:35], s66 offen offset:2048 lds
    buffer_load_dwordx4 v5, s[32:35], s66 offen offset:3072 lds
    s_mov_b32 m0, 53248
    s_add_u32 s66, s65, 61440
    buffer_load_dwordx4 v6, s[36:39], s66 offen offset:0 lds
    buffer_load_dwordx4 v7, s[36:39], s66 offen offset:1024 lds
    buffer_load_dwordx4 v8, s[36:39], s66 offen offset:2048 lds
    buffer_load_dwordx4 v9, s[36:39], s66 offen offset:3072 lds
    s_mov_b32 m0, 8192
    s_add_u32 s66, s64, 81920
    buffer_load_dwordx4 v2, s[32:35], s66 offen offset:0 lds
    buffer_load_dwordx4 v3, s[32:35], s66 offen offset:1024 lds
    buffer_load_dwordx4 v4, s[32:35], s66 offen offset:2048 lds
    buffer_load_dwordx4 v5, s[32:35], s66 offen offset:3072 lds
    s_mov_b32 m0, 57344
    s_add_u32 s66, s65, 122880
    buffer_load_dwordx4 v6, s[36:39], s66 offen offset:0 lds
    buffer_load_dwordx4 v7, s[36:39], s66 offen offset:1024 lds
    buffer_load_dwordx4 v8, s[36:39], s66 offen offset:2048 lds
    buffer_load_dwordx4 v9, s[36:39], s66 offen offset:3072 lds
    s_mov_b32 m0, 12288
    s_add_u32 s66, s64, 122880
    buffer_load_dwordx4 v2, s[32:35], s66 offen offset:0 lds
    buffer_load_dwordx4 v3, s[32:35], s66 offen offset:1024 lds
    buffer_load_dwordx4 v4, s[32:35], s66 offen offset:2048 lds
    buffer_load_dwordx4 v5, s[32:35], s66 offen offset:3072 lds
    s_mov_b32 m0, 61440
    s_add_u32 s66, s65, 184320
    buffer_load_dwordx4 v6, s[36:39], s66 offen offset:0 lds
    buffer_load_dwordx4 v7, s[36:39], s66 offen offset:1024 lds
    s_waitcnt vmcnt(54)
    buffer_load_dwordx4 v8, s[36:39], s66 offen offset:2048 lds
    buffer_load_dwordx4 v9, s[36:39], s66 offen offset:3072 lds
    s_add_u32 s96, s96, 1
    s_cmp_eq_u32 s96, 10
    s_cselect_b32 s96, 0, s96
    s_waitcnt vmcnt(32)
    s_barrier
    ds_read_b128 v[132:135], v15 offset:0
    ds_read_b64 v[136:137], v15 offset:16
    ds_read_b128 v[138:141], v15 offset:1024
    ds_read_b64 v[142:143], v15 offset:1040
    ds_read_b128 v[144:147], v15 offset:2048
    ds_read_b64 v[148:149], v15 offset:2064
    ds_read_b128 v[150:153], v15 offset:3072
    ds_read_b64 v[154:155], v15 offset:3088
    v_lshrrev_b32 v22, 4, v0
    s_lshl_b32 s64, s59, 12
    v_lshrrev_b32 v23, 2, v0
    v_and_b32 v23, 3, v23
    v_mul_u32_u24 v23, 4160, v23
    v_lshl_add_u32 v23, v22, 4, v23
    v_and_b32 v24, 3, v0
    v_lshl_add_u32 v23, v24, 3, v23
    v_add_u32 v16, s70, v23
    v_and_b32 v23, 15, v0
    v_lshlrev_b32 v23, 5, v23
    v_lshlrev_b32 v24, 4, v22
    v_sub_u32 v24, v24, v23
    v_add_u32 v24, s70, v24
    v_add_u32 v17, 17120, v24
    v_lshl_add_u32 v23, v22, 3, v23
    v_sub_u32 v24, s70, v23
    v_add_u32 v18, 17144, v24
    s_add_u32 s64, s64, 0xa00000
    v_add_u32 v19, s64, v23
    v_lshlrev_b32 v20, 16, v156
    v_mov_b32 v112, 0
    v_mov_b32 v113, 0
    v_mov_b32 v114, 0
    v_mov_b32 v115, 0
    v_mov_b32 v116, 0
    v_mov_b32 v117, 0
    s_waitcnt lgkmcnt(0)
    v_readlane_b32 s65, v132, 0
    v_readlane_b32 s66, v133, 0
    v_alignbit_b32 v64, v133, v132, 16
    v_alignbit_b32 v65, v134, v133, 16
    v_alignbit_b32 v66, v135, v134, 16
    v_alignbit_b32 v67, v136, v135, 16
    v_mov_b32 v68, v133
    v_mov_b32 v69, v134
    v_mov_b32 v70, v135
    v_mov_b32 v71, v136
    v_alignbit_b32 v72, v134, v133, 16
    v_alignbit_b32 v73, v135, v134, 16
    v_alignbit_b32 v74, v136, v135, 16
    v_alignbit_b32 v75, v137, v136, 16
    v_writelane_b32 v116, s65, 1
    v_writelane_b32 v117, s66, 1
    s_waitcnt vmcnt(0)
    s_barrier
    v_alignbit_b32 v76, v139, v138, 16
    v_alignbit_b32 v77, v140, v139, 16
    v_alignbit_b32 v78, v141, v140, 16
    v_alignbit_b32 v79, v142, v141, 16
    v_mov_b32 v80, v139
    v_mov_b32 v81, v140
    v_mov_b32 v82, v141
    v_mov_b32 v83, v142
    v_alignbit_b32 v84, v140, v139, 16
    v_alignbit_b32 v85, v141, v140, 16
    v_alignbit_b32 v86, v142, v141, 16
    v_alignbit_b32 v87, v143, v142, 16
    v_alignbit_b32 v88, v145, v144, 16
    v_alignbit_b32 v89, v146, v145, 16
    v_alignbit_b32 v90, v147, v146, 16
    v_alignbit_b32 v91, v148, v147, 16
    v_mov_b32 v92, v145
    v_mov_b32 v93, v146
    v_mov_b32 v94, v147
    v_mov_b32 v95, v148
    v_alignbit_b32 v96, v146, v145, 16
    v_alignbit_b32 v97, v147, v146, 16
    v_alignbit_b32 v98, v148, v147, 16
    v_alignbit_b32 v99, v149, v148, 16
    v_alignbit_b32 v100, v151, v150, 16
    v_alignbit_b32 v101, v152, v151, 16
    v_alignbit_b32 v102, v153, v152, 16
    v_alignbit_b32 v103, v154, v153, 16
    v_mov_b32 v104, v151
    v_mov_b32 v105, v152
    v_mov_b32 v106, v153
    v_mov_b32 v107, v154
    v_alignbit_b32 v108, v152, v151, 16
    v_alignbit_b32 v109, v153, v152, 16
    v_alignbit_b32 v110, v154, v153, 16
    v_alignbit_b32 v111, v155, v154, 16
    v_alignbit_b32 v120, v113, v112, 16
    v_alignbit_b32 v121, v114, v113, 16
    v_alignbit_b32 v122, v115, v114, 16
    v_alignbit_b32 v123, v116, v115, 16
    v_mov_b32 v124, v113
    v_mov_b32 v125, v114
    v_mov_b32 v126, v115
    v_mov_b32 v127, v116
    v_alignbit_b32 v128, v114, v113, 16
    v_alignbit_b32 v129, v115, v114, 16
    v_alignbit_b32 v130, v116, v115, 16
    v_alignbit_b32 v131, v117, v116, 16
L_CONV:
    s_setprio 0
    ds_write_b128 v15, v[64:67] offset:32
    ds_write_b128 v15, v[68:71] offset:4192
    ds_write_b128 v15, v[72:75] offset:8352
    ds_write_b128 v15, v[134:137] offset:12512
    ds_write_b128 v15, v[76:79] offset:1056
    ds_write_b128 v15, v[80:83] offset:5216
    ds_write_b128 v15, v[84:87] offset:9376
    ds_write_b128 v15, v[140:143] offset:13536
    ds_write_b128 v15, v[88:91] offset:2080
    ds_write_b128 v15, v[92:95] offset:6240
    ds_write_b128 v15, v[96:99] offset:10400
    ds_write_b128 v15, v[146:149] offset:14560
    ds_write_b128 v15, v[100:103] offset:3104
    ds_write_b128 v15, v[104:107] offset:7264
    ds_write_b128 v15, v[108:111] offset:11424
    ds_write_b128 v15, v[152:155] offset:15584
    s_mov_b32 exec_hi, 0
    ds_write_b128 v15, v[112:115] offset:20736
    s_mov_b64 exec, 3
    ds_write_b128 v15, v[120:123] offset:0
    ds_write_b128 v15, v[124:127] offset:4160
    ds_write_b128 v15, v[128:131] offset:8320
    ds_write_b128 v15, v[114:117] offset:12480
    s_mov_b64 exec, -1
    v_mov_b32 v2, v16
    v_mov_b32 v3, v17
    v_mov_b32 v4, v18
    v_mov_b32 v5, v19
    v_mov_b32 v7, v20
    v_mov_b32 v14, 162048
    s_mov_b32 s62, 0
SIG_1:
    ds_read_b32 v15, v14 offset:0
    s_waitcnt lgkmcnt(0)
    v_readfirstlane_b32 s64, v15
    s_add_u32 s62, s62, 1
    s_cmp_ge_u32 s64, 1
    s_cbranch_scc1 SIGD_2
    s_sleep 1
    s_cmp_lt_u32 s62, 8000000
    s_cbranch_scc1 SIG_1
SIGD_2:
    s_setprio 3
    ds_read_b64_tr_b16 v[64:65], v2 offset:0
    ds_read_b64_tr_b16 v[66:67], v2 offset:8
    ds_read_b128 v[96:99], v3 offset:3584
    ds_read_b128 v[100:103], v3 offset:3072
    ds_read_b128 v[104:107], v3 offset:2560
    ds_read_b128 v[108:111], v3 offset:2048
    ds_read_b128 v[112:115], v3 offset:1536
    ds_read_b128 v[116:119], v3 offset:1024
    ds_read_b128 v[120:123], v3 offset:512
    ds_read_b128 v[124:127], v3 offset:0
    ds_read_b64_tr_b16 v[68:69], v2 offset:512
    ds_read_b64_tr_b16 v[70:71], v2 offset:520
    ds_read_b64_tr_b16 v[72:73], v2 offset:1024
    ds_read_b64_tr_b16 v[74:75], v2 offset:1032
    ds_read_b64_tr_b16 v[76:77], v2 offset:1536
    ds_read_b64_tr_b16 v[78:79], v2 offset:1544
    ds_read_b64_tr_b16 v[80:81], v2 offset:2048
    ds_read_b64_tr_b16 v[82:83], v2 offset:2056
    ds_read_b64_tr_b16 v[84:85], v2 offset:2560
    ds_read_b64_tr_b16 v[86:87], v2 offset:2568
    ds_read_b64_tr_b16 v[88:89], v2 offset:3072
    ds_read_b64_tr_b16 v[90:91], v2 offset:3080
    ds_read_b64_tr_b16 v[92:93], v2 offset:3584
    ds_read_b64_tr_b16 v[94:95], v2 offset:3592
    s_waitcnt lgkmcnt(15)
    v_mfma_f32_16x16x32_bf16 v[16:19], v[64:67], v[96:99], 0
    v_mfma_f32_16x16x32_bf16 v[20:23], v[64:67], v[100:103], 0
    v_mfma_f32_16x16x32_bf16 v[24:27], v[64:67], v[104:107], 0
    v_mfma_f32_16x16x32_bf16 v[28:31], v[64:67], v[108:111], 0
    ds_read_b64_tr_b16 v[128:129], v2 offset:64
    v_mfma_f32_16x16x32_bf16 v[32:35], v[64:67], v[112:115], 0
    ds_read_b64_tr_b16 v[130:131], v2 offset:72
    v_mfma_f32_16x16x32_bf16 v[36:39], v[64:67], v[116:119], 0
    ds_read_b128 v[160:163], v3 offset:3648
    v_mfma_f32_16x16x32_bf16 v[40:43], v[64:67], v[120:123], 0
    ds_read_b128 v[164:167], v3 offset:3136
    s_waitcnt lgkmcnt(15)
    v_mfma_f32_16x16x32_bf16 v[44:47], v[64:67], v[124:127], 0
    ds_read_b128 v[168:171], v3 offset:2624
    v_mfma_f32_16x16x32_bf16 v[20:23], v[68:71], v[96:99], v[20:23]
    ds_read_b128 v[172:175], v3 offset:2112
    v_mfma_f32_16x16x32_bf16 v[24:27], v[68:71], v[100:103], v[24:27]
    ds_read_b128 v[176:179], v3 offset:1600
    v_mfma_f32_16x16x32_bf16 v[28:31], v[68:71], v[104:107], v[28:31]
    ds_read_b128 v[180:183], v3 offset:1088
    v_mfma_f32_16x16x32_bf16 v[32:35], v[68:71], v[108:111], v[32:35]
    ds_read_b128 v[184:187], v3 offset:576
    v_mfma_f32_16x16x32_bf16 v[36:39], v[68:71], v[112:115], v[36:39]
    ds_read_b128 v[188:191], v3 offset:64
    v_mfma_f32_16x16x32_bf16 v[40:43], v[68:71], v[116:119], v[40:43]
    ds_read_b64_tr_b16 v[132:133], v2 offset:576
    v_mfma_f32_16x16x32_bf16 v[44:47], v[68:71], v[120:123], v[44:47]
    ds_read_b64_tr_b16 v[134:135], v2 offset:584
    s_waitcnt lgkmcnt(15)
    v_mfma_f32_16x16x32_bf16 v[24:27], v[72:75], v[96:99], v[24:27]
    ds_read_b64_tr_b16 v[136:137], v2 offset:1088
    v_mfma_f32_16x16x32_bf16 v[28:31], v[72:75], v[100:103], v[28:31]
    ds_read_b64_tr_b16 v[138:139], v2 offset:1096
    v_mfma_f32_16x16x32_bf16 v[32:35], v[72:75], v[104:107], v[32:35]
    ds_read_b64_tr_b16 v[140:141], v2 offset:1600
    v_mfma_f32_16x16x32_bf16 v[36:39], v[72:75], v[108:111], v[36:39]
    ds_read_b64_tr_b16 v[142:143], v2 offset:1608
    v_mfma_f32_16x16x32_bf16 v[40:43], v[72:75], v[112:115], v[40:43]
    ds_read_b64_tr_b16 v[144:145], v2 offset:2112
    v_mfma_f32_16x16x32_bf16 v[44:47], v[72:75], v[116:119], v[44:47]
    ds_read_b64_tr_b16 v[146:147], v2 offset:2120
    v_mfma_f32_16x16x32_bf16 v[28:31], v[76:79], v[96:99], v[28:31]
    ds_read_b64_tr_b16 v[148:149], v2 offset:2624
    v_mfma_f32_16x16x32_bf16 v[32:35], v[76:79], v[100:103], v[32:35]
    ds_read_b64_tr_b16 v[150:151], v2 offset:2632
    v_mfma_f32_16x16x32_bf16 v[36:39], v[76:79], v[104:107], v[36:39]
    ds_read_b64_tr_b16 v[152:153], v2 offset:3136
    v_mfma_f32_16x16x32_bf16 v[40:43], v[76:79], v[108:111], v[40:43]
    ds_read_b64_tr_b16 v[154:155], v2 offset:3144
    v_mfma_f32_16x16x32_bf16 v[44:47], v[76:79], v[112:115], v[44:47]
    ds_read_b64_tr_b16 v[156:157], v2 offset:3648
    v_mfma_f32_16x16x32_bf16 v[32:35], v[80:83], v[96:99], v[32:35]
    ds_read_b64_tr_b16 v[158:159], v2 offset:3656
    v_mfma_f32_16x16x32_bf16 v[36:39], v[80:83], v[100:103], v[36:39]
    v_mov_b32 v223, v240
    v_mfma_f32_16x16x32_bf16 v[40:43], v[80:83], v[104:107], v[40:43]
    v_mov_b32 v222, v240
    v_mfma_f32_16x16x32_bf16 v[44:47], v[80:83], v[108:111], v[44:47]
    v_mov_b32 v221, v240
    v_mfma_f32_16x16x32_bf16 v[36:39], v[84:87], v[96:99], v[36:39]
    v_mov_b32 v220, v240
    v_mfma_f32_16x16x32_bf16 v[40:43], v[84:87], v[100:103], v[40:43]
    v_mov_b32 v219, v240
    v_mfma_f32_16x16x32_bf16 v[44:47], v[84:87], v[104:107], v[44:47]
    v_mov_b32 v218, v240
    s_waitcnt lgkmcnt(15)
    v_mfma_f32_16x16x32_bf16 v[40:43], v[88:91], v[96:99], v[40:43]
    v_mov_b32 v217, v240
    v_mfma_f32_16x16x32_bf16 v[44:47], v[88:91], v[100:103], v[44:47]
    v_mov_b32 v216, v240
    v_mfma_f32_16x16x32_bf16 v[44:47], v[92:95], v[96:99], v[44:47]
    v_mov_b32 v215, v240
    v_mfma_f32_16x16x32_bf16 v[16:19], v[128:131], v[160:163], v[16:19]
    v_mfma_f32_16x16x32_bf16 v[20:23], v[128:131], v[164:167], v[20:23]
    v_mfma_f32_16x16x32_bf16 v[24:27], v[128:131], v[168:171], v[24:27]
    v_mfma_f32_16x16x32_bf16 v[28:31], v[128:131], v[172:175], v[28:31]
    ds_read_b64_tr_b16 v[64:65], v2 offset:128
    v_mfma_f32_16x16x32_bf16 v[32:35], v[128:131], v[176:179], v[32:35]
    ds_read_b64_tr_b16 v[66:67], v2 offset:136
    v_mfma_f32_16x16x32_bf16 v[36:39], v[128:131], v[180:183], v[36:39]
    ds_read_b128 v[96:99], v3 offset:3712
    v_mfma_f32_16x16x32_bf16 v[40:43], v[128:131], v[184:187], v[40:43]
    ds_read_b128 v[100:103], v3 offset:3200
    s_waitcnt lgkmcnt(15)
    v_mfma_f32_16x16x32_bf16 v[44:47], v[128:131], v[188:191], v[44:47]
    ds_read_b128 v[104:107], v3 offset:2688
    v_mfma_f32_16x16x32_bf16 v[20:23], v[132:135], v[160:163], v[20:23]
    ds_read_b128 v[108:111], v3 offset:2176
    v_mfma_f32_16x16x32_bf16 v[24:27], v[132:135], v[164:167], v[24:27]
    ds_read_b128 v[112:115], v3 offset:1664
    v_mfma_f32_16x16x32_bf16 v[28:31], v[132:135], v[168:171], v[28:31]
    ds_read_b128 v[116:119], v3 offset:1152
    v_mfma_f32_16x16x32_bf16 v[32:35], v[132:135], v[172:175], v[32:35]
    ds_read_b128 v[120:123], v3 offset:640
    v_mfma_f32_16x16x32_bf16 v[36:39], v[132:135], v[176:179], v[36:39]
    ds_read_b128 v[124:127], v3 offset:128
    v_mfma_f32_16x16x32_bf16 v[40:43], v[132:135], v[180:183], v[40:43]
    ds_read_b64_tr_b16 v[68:69], v2 offset:640
    v_mfma_f32_16x16x32_bf16 v[44:47], v[132:135], v[184:187], v[44:47]
    ds_read_b64_tr_b16 v[70:71], v2 offset:648
    s_waitcnt lgkmcnt(15)
    v_mfma_f32_16x16x32_bf16 v[24:27], v[136:139], v[160:163], v[24:27]
    ds_read_b64_tr_b16 v[72:73], v2 offset:1152
    v_mfma_f32_16x16x32_bf16 v[28:31], v[136:139], v[164:167], v[28:31]
    ds_read_b64_tr_b16 v[74:75], v2 offset:1160
    v_mfma_f32_16x16x32_bf16 v[32:35], v[136:139], v[168:171], v[32:35]
    ds_read_b64_tr_b16 v[76:77], v2 offset:1664
    v_mfma_f32_16x16x32_bf16 v[36:39], v[136:139], v[172:175], v[36:39]
    ds_read_b64_tr_b16 v[78:79], v2 offset:1672
    v_mfma_f32_16x16x32_bf16 v[40:43], v[136:139], v[176:179], v[40:43]
    ds_read_b64_tr_b16 v[80:81], v2 offset:2176
    v_mfma_f32_16x16x32_bf16 v[44:47], v[136:139], v[180:183], v[44:47]
    ds_read_b64_tr_b16 v[82:83], v2 offset:2184
    v_mfma_f32_16x16x32_bf16 v[28:31], v[140:143], v[160:163], v[28:31]
    ds_read_b64_tr_b16 v[84:85], v2 offset:2688
    v_mfma_f32_16x16x32_bf16 v[32:35], v[140:143], v[164:167], v[32:35]
    ds_read_b64_tr_b16 v[86:87], v2 offset:2696
    v_mfma_f32_16x16x32_bf16 v[36:39], v[140:143], v[168:171], v[36:39]
    ds_read_b64_tr_b16 v[88:89], v2 offset:3200
    v_mfma_f32_16x16x32_bf16 v[40:43], v[140:143], v[172:175], v[40:43]
    ds_read_b64_tr_b16 v[90:91], v2 offset:3208
    v_mfma_f32_16x16x32_bf16 v[44:47], v[140:143], v[176:179], v[44:47]
    ds_read_b64_tr_b16 v[92:93], v2 offset:3712
    v_mfma_f32_16x16x32_bf16 v[32:35], v[144:147], v[160:163], v[32:35]
    ds_read_b64_tr_b16 v[94:95], v2 offset:3720
    v_mfma_f32_16x16x32_bf16 v[36:39], v[144:147], v[164:167], v[36:39]
    v_mov_b32 v214, v240
    v_mfma_f32_16x16x32_bf16 v[40:43], v[144:147], v[168:171], v[40:43]
    v_mov_b32 v213, v240
    v_mfma_f32_16x16x32_bf16 v[44:47], v[144:147], v[172:175], v[44:47]
    v_mov_b32 v212, v240
    v_mfma_f32_16x16x32_bf16 v[36:39], v[148:151], v[160:163], v[36:39]
    v_mov_b32 v211, v240
    v_mfma_f32_16x16x32_bf16 v[40:43], v[148:151], v[164:167], v[40:43]
    v_mov_b32 v210, v240
    v_mfma_f32_16x16x32_bf16 v[44:47], v[148:151], v[168:171], v[44:47]
    v_mov_b32 v209, v240
    s_waitcnt lgkmcnt(15)
    v_mfma_f32_16x16x32_bf16 v[40:43], v[152:155], v[160:163], v[40:43]
    v_mov_b32 v208, v240
    v_mfma_f32_16x16x32_bf16 v[44:47], v[152:155], v[164:167], v[44:47]
    v_mov_b32 v63, v240
    v_mfma_f32_16x16x32_bf16 v[44:47], v[156:159], v[160:163], v[44:47]
    v_mov_b32 v62, v240
    v_mfma_f32_16x16x32_bf16 v[16:19], v[64:67], v[96:99], v[16:19]
    v_mfma_f32_16x16x32_bf16 v[20:23], v[64:67], v[100:103], v[20:23]
    v_mfma_f32_16x16x32_bf16 v[24:27], v[64:67], v[104:107], v[24:27]
    v_mfma_f32_16x16x32_bf16 v[28:31], v[64:67], v[108:111], v[28:31]
    ds_read_b64_tr_b16 v[128:129], v2 offset:192
    v_mfma_f32_16x16x32_bf16 v[32:35], v[64:67], v[112:115], v[32:35]
    ds_read_b64_tr_b16 v[130:131], v2 offset:200
    v_mfma_f32_16x16x32_bf16 v[36:39], v[64:67], v[116:119], v[36:39]
    ds_read_b128 v[160:163], v3 offset:3776
    v_mfma_f32_16x16x32_bf16 v[40:43], v[64:67], v[120:123], v[40:43]
    ds_read_b128 v[164:167], v3 offset:3264
    s_waitcnt lgkmcnt(15)
    v_mfma_f32_16x16x32_bf16 v[44:47], v[64:67], v[124:127], v[44:47]
    ds_read_b128 v[168:171], v3 offset:2752
    v_mfma_f32_16x16x32_bf16 v[20:23], v[68:71], v[96:99], v[20:23]
    ds_read_b128 v[172:175], v3 offset:2240
    v_mfma_f32_16x16x32_bf16 v[24:27], v[68:71], v[100:103], v[24:27]
    ds_read_b128 v[176:179], v3 offset:1728
    v_mfma_f32_16x16x32_bf16 v[28:31], v[68:71], v[104:107], v[28:31]
    ds_read_b128 v[180:183], v3 offset:1216
    v_mfma_f32_16x16x32_bf16 v[32:35], v[68:71], v[108:111], v[32:35]
    ds_read_b128 v[184:187], v3 offset:704
    v_mfma_f32_16x16x32_bf16 v[36:39], v[68:71], v[112:115], v[36:39]
    ds_read_b128 v[188:191], v3 offset:192
    v_mfma_f32_16x16x32_bf16 v[40:43], v[68:71], v[116:119], v[40:43]
    ds_read_b64_tr_b16 v[132:133], v2 offset:704
    v_mfma_f32_16x16x32_bf16 v[44:47], v[68:71], v[120:123], v[44:47]
    ds_read_b64_tr_b16 v[134:135], v2 offset:712
    s_waitcnt lgkmcnt(15)
    v_mfma_f32_16x16x32_bf16 v[24:27], v[72:75], v[96:99], v[24:27]
    ds_read_b64_tr_b16 v[136:137], v2 offset:1216
    v_mfma_f32_16x16x32_bf16 v[28:31], v[72:75], v[100:103], v[28:31]
    ds_read_b64_tr_b16 v[138:139], v2 offset:1224
    v_mfma_f32_16x16x32_bf16 v[32:35], v[72:75], v[104:107], v[32:35]
    ds_read_b64_tr_b16 v[140:141], v2 offset:1728
    v_mfma_f32_16x16x32_bf16 v[36:39], v[72:75], v[108:111], v[36:39]
    ds_read_b64_tr_b16 v[142:143], v2 offset:1736
    v_mfma_f32_16x16x32_bf16 v[40:43], v[72:75], v[112:115], v[40:43]
    ds_read_b64_tr_b16 v[144:145], v2 offset:2240
    v_mfma_f32_16x16x32_bf16 v[44:47], v[72:75], v[116:119], v[44:47]
    ds_read_b64_tr_b16 v[146:147], v2 offset:2248
    v_mfma_f32_16x16x32_bf16 v[28:31], v[76:79], v[96:99], v[28:31]
    ds_read_b64_tr_b16 v[148:149], v2 offset:2752
    v_mfma_f32_16x16x32_bf16 v[32:35], v[76:79], v[100:103], v[32:35]
    ds_read_b64_tr_b16 v[150:151], v2 offset:2760
    v_mfma_f32_16x16x32_bf16 v[36:39], v[76:79], v[104:107], v[36:39]
    ds_read_b64_tr_b16 v[152:153], v2 offset:3264
    v_mfma_f32_16x16x32_bf16 v[40:43], v[76:79], v[108:111], v[40:43]
    ds_read_b64_tr_b16 v[154:155], v2 offset:3272
    v_mfma_f32_16x16x32_bf16 v[44:47], v[76:79], v[112:115], v[44:47]
    ds_read_b64_tr_b16 v[156:157], v2 offset:3776
    v_mfma_f32_16x16x32_bf16 v[32:35], v[80:83], v[96:99], v[32:35]
    ds_read_b64_tr_b16 v[158:159], v2 offset:3784
    v_mfma_f32_16x16x32_bf16 v[36:39], v[80:83], v[100:103], v[36:39]
    v_mov_b32 v61, v240
    v_mfma_f32_16x16x32_bf16 v[40:43], v[80:83], v[104:107], v[40:43]
    v_mov_b32 v60, v240
    v_mfma_f32_16x16x32_bf16 v[44:47], v[80:83], v[108:111], v[44:47]
    v_mov_b32 v59, v240
    v_mfma_f32_16x16x32_bf16 v[36:39], v[84:87], v[96:99], v[36:39]
    v_mov_b32 v58, v240
    v_mfma_f32_16x16x32_bf16 v[40:43], v[84:87], v[100:103], v[40:43]
    v_mov_b32 v57, v240
    v_mfma_f32_16x16x32_bf16 v[44:47], v[84:87], v[104:107], v[44:47]
    v_mov_b32 v56, v240
    s_waitcnt lgkmcnt(15)
    v_mfma_f32_16x16x32_bf16 v[40:43], v[88:91], v[96:99], v[40:43]
    v_mov_b32 v55, v240
    v_mfma_f32_16x16x32_bf16 v[44:47], v[88:91], v[100:103], v[44:47]
    v_mov_b32 v54, v240
    v_mfma_f32_16x16x32_bf16 v[44:47], v[92:95], v[96:99], v[44:47]
    v_mov_b32 v53, v240
    v_mfma_f32_16x16x32_bf16 v[16:19], v[128:131], v[160:163], v[16:19]
    v_mfma_f32_16x16x32_bf16 v[20:23], v[128:131], v[164:167], v[20:23]
    v_mfma_f32_16x16x32_bf16 v[24:27], v[128:131], v[168:171], v[24:27]
    v_mfma_f32_16x16x32_bf16 v[28:31], v[128:131], v[172:175], v[28:31]
    ds_read_b64_tr_b16 v[64:65], v2 offset:256
    v_mfma_f32_16x16x32_bf16 v[32:35], v[128:131], v[176:179], v[32:35]
    ds_read_b64_tr_b16 v[66:67], v2 offset:264
    v_mfma_f32_16x16x32_bf16 v[36:39], v[128:131], v[180:183], v[36:39]
    ds_read_b128 v[96:99], v3 offset:3840
    v_mfma_f32_16x16x32_bf16 v[40:43], v[128:131], v[184:187], v[40:43]
    ds_read_b128 v[100:103], v3 offset:3328
    s_waitcnt lgkmcnt(15)
    v_mfma_f32_16x16x32_bf16 v[44:47], v[128:131], v[188:191], v[44:47]
    ds_read_b128 v[104:107], v3 offset:2816
    v_mfma_f32_16x16x32_bf16 v[20:23], v[132:135], v[160:163], v[20:23]
    ds_read_b128 v[108:111], v3 offset:2304
    v_mfma_f32_16x16x32_bf16 v[24:27], v[132:135], v[164:167], v[24:27]
    ds_read_b128 v[112:115], v3 offset:1792
    v_mfma_f32_16x16x32_bf16 v[28:31], v[132:135], v[168:171], v[28:31]
    ds_read_b128 v[116:119], v3 offset:1280
    v_mfma_f32_16x16x32_bf16 v[32:35], v[132:135], v[172:175], v[32:35]
    ds_read_b128 v[120:123], v3 offset:768
    v_mfma_f32_16x16x32_bf16 v[36:39], v[132:135], v[176:179], v[36:39]
    ds_read_b128 v[124:127], v3 offset:256
    v_mfma_f32_16x16x32_bf16 v[40:43], v[132:135], v[180:183], v[40:43]
    ds_read_b64_tr_b16 v[68:69], v2 offset:768
    v_mfma_f32_16x16x32_bf16 v[44:47], v[132:135], v[184:187], v[44:47]
    ds_read_b64_tr_b16 v[70:71], v2 offset:776
    s_waitcnt lgkmcnt(15)
    v_mfma_f32_16x16x32_bf16 v[24:27], v[136:139], v[160:163], v[24:27]
    ds_read_b64_tr_b16 v[72:73], v2 offset:1280
    v_mfma_f32_16x16x32_bf16 v[28:31], v[136:139], v[164:167], v[28:31]
    ds_read_b64_tr_b16 v[74:75], v2 offset:1288
    v_mfma_f32_16x16x32_bf16 v[32:35], v[136:139], v[168:171], v[32:35]
    ds_read_b64_tr_b16 v[76:77], v2 offset:1792
    v_mfma_f32_16x16x32_bf16 v[36:39], v[136:139], v[172:175], v[36:39]
    ds_read_b64_tr_b16 v[78:79], v2 offset:1800
    v_mfma_f32_16x16x32_bf16 v[40:43], v[136:139], v[176:179], v[40:43]
    ds_read_b64_tr_b16 v[80:81], v2 offset:2304
    v_mfma_f32_16x16x32_bf16 v[44:47], v[136:139], v[180:183], v[44:47]
    ds_read_b64_tr_b16 v[82:83], v2 offset:2312
    v_mfma_f32_16x16x32_bf16 v[28:31], v[140:143], v[160:163], v[28:31]
    ds_read_b64_tr_b16 v[84:85], v2 offset:2816
    v_mfma_f32_16x16x32_bf16 v[32:35], v[140:143], v[164:167], v[32:35]
    ds_read_b64_tr_b16 v[86:87], v2 offset:2824
    v_mfma_f32_16x16x32_bf16 v[36:39], v[140:143], v[168:171], v[36:39]
    ds_read_b64_tr_b16 v[88:89], v2 offset:3328
    v_mfma_f32_16x16x32_bf16 v[40:43], v[140:143], v[172:175], v[40:43]
    ds_read_b64_tr_b16 v[90:91], v2 offset:3336
    v_mfma_f32_16x16x32_bf16 v[44:47], v[140:143], v[176:179], v[44:47]
    ds_read_b64_tr_b16 v[92:93], v2 offset:3840
    v_mfma_f32_16x16x32_bf16 v[32:35], v[144:147], v[160:163], v[32:35]
    ds_read_b64_tr_b16 v[94:95], v2 offset:3848
    v_mfma_f32_16x16x32_bf16 v[36:39], v[144:147], v[164:167], v[36:39]
    v_mov_b32 v52, v240
    v_mfma_f32_16x16x32_bf16 v[40:43], v[144:147], v[168:171], v[40:43]
    v_mov_b32 v51, v240
    v_mfma_f32_16x16x32_bf16 v[44:47], v[144:147], v[172:175], v[44:47]
    v_mov_b32 v50, v240
    v_mfma_f32_16x16x32_bf16 v[36:39], v[148:151], v[160:163], v[36:39]
    v_mov_b32 v49, v240
    v_mfma_f32_16x16x32_bf16 v[40:43], v[148:151], v[164:167], v[40:43]
    v_mov_b32 v48, v240
    v_mfma_f32_16x16x32_bf16 v[44:47], v[148:151], v[168:171], v[44:47]
    v_mov_b32 v207, 0
    s_waitcnt lgkmcnt(15)
    v_mfma_f32_16x16x32_bf16 v[40:43], v[152:155], v[160:163], v[40:43]
    v_mov_b32 v206, 0
    v_mfma_f32_16x16x32_bf16 v[44:47], v[152:155], v[164:167], v[44:47]
    v_mov_b32 v205, 0
    v_mfma_f32_16x16x32_bf16 v[44:47], v[156:159], v[160:163], v[44:47]
    v_mov_b32 v204, 0
    v_mfma_f32_16x16x32_bf16 v[16:19], v[64:67], v[96:99], v[16:19]
    v_mfma_f32_16x16x32_bf16 v[20:23], v[64:67], v[100:103], v[20:23]
    v_mfma_f32_16x16x32_bf16 v[24:27], v[64:67], v[104:107], v[24:27]
    v_mfma_f32_16x16x32_bf16 v[28:31], v[64:67], v[108:111], v[28:31]
    ds_read_b64_tr_b16 v[128:129], v2 offset:320
    v_mfma_f32_16x16x32_bf16 v[32:35], v[64:67], v[112:115], v[32:35]
    ds_read_b64_tr_b16 v[130:131], v2 offset:328
    v_mfma_f32_16x16x32_bf16 v[36:39], v[64:67], v[116:119], v[36:39]
    ds_read_b128 v[160:163], v3 offset:3904
    v_mfma_f32_16x16x32_bf16 v[40:43], v[64:67], v[120:123], v[40:43]
    ds_read_b128 v[164:167], v3 offset:3392
    s_waitcnt lgkmcnt(15)
    v_mfma_f32_16x16x32_bf16 v[44:47], v[64:67], v[124:127], v[44:47]
    ds_read_b128 v[168:171], v3 offset:2880
    v_mfma_f32_16x16x32_bf16 v[20:23], v[68:71], v[96:99], v[20:23]
    ds_read_b128 v[172:175], v3 offset:2368
    v_mfma_f32_16x16x32_bf16 v[24:27], v[68:71], v[100:103], v[24:27]
    ds_read_b128 v[176:179], v3 offset:1856
    v_mfma_f32_16x16x32_bf16 v[28:31], v[68:71], v[104:107], v[28:31]
    ds_read_b128 v[180:183], v3 offset:1344
    v_mfma_f32_16x16x32_bf16 v[32:35], v[68:71], v[108:111], v[32:35]
    ds_read_b128 v[184:187], v3 offset:832
    v_mfma_f32_16x16x32_bf16 v[36:39], v[68:71], v[112:115], v[36:39]
    ds_read_b128 v[188:191], v3 offset:320
    v_mfma_f32_16x16x32_bf16 v[40:43], v[68:71], v[116:119], v[40:43]
    ds_read_b64_tr_b16 v[132:133], v2 offset:832
    v_mfma_f32_16x16x32_bf16 v[44:47], v[68:71], v[120:123], v[44:47]
    ds_read_b64_tr_b16 v[134:135], v2 offset:840
    s_waitcnt lgkmcnt(15)
    v_mfma_f32_16x16x32_bf16 v[24:27], v[72:75], v[96:99], v[24:27]
    ds_read_b64_tr_b16 v[136:137], v2 offset:1344
    v_mfma_f32_16x16x32_bf16 v[28:31], v[72:75], v[100:103], v[28:31]
    ds_read_b64_tr_b16 v[138:139], v2 offset:1352
    v_mfma_f32_16x16x32_bf16 v[32:35], v[72:75], v[104:107], v[32:35]
    ds_read_b64_tr_b16 v[140:141], v2 offset:1856
    v_mfma_f32_16x16x32_bf16 v[36:39], v[72:75], v[108:111], v[36:39]
    ds_read_b64_tr_b16 v[142:143], v2 offset:1864
    v_mfma_f32_16x16x32_bf16 v[40:43], v[72:75], v[112:115], v[40:43]
    ds_read_b64_tr_b16 v[144:145], v2 offset:2368
    v_mfma_f32_16x16x32_bf16 v[44:47], v[72:75], v[116:119], v[44:47]
    ds_read_b64_tr_b16 v[146:147], v2 offset:2376
    v_mfma_f32_16x16x32_bf16 v[28:31], v[76:79], v[96:99], v[28:31]
    ds_read_b64_tr_b16 v[148:149], v2 offset:2880
    v_mfma_f32_16x16x32_bf16 v[32:35], v[76:79], v[100:103], v[32:35]
    ds_read_b64_tr_b16 v[150:151], v2 offset:2888
    v_mfma_f32_16x16x32_bf16 v[36:39], v[76:79], v[104:107], v[36:39]
    ds_read_b64_tr_b16 v[152:153], v2 offset:3392
    v_mfma_f32_16x16x32_bf16 v[40:43], v[76:79], v[108:111], v[40:43]
    ds_read_b64_tr_b16 v[154:155], v2 offset:3400
    v_mfma_f32_16x16x32_bf16 v[44:47], v[76:79], v[112:115], v[44:47]
    ds_read_b64_tr_b16 v[156:157], v2 offset:3904
    v_mfma_f32_16x16x32_bf16 v[32:35], v[80:83], v[96:99], v[32:35]
    ds_read_b64_tr_b16 v[158:159], v2 offset:3912
    v_mfma_f32_16x16x32_bf16 v[36:39], v[80:83], v[100:103], v[36:39]
    v_mov_b32 v203, 0
    v_mfma_f32_16x16x32_bf16 v[40:43], v[80:83], v[104:107], v[40:43]
    v_mov_b32 v202, 0
    v_mfma_f32_16x16x32_bf16 v[44:47], v[80:83], v[108:111], v[44:47]
    v_mov_b32 v201, 0
    v_mfma_f32_16x16x32_bf16 v[36:39], v[84:87], v[96:99], v[36:39]
    v_mov_b32 v200, 0
    v_mfma_f32_16x16x32_bf16 v[40:43], v[84:87], v[100:103], v[40:43]
    v_mov_b32 v199, 0
    v_mfma_f32_16x16x32_bf16 v[44:47], v[84:87], v[104:107], v[44:47]
    v_mov_b32 v198, 0
    s_waitcnt lgkmcnt(15)
    v_mfma_f32_16x16x32_bf16 v[40:43], v[88:91], v[96:99], v[40:43]
    v_mov_b32 v197, 0
    v_mfma_f32_16x16x32_bf16 v[44:47], v[88:91], v[100:103], v[44:47]
    v_mov_b32 v196, 0
    v_mfma_f32_16x16x32_bf16 v[44:47], v[92:95], v[96:99], v[44:47]
    v_mov_b32 v195, 0
    v_mfma_f32_16x16x32_bf16 v[16:19], v[128:131], v[160:163], v[16:19]
    v_mfma_f32_16x16x32_bf16 v[20:23], v[128:131], v[164:167], v[20:23]
    v_mfma_f32_16x16x32_bf16 v[24:27], v[128:131], v[168:171], v[24:27]
    v_mfma_f32_16x16x32_bf16 v[28:31], v[128:131], v[172:175], v[28:31]
    ds_read_b64_tr_b16 v[64:65], v2 offset:384
    v_mfma_f32_16x16x32_bf16 v[32:35], v[128:131], v[176:179], v[32:35]
    ds_read_b64_tr_b16 v[66:67], v2 offset:392
    v_mfma_f32_16x16x32_bf16 v[36:39], v[128:131], v[180:183], v[36:39]
    ds_read_b128 v[96:99], v3 offset:3968
    v_mfma_f32_16x16x32_bf16 v[40:43], v[128:131], v[184:187], v[40:43]
    ds_read_b128 v[100:103], v3 offset:3456
    s_waitcnt lgkmcnt(15)
    v_mfma_f32_16x16x32_bf16 v[44:47], v[128:131], v[188:191], v[44:47]
    ds_read_b128 v[104:107], v3 offset:2944
    v_mfma_f32_16x16x32_bf16 v[20:23], v[132:135], v[160:163], v[20:23]
    ds_read_b128 v[108:111], v3 offset:2432
    v_mfma_f32_16x16x32_bf16 v[24:27], v[132:135], v[164:167], v[24:27]
    ds_read_b128 v[112:115], v3 offset:1920
    v_mfma_f32_16x16x32_bf16 v[28:31], v[132:135], v[168:171], v[28:31]
    ds_read_b128 v[116:119], v3 offset:1408
    v_mfma_f32_16x16x32_bf16 v[32:35], v[132:135], v[172:175], v[32:35]
    ds_read_b128 v[120:123], v3 offset:896
    v_mfma_f32_16x16x32_bf16 v[36:39], v[132:135], v[176:179], v[36:39]
    ds_read_b128 v[124:127], v3 offset:384
    v_mfma_f32_16x16x32_bf16 v[40:43], v[132:135], v[180:183], v[40:43]
    ds_read_b64_tr_b16 v[68:69], v2 offset:896
    v_mfma_f32_16x16x32_bf16 v[44:47], v[132:135], v[184:187], v[44:47]
    ds_read_b64_tr_b16 v[70:71], v2 offset:904
    s_waitcnt lgkmcnt(15)
    v_mfma_f32_16x16x32_bf16 v[24:27], v[136:139], v[160:163], v[24:27]
    ds_read_b64_tr_b16 v[72:73], v2 offset:1408
    v_mfma_f32_16x16x32_bf16 v[28:31], v[136:139], v[164:167], v[28:31]
    ds_read_b64_tr_b16 v[74:75], v2 offset:1416
    v_mfma_f32_16x16x32_bf16 v[32:35], v[136:139], v[168:171], v[32:35]
    ds_read_b64_tr_b16 v[76:77], v2 offset:1920
    v_mfma_f32_16x16x32_bf16 v[36:39], v[136:139], v[172:175], v[36:39]
    ds_read_b64_tr_b16 v[78:79], v2 offset:1928
    v_mfma_f32_16x16x32_bf16 v[40:43], v[136:139], v[176:179], v[40:43]
    ds_read_b64_tr_b16 v[80:81], v2 offset:2432
    v_mfma_f32_16x16x32_bf16 v[44:47], v[136:139], v[180:183], v[44:47]
    ds_read_b64_tr_b16 v[82:83], v2 offset:2440
    v_mfma_f32_16x16x32_bf16 v[28:31], v[140:143], v[160:163], v[28:31]
    ds_read_b64_tr_b16 v[84:85], v2 offset:2944
    v_mfma_f32_16x16x32_bf16 v[32:35], v[140:143], v[164:167], v[32:35]
    ds_read_b64_tr_b16 v[86:87], v2 offset:2952
    v_mfma_f32_16x16x32_bf16 v[36:39], v[140:143], v[168:171], v[36:39]
    ds_read_b64_tr_b16 v[88:89], v2 offset:3456
    v_mfma_f32_16x16x32_bf16 v[40:43], v[140:143], v[172:175], v[40:43]
    ds_read_b64_tr_b16 v[90:91], v2 offset:3464
    v_mfma_f32_16x16x32_bf16 v[44:47], v[140:143], v[176:179], v[44:47]
    ds_read_b64_tr_b16 v[92:93], v2 offset:3968
    v_mfma_f32_16x16x32_bf16 v[32:35], v[144:147], v[160:163], v[32:35]
    ds_read_b64_tr_b16 v[94:95], v2 offset:3976
    v_mfma_f32_16x16x32_bf16 v[36:39], v[144:147], v[164:167], v[36:39]
    v_mov_b32 v194, 0
    v_mfma_f32_16x16x32_bf16 v[40:43], v[144:147], v[168:171], v[40:43]
    v_mov_b32 v193, 0
    v_mfma_f32_16x16x32_bf16 v[44:47], v[144:147], v[172:175], v[44:47]
    v_mov_b32 v192, 0
    v_mfma_f32_16x16x32_bf16 v[36:39], v[148:151], v[160:163], v[36:39]
    v_mfma_f32_16x16x32_bf16 v[40:43], v[148:151], v[164:167], v[40:43]
    v_mfma_f32_16x16x32_bf16 v[44:47], v[148:151], v[168:171], v[44:47]
    s_waitcnt lgkmcnt(15)
    v_mfma_f32_16x16x32_bf16 v[40:43], v[152:155], v[160:163], v[40:43]
    v_mfma_f32_16x16x32_bf16 v[44:47], v[152:155], v[164:167], v[44:47]
    v_mfma_f32_16x16x32_bf16 v[44:47], v[156:159], v[160:163], v[44:47]
    v_mfma_f32_16x16x32_bf16 v[16:19], v[64:67], v[96:99], v[16:19]
    v_mfma_f32_16x16x32_bf16 v[20:23], v[64:67], v[100:103], v[20:23]
    v_mfma_f32_16x16x32_bf16 v[24:27], v[64:67], v[104:107], v[24:27]
    v_mfma_f32_16x16x32_bf16 v[28:31], v[64:67], v[108:111], v[28:31]
    ds_read_b64_tr_b16 v[128:129], v2 offset:448
    v_mfma_f32_16x16x32_bf16 v[32:35], v[64:67], v[112:115], v[32:35]
    ds_read_b64_tr_b16 v[130:131], v2 offset:456
    v_mfma_f32_16x16x32_bf16 v[36:39], v[64:67], v[116:119], v[36:39]
    ds_read_b128 v[160:163], v3 offset:4032
    v_mfma_f32_16x16x32_bf16 v[40:43], v[64:67], v[120:123], v[40:43]
    ds_read_b128 v[164:167], v3 offset:3520
    s_waitcnt lgkmcnt(15)
    v_mfma_f32_16x16x32_bf16 v[44:47], v[64:67], v[124:127], v[44:47]
    ds_read_b128 v[168:171], v3 offset:3008
    v_mfma_f32_16x16x32_bf16 v[20:23], v[68:71], v[96:99], v[20:23]
    ds_read_b128 v[172:175], v3 offset:2496
    v_mfma_f32_16x16x32_bf16 v[24:27], v[68:71], v[100:103], v[24:27]
    ds_read_b128 v[176:179], v3 offset:1984
    v_mfma_f32_16x16x32_bf16 v[28:31], v[68:71], v[104:107], v[28:31]
    ds_read_b128 v[180:183], v3 offset:1472
    v_mfma_f32_16x16x32_bf16 v[32:35], v[68:71], v[108:111], v[32:35]
    ds_read_b128 v[184:187], v3 offset:960
    v_mfma_f32_16x16x32_bf16 v[36:39], v[68:71], v[112:115], v[36:39]
    ds_read_b128 v[188:191], v3 offset:448
    v_mfma_f32_16x16x32_bf16 v[40:43], v[68:71], v[116:119], v[40:43]
    ds_read_b64_tr_b16 v[132:133], v2 offset:960
    v_mfma_f32_16x16x32_bf16 v[44:47], v[68:71], v[120:123], v[44:47]
    ds_read_b64_tr_b16 v[134:135], v2 offset:968
    s_waitcnt lgkmcnt(15)
    v_mfma_f32_16x16x32_bf16 v[24:27], v[72:75], v[96:99], v[24:27]
    ds_read_b64_tr_b16 v[136:137], v2 offset:1472
    v_mfma_f32_16x16x32_bf16 v[28:31], v[72:75], v[100:103], v[28:31]
    ds_read_b64_tr_b16 v[138:139], v2 offset:1480
    v_mfma_f32_16x16x32_bf16 v[32:35], v[72:75], v[104:107], v[32:35]
    ds_read_b64_tr_b16 v[140:141], v2 offset:1984
    v_mfma_f32_16x16x32_bf16 v[36:39], v[72:75], v[108:111], v[36:39]
    ds_read_b64_tr_b16 v[142:143], v2 offset:1992
    v_mfma_f32_16x16x32_bf16 v[40:43], v[72:75], v[112:115], v[40:43]
    ds_read_b64_tr_b16 v[144:145], v2 offset:2496
    v_mfma_f32_16x16x32_bf16 v[44:47], v[72:75], v[116:119], v[44:47]
    ds_read_b64_tr_b16 v[146:147], v2 offset:2504
    v_mfma_f32_16x16x32_bf16 v[28:31], v[76:79], v[96:99], v[28:31]
    ds_read_b64_tr_b16 v[148:149], v2 offset:3008
    v_mfma_f32_16x16x32_bf16 v[32:35], v[76:79], v[100:103], v[32:35]
    ds_read_b64_tr_b16 v[150:151], v2 offset:3016
    v_mfma_f32_16x16x32_bf16 v[36:39], v[76:79], v[104:107], v[36:39]
    ds_read_b64_tr_b16 v[152:153], v2 offset:3520
    v_mfma_f32_16x16x32_bf16 v[40:43], v[76:79], v[108:111], v[40:43]
    ds_read_b64_tr_b16 v[154:155], v2 offset:3528
    v_mfma_f32_16x16x32_bf16 v[44:47], v[76:79], v[112:115], v[44:47]
    ds_read_b64_tr_b16 v[156:157], v2 offset:4032
    v_mfma_f32_16x16x32_bf16 v[32:35], v[80:83], v[96:99], v[32:35]
    ds_read_b64_tr_b16 v[158:159], v2 offset:4040
    v_mfma_f32_16x16x32_bf16 v[36:39], v[80:83], v[100:103], v[36:39]
    v_mfma_f32_16x16x32_bf16 v[40:43], v[80:83], v[104:107], v[40:43]
    v_mfma_f32_16x16x32_bf16 v[44:47], v[80:83], v[108:111], v[44:47]
    v_mfma_f32_16x16x32_bf16 v[36:39], v[84:87], v[96:99], v[36:39]
    v_mfma_f32_16x16x32_bf16 v[40:43], v[84:87], v[100:103], v[40:43]
    v_mfma_f32_16x16x32_bf16 v[44:47], v[84:87], v[104:107], v[44:47]
    s_waitcnt lgkmcnt(15)
    v_mfma_f32_16x16x32_bf16 v[40:43], v[88:91], v[96:99], v[40:43]
    v_mfma_f32_16x16x32_bf16 v[44:47], v[88:91], v[100:103], v[44:47]
    v_mfma_f32_16x16x32_bf16 v[44:47], v[92:95], v[96:99], v[44:47]
    v_mfma_f32_16x16x32_bf16 v[16:19], v[128:131], v[160:163], v[16:19]
    ds_read_b64 v[64:65], v4 offset:3584
    ds_read_b64 v[66:67], v4 offset:3072
    v_mfma_f32_16x16x32_bf16 v[20:23], v[128:131], v[164:167], v[20:23]
    ds_read_b64 v[68:69], v4 offset:2560
    ds_read_b64 v[70:71], v4 offset:2048
    v_mfma_f32_16x16x32_bf16 v[24:27], v[128:131], v[168:171], v[24:27]
    ds_read_b64 v[72:73], v4 offset:1536
    ds_read_b64 v[74:75], v4 offset:1024
    v_mfma_f32_16x16x32_bf16 v[28:31], v[128:131], v[172:175], v[28:31]
    ds_read_b64 v[76:77], v4 offset:512
    ds_read_b64 v[78:79], v4 offset:0
    v_mfma_f32_16x16x32_bf16 v[32:35], v[128:131], v[176:179], v[32:35]
    s_waitcnt lgkmcnt(7)
    v_and_b32 v80, 0xffff0000, v65
    v_lshlrev_b32 v81, 16, v65
    v_mfma_f32_16x16x32_bf16 v[36:39], v[128:131], v[180:183], v[36:39]
    v_and_b32 v82, 0xffff0000, v64
    v_lshlrev_b32 v83, 16, v64
    v_mfma_f32_16x16x32_bf16 v[40:43], v[128:131], v[184:187], v[40:43]
    v_fma_f32 v80, v7, v80, v16
    v_fma_f32 v81, v7, v81, v17
    v_mfma_f32_16x16x32_bf16 v[44:47], v[128:131], v[188:191], v[44:47]
    v_fma_f32 v82, v7, v82, v18
    v_fma_f32 v83, v7, v83, v19
    v_mfma_f32_16x16x32_bf16 v[20:23], v[132:135], v[160:163], v[20:23]
    v_cvt_pk_bf16_f32 v80, v80, v81
    v_cvt_pk_bf16_f32 v81, v82, v83
    v_mfma_f32_16x16x32_bf16 v[24:27], v[132:135], v[164:167], v[24:27]
    buffer_store_dwordx2 v[80:81], v5, s[28:31], 0 offen offset:0 sc1
    s_waitcnt lgkmcnt(6)
    v_and_b32 v84, 0xffff0000, v67
    v_mfma_f32_16x16x32_bf16 v[28:31], v[132:135], v[168:171], v[28:31]
    v_lshlrev_b32 v85, 16, v67
    v_and_b32 v86, 0xffff0000, v66
    v_mfma_f32_16x16x32_bf16 v[32:35], v[132:135], v[172:175], v[32:35]
    v_lshlrev_b32 v87, 16, v66
    v_fma_f32 v84, v7, v84, v20
    v_mfma_f32_16x16x32_bf16 v[36:39], v[132:135], v[176:179], v[36:39]
    v_fma_f32 v85, v7, v85, v21
    v_fma_f32 v86, v7, v86, v22
    v_mfma_f32_16x16x32_bf16 v[40:43], v[132:135], v[180:183], v[40:43]
    v_fma_f32 v87, v7, v87, v23
    v_cvt_pk_bf16_f32 v84, v84, v85
    v_mfma_f32_16x16x32_bf16 v[44:47], v[132:135], v[184:187], v[44:47]
    v_cvt_pk_bf16_f32 v85, v86, v87
    buffer_store_dwordx2 v[84:85], v5, s[28:31], 0 offen offset:512 sc1
    v_mfma_f32_16x16x32_bf16 v[24:27], v[136:139], v[160:163], v[24:27]
    s_waitcnt lgkmcnt(5)
    v_and_b32 v88, 0xffff0000, v69
    v_lshlrev_b32 v89, 16, v69
    v_mfma_f32_16x16x32_bf16 v[28:31], v[136:139], v[164:167], v[28:31]
    v_and_b32 v90, 0xffff0000, v68
    v_lshlrev_b32 v91, 16, v68
    v_mfma_f32_16x16x32_bf16 v[32:35], v[136:139], v[168:171], v[32:35]
    v_mfma_f32_16x16x32_bf16 v[36:39], v[136:139], v[172:175], v[36:39]
    v_mfma_f32_16x16x32_bf16 v[40:43], v[136:139], v[176:179], v[40:43]
    v_fma_f32 v88, v7, v88, v24
    v_fma_f32 v89, v7, v89, v25
    v_mfma_f32_16x16x32_bf16 v[44:47], v[136:139], v[180:183], v[44:47]
    v_fma_f32 v90, v7, v90, v26
    v_fma_f32 v91, v7, v91, v27
    v_mfma_f32_16x16x32_bf16 v[28:31], v[140:143], v[160:163], v[28:31]
    v_cvt_pk_bf16_f32 v88, v88, v89
    v_cvt_pk_bf16_f32 v89, v90, v91
    v_mfma_f32_16x16x32_bf16 v[32:35], v[140:143], v[164:167], v[32:35]
    buffer_store_dwordx2 v[88:89], v5, s[28:31], 0 offen offset:1024 sc1
    s_waitcnt lgkmcnt(4)
    v_and_b32 v92, 0xffff0000, v71
    v_mfma_f32_16x16x32_bf16 v[36:39], v[140:143], v[168:171], v[36:39]
    v_lshlrev_b32 v93, 16, v71
    v_and_b32 v94, 0xffff0000, v70
    v_mfma_f32_16x16x32_bf16 v[40:43], v[140:143], v[172:175], v[40:43]
    v_lshlrev_b32 v95, 16, v70
    v_fma_f32 v92, v7, v92, v28
    v_mfma_f32_16x16x32_bf16 v[44:47], v[140:143], v[176:179], v[44:47]
    v_fma_f32 v93, v7, v93, v29
    v_fma_f32 v94, v7, v94, v30
    v_mfma_f32_16x16x32_bf16 v[32:35], v[144:147], v[160:163], v[32:35]
    v_fma_f32 v95, v7, v95, v31
    v_cvt_pk_bf16_f32 v92, v92, v93
    v_mfma_f32_16x16x32_bf16 v[36:39], v[144:147], v[164:167], v[36:39]
    v_cvt_pk_bf16_f32 v93, v94, v95
    buffer_store_dwordx2 v[92:93], v5, s[28:31], 0 offen offset:1536 sc1
    v_mfma_f32_16x16x32_bf16 v[40:43], v[144:147], v[168:171], v[40:43]
    s_waitcnt lgkmcnt(3)
    v_and_b32 v96, 0xffff0000, v73
    v_lshlrev_b32 v97, 16, v73
    v_mfma_f32_16x16x32_bf16 v[44:47], v[144:147], v[172:175], v[44:47]
    v_and_b32 v98, 0xffff0000, v72
    v_lshlrev_b32 v99, 16, v72
    v_mfma_f32_16x16x32_bf16 v[36:39], v[148:151], v[160:163], v[36:39]
    v_fma_f32 v96, v7, v96, v32
    v_fma_f32 v97, v7, v97, v33
    v_mfma_f32_16x16x32_bf16 v[40:43], v[148:151], v[164:167], v[40:43]
    v_fma_f32 v98, v7, v98, v34
    v_fma_f32 v99, v7, v99, v35
    v_mfma_f32_16x16x32_bf16 v[44:47], v[148:151], v[168:171], v[44:47]
    v_cvt_pk_bf16_f32 v96, v96, v97
    v_cvt_pk_bf16_f32 v97, v98, v99
    v_mfma_f32_16x16x32_bf16 v[40:43], v[152:155], v[160:163], v[40:43]
    buffer_store_dwordx2 v[96:97], v5, s[28:31], 0 offen offset:2048 sc1
    s_waitcnt lgkmcnt(2)
    v_and_b32 v100, 0xffff0000, v75
    v_mfma_f32_16x16x32_bf16 v[44:47], v[152:155], v[164:167], v[44:47]
    v_lshlrev_b32 v101, 16, v75
    v_and_b32 v102, 0xffff0000, v74
    v_mfma_f32_16x16x32_bf16 v[44:47], v[156:159], v[160:163], v[44:47]
    v_lshlrev_b32 v103, 16, v74
    v_fma_f32 v100, v7, v100, v36
    v_fma_f32 v101, v7, v101, v37
    v_fma_f32 v102, v7, v102, v38
    v_fma_f32 v103, v7, v103, v39
    v_cvt_pk_bf16_f32 v100, v100, v101
    v_cvt_pk_bf16_f32 v101, v102, v103
    buffer_store_dwordx2 v[100:101], v5, s[28:31], 0 offen offset:2560 sc1
    s_waitcnt lgkmcnt(1)
    v_and_b32 v104, 0xffff0000, v77
    v_lshlrev_b32 v105, 16, v77
    v_and_b32 v106, 0xffff0000, v76
    v_lshlrev_b32 v107, 16, v76
    v_fma_f32 v104, v7, v104, v40
    v_fma_f32 v105, v7, v105, v41
    v_fma_f32 v106, v7, v106, v42
    v_fma_f32 v107, v7, v107, v43
    v_cvt_pk_bf16_f32 v104, v104, v105
    v_cvt_pk_bf16_f32 v105, v106, v107
    buffer_store_dwordx2 v[104:105], v5, s[28:31], 0 offen offset:3072 sc1
    s_waitcnt lgkmcnt(0)
    v_and_b32 v108, 0xffff0000, v79
    v_lshlrev_b32 v109, 16, v79
    v_and_b32 v110, 0xffff0000, v78
    v_lshlrev_b32 v111, 16, v78
    v_fma_f32 v108, v7, v108, v44
    v_fma_f32 v109, v7, v109, v45
    v_fma_f32 v110, v7, v110, v46
    v_fma_f32 v111, v7, v111, v47
    v_cvt_pk_bf16_f32 v108, v108, v109
    v_cvt_pk_bf16_f32 v109, v110, v111
    buffer_store_dwordx2 v[108:109], v5, s[28:31], 0 offen offset:3584 sc1
L_ATT:
    v_mov_b32 v14, 162048
    s_mov_b32 s62, 0
SIG_3:
    ds_read_b32 v15, v14 offset:4
    s_waitcnt lgkmcnt(0)
    v_readfirstlane_b32 s64, v15
    s_add_u32 s62, s62, 1
    s_cmp_ge_u32 s64, 1
    s_cbranch_scc1 SIGD_4
    s_sleep 1
    s_cmp_lt_u32 s62, 8000000
    s_cbranch_scc1 SIG_3
SIGD_4:
    ds_read_b64 v[132:133], v243 offset:2048
    ds_read_b64 v[38:39], v226 offset:0
    ds_read_b128 v[128:131], v242
    ds_read_b128 v[40:43], v225 offset:0
    ds_read_b128 v[44:47], v225 offset:1024
    ds_read_b64 v[36:37], v230 offset:2048
    ds_read_b128 v[32:35], v229
    s_mov_b64 exec, s[74:75]
    ds_read_b128 v[48:51], v227 offset:0
    ds_read_b128 v[52:55], v227 offset:640
    ds_read_b128 v[56:59], v227 offset:1280
    ds_read_b128 v[60:63], v227 offset:1920
    s_mov_b64 exec, -1
    s_waitcnt lgkmcnt(9)
    v_mfma_f32_32x32x4_2b_bf16 v[64:95], v[38:39], v[132:133], 0
    s_add_u32 m0, s88, 40960
    s_add_u32 s69, s97, 40960
    buffer_load_dwordx4 v228, s[28:31], s69 offen offset:0 sc1 lds
    buffer_load_dwordx4 v228, s[28:31], s69 offen offset:1024 sc1 lds
    buffer_load_dwordx4 v228, s[28:31], s69 offen offset:2048 sc1 lds
    buffer_load_dwordx4 v228, s[28:31], s69 offen offset:3072 sc1 lds
    v_mov_b32 v144, 0
    v_mov_b32 v145, 0
    v_mov_b32 v146, 0
    v_mov_b32 v147, 0
    v_mov_b32 v148, 0
    v_mov_b32 v149, 0
    v_mov_b32 v150, 0
    v_mov_b32 v151, 0
    v_mov_b32 v152, 0
    v_mov_b32 v153, 0
    v_mov_b32 v154, 0
    v_mov_b32 v155, 0
    v_mov_b32 v156, 0
    v_mov_b32 v157, 0
    v_mov_b32 v158, 0
    v_mov_b32 v159, 0
    s_waitcnt lgkmcnt(7)
    v_mfma_f32_32x32x16_bf16 v[64:79], v[40:43], v[128:131], v[64:79]
    s_waitcnt lgkmcnt(6)
    v_mfma_f32_32x32x16_bf16 v[80:95], v[44:47], v[128:131], v[80:95]
    s_add_u32 m0, m0, 4096
    s_add_u32 s69, s69, 4096
    buffer_load_dwordx4 v228, s[28:31], s69 offen offset:0 sc1 lds
    ds_read_b32 v15, v14 offset:4
    s_waitcnt lgkmcnt(0)
    v_readfirstlane_b32 s64, v15
    s_nop 0
    s_cmp_ge_u32 s64, 2
    s_cbranch_scc1 SOK_5
    v_mov_b32 v14, 162048
    s_mov_b32 s62, 0
SIG_6:
    ds_read_b32 v15, v14 offset:4
    s_waitcnt lgkmcnt(0)
    v_readfirstlane_b32 s64, v15
    s_add_u32 s62, s62, 1
    s_cmp_ge_u32 s64, 2
    s_cbranch_scc1 SIGD_7
    s_sleep 1
    s_cmp_lt_u32 s62, 8000000
    s_cbranch_scc1 SIG_6
SIGD_7:
SOK_5:
    s_nop 1
    s_setprio 2
    v_exp_f32 v64, v64
    v_exp_f32 v65, v65
    s_mov_b64 exec, s[74:75]
    ds_read_b128 v[208:211], v227 offset:10240
    ds_read_b128 v[212:215], v227 offset:10880
    ds_read_b128 v[216:219], v227 offset:11520
    ds_read_b128 v[220:223], v227 offset:12160
    s_mov_b64 exec, -1
    v_exp_f32 v66, v66
    v_exp_f32 v67, v67
    v_exp_f32 v68, v68
    v_exp_f32 v69, v69
    v_mfma_f32_32x32x4_2b_bf16 v[96:127], v[38:39], v[36:37], 0
    ds_read_b64 v[38:39], v226 offset:10240
    v_exp_f32 v70, v70
    v_exp_f32 v71, v71
    v_exp_f32 v72, v72
    v_exp_f32 v73, v73
    v_exp_f32 v74, v74
    v_exp_f32 v75, v75
    v_exp_f32 v76, v76
    v_exp_f32 v77, v77
    v_smfmac_f32_32x32x32_bf16 v[144:159], v[48:51], v[64:71], v224
    v_exp_f32 v78, v78
    v_exp_f32 v79, v79
    v_exp_f32 v80, v80
    v_exp_f32 v81, v81
    v_smfmac_f32_32x32x32_bf16 v[144:159], v[52:55], v[72:79], v224
    v_exp_f32 v82, v82
    v_exp_f32 v83, v83
    v_exp_f32 v84, v84
    v_exp_f32 v85, v85
    v_mfma_f32_32x32x16_bf16 v[96:111], v[40:43], v[32:35], v[96:111]
    ds_read_b128 v[40:43], v225 offset:10240
    v_exp_f32 v86, v86
    v_exp_f32 v87, v87
    v_exp_f32 v88, v88
    v_exp_f32 v89, v89
    v_smfmac_f32_32x32x32_bf16 v[144:159], v[56:59], v[80:87], v224
    v_exp_f32 v90, v90
    v_exp_f32 v91, v91
    v_exp_f32 v92, v92
    v_exp_f32 v93, v93
    v_mfma_f32_32x32x16_bf16 v[112:127], v[44:47], v[32:35], v[112:127]
    ds_read_b128 v[44:47], v225 offset:11264
    v_exp_f32 v94, v94
    v_exp_f32 v95, v95
    s_cmp_lg_u32 s3, 3
    s_cbranch_scc1 N3_8
    v_mov_b32 v15, 3
    s_waitcnt vmcnt(5)
    ds_write_b32 v14, v15 offset:4
N3_8:
    v_exp_f32 v96, v96
    v_exp_f32 v97, v97
    s_waitcnt lgkmcnt(2)
    v_smfmac_f32_32x32x32_bf16 v[144:159], v[60:63], v[88:95], v224
    v_exp_f32 v98, v98
    v_exp_f32 v99, v99
    v_exp_f32 v100, v100
    v_exp_f32 v101, v101
    v_mfma_f32_32x32x4_2b_bf16 v[64:95], v[38:39], v[132:133], 0
    v_exp_f32 v102, v102
    v_exp_f32 v103, v103
    v_exp_f32 v104, v104
    v_exp_f32 v105, v105
    v_exp_f32 v106, v106
    v_exp_f32 v107, v107
    v_exp_f32 v108, v108
    v_exp_f32 v109, v109
    v_smfmac_f32_32x32x32_bf16 v[192:207], v[48:51], v[96:103], v224
    v_exp_f32 v110, v110
    v_exp_f32 v111, v111
    v_exp_f32 v112, v112
    v_exp_f32 v113, v113
    v_smfmac_f32_32x32x32_bf16 v[192:207], v[52:55], v[104:111], v224
    v_exp_f32 v114, v114
    v_exp_f32 v115, v115
    v_exp_f32 v116, v116
    v_exp_f32 v117, v117
    s_waitcnt lgkmcnt(0)
    v_mfma_f32_32x32x16_bf16 v[64:79], v[40:43], v[128:131], v[64:79]
    v_exp_f32 v118, v118
    v_exp_f32 v119, v119
    ds_read_b32 v15, v14 offset:4
    v_exp_f32 v120, v120
    v_exp_f32 v121, v121
    v_smfmac_f32_32x32x32_bf16 v[192:207], v[56:59], v[112:119], v224
    v_exp_f32 v122, v122
    v_exp_f32 v123, v123
    v_exp_f32 v124, v124
    v_exp_f32 v125, v125
    v_mfma_f32_32x32x16_bf16 v[80:95], v[44:47], v[128:131], v[80:95]
    v_exp_f32 v126, v126
    v_exp_f32 v127, v127
    s_waitcnt lgkmcnt(0)
    v_readfirstlane_b32 s64, v15
    s_nop 0
    s_cmp_ge_u32 s64, 3
    s_cbranch_scc1 SOK_9
    v_mov_b32 v14, 162048
    s_mov_b32 s62, 0
SIG_10:
    ds_read_b32 v15, v14 offset:4
    s_waitcnt lgkmcnt(0)
    v_readfirstlane_b32 s64, v15
    s_add_u32 s62, s62, 1
    s_cmp_ge_u32 s64, 3
    s_cbranch_scc1 SIGD_11
    s_sleep 1
    s_cmp_lt_u32 s62, 8000000
    s_cbranch_scc1 SIG_10
SIGD_11:
SOK_9:
    s_setprio 1
    v_exp_f32 v64, v64
    v_exp_f32 v65, v65
    v_smfmac_f32_32x32x32_bf16 v[192:207], v[60:63], v[120:127], v224
    s_mov_b64 exec, s[74:75]
    ds_read_b128 v[48:51], v227 offset:20480
    ds_read_b128 v[52:55], v227 offset:21120
    ds_read_b128 v[56:59], v227 offset:21760
    ds_read_b128 v[60:63], v227 offset:22400
    s_mov_b64 exec, -1
    v_exp_f32 v66, v66
    v_exp_f32 v67, v67
    v_exp_f32 v68, v68
    v_exp_f32 v69, v69
    v_mfma_f32_32x32x4_2b_bf16 v[96:127], v[38:39], v[36:37], 0
    ds_read_b64 v[38:39], v226 offset:20480
    v_exp_f32 v70, v70
    v_exp_f32 v71, v71
    v_exp_f32 v72, v72
    v_exp_f32 v73, v73
    v_exp_f32 v74, v74
    v_exp_f32 v75, v75
    v_exp_f32 v76, v76
    v_exp_f32 v77, v77
    v_smfmac_f32_32x32x32_bf16 v[144:159], v[208:211], v[64:71], v224
    v_exp_f32 v78, v78
    v_exp_f32 v79, v79
    v_exp_f32 v80, v80
    v_exp_f32 v81, v81
    v_smfmac_f32_32x32x32_bf16 v[144:159], v[212:215], v[72:79], v224
    v_exp_f32 v82, v82
    v_exp_f32 v83, v83
    v_exp_f32 v84, v84
    v_exp_f32 v85, v85
    v_mfma_f32_32x32x16_bf16 v[96:111], v[40:43], v[32:35], v[96:111]
    ds_read_b128 v[40:43], v225 offset:20480
    v_exp_f32 v86, v86
    v_exp_f32 v87, v87
    v_exp_f32 v88, v88
    v_exp_f32 v89, v89
    v_smfmac_f32_32x32x32_bf16 v[144:159], v[216:219], v[80:87], v224
    v_exp_f32 v90, v90
    v_exp_f32 v91, v91
    v_exp_f32 v92, v92
    v_exp_f32 v93, v93
    v_mfma_f32_32x32x16_bf16 v[112:127], v[44:47], v[32:35], v[112:127]
    ds_read_b128 v[44:47], v225 offset:21504
    v_exp_f32 v94, v94
    v_exp_f32 v95, v95
    v_exp_f32 v96, v96
    v_exp_f32 v97, v97
    s_waitcnt lgkmcnt(2)
    v_smfmac_f32_32x32x32_bf16 v[144:159], v[220:223], v[88:95], v224
    v_exp_f32 v98, v98
    v_exp_f32 v99, v99
    v_exp_f32 v100, v100
    v_exp_f32 v101, v101
    v_mfma_f32_32x32x4_2b_bf16 v[64:95], v[38:39], v[132:133], 0
    v_exp_f32 v102, v102
    v_exp_f32 v103, v103
    v_exp_f32 v104, v104
    v_exp_f32 v105, v105
    v_exp_f32 v106, v106
    v_exp_f32 v107, v107
    v_exp_f32 v108, v108
    v_exp_f32 v109, v109
    v_smfmac_f32_32x32x32_bf16 v[192:207], v[208:211], v[96:103], v224
    v_exp_f32 v110, v110
    v_exp_f32 v111, v111
    v_exp_f32 v112, v112
    v_exp_f32 v113, v113
    v_smfmac_f32_32x32x32_bf16 v[192:207], v[212:215], v[104:111], v224
    v_exp_f32 v114, v114
    v_exp_f32 v115, v115
    v_exp_f32 v116, v116
    v_exp_f32 v117, v117
    s_waitcnt lgkmcnt(0)
    v_mfma_f32_32x32x16_bf16 v[64:79], v[40:43], v[128:131], v[64:79]
    v_exp_f32 v118, v118
    v_exp_f32 v119, v119
    v_exp_f32 v120, v120
    v_exp_f32 v121, v121
    v_smfmac_f32_32x32x32_bf16 v[192:207], v[216:219], v[112:119], v224
    v_exp_f32 v122, v122
    v_exp_f32 v123, v123
    v_exp_f32 v124, v124
    v_exp_f32 v125, v125
    v_mfma_f32_32x32x16_bf16 v[80:95], v[44:47], v[128:131], v[80:95]
    v_exp_f32 v126, v126
    v_exp_f32 v127, v127
    s_setprio 0
    v_exp_f32 v64, v64
    v_exp_f32 v65, v65
    v_smfmac_f32_32x32x32_bf16 v[192:207], v[220:223], v[120:127], v224
    s_mov_b64 exec, s[74:75]
    ds_read_b128 v[208:211], v227 offset:30720
    ds_read_b128 v[212:215], v227 offset:31360
    ds_read_b128 v[216:219], v227 offset:32000
    ds_read_b128 v[220:223], v227 offset:32640
    s_mov_b64 exec, -1
    v_exp_f32 v66, v66
    v_exp_f32 v67, v67
    v_exp_f32 v68, v68
    v_exp_f32 v69, v69
    v_mfma_f32_32x32x4_2b_bf16 v[96:127], v[38:39], v[36:37], 0
    ds_read_b64 v[38:39], v226 offset:30720
    v_exp_f32 v70, v70
    v_exp_f32 v71, v71
    v_exp_f32 v72, v72
    v_exp_f32 v73, v73
    v_exp_f32 v74, v74
    v_exp_f32 v75, v75
    v_exp_f32 v76, v76
    v_exp_f32 v77, v77
    v_smfmac_f32_32x32x32_bf16 v[144:159], v[48:51], v[64:71], v224
    v_exp_f32 v78, v78
    v_exp_f32 v79, v79
    v_exp_f32 v80, v80
    v_exp_f32 v81, v81
    v_smfmac_f32_32x32x32_bf16 v[144:159], v[52:55], v[72:79], v224
    v_exp_f32 v82, v82
    v_exp_f32 v83, v83
    v_exp_f32 v84, v84
    v_exp_f32 v85, v85
    v_mfma_f32_32x32x16_bf16 v[96:111], v[40:43], v[32:35], v[96:111]
    ds_read_b128 v[40:43], v225 offset:30720
    v_exp_f32 v86, v86
    v_exp_f32 v87, v87
    v_exp_f32 v88, v88
    v_exp_f32 v89, v89
    v_smfmac_f32_32x32x32_bf16 v[144:159], v[56:59], v[80:87], v224
    v_exp_f32 v90, v90
    v_exp_f32 v91, v91
    v_exp_f32 v92, v92
    v_exp_f32 v93, v93
    v_mfma_f32_32x32x16_bf16 v[112:127], v[44:47], v[32:35], v[112:127]
    ds_read_b128 v[44:47], v225 offset:31744
    v_exp_f32 v94, v94
    v_exp_f32 v95, v95
    v_exp_f32 v96, v96
    v_exp_f32 v97, v97
    s_waitcnt lgkmcnt(2)
    v_smfmac_f32_32x32x32_bf16 v[144:159], v[60:63], v[88:95], v224
    v_exp_f32 v98, v98
    v_exp_f32 v99, v99
    v_exp_f32 v100, v100
    v_exp_f32 v101, v101
    v_mfma_f32_32x32x4_2b_bf16 v[64:95], v[38:39], v[132:133], 0
    v_exp_f32 v102, v102
    v_exp_f32 v103, v103
    v_exp_f32 v104, v104
    v_exp_f32 v105, v105
    v_exp_f32 v106, v106
    v_exp_f32 v107, v107
    v_exp_f32 v108, v108
    v_exp_f32 v109, v109
    v_smfmac_f32_32x32x32_bf16 v[192:207], v[48:51], v[96:103], v224
    v_exp_f32 v110, v110
    v_exp_f32 v111, v111
    v_exp_f32 v112, v112
    v_exp_f32 v113, v113
    v_smfmac_f32_32x32x32_bf16 v[192:207], v[52:55], v[104:111], v224
    v_exp_f32 v114, v114
    v_exp_f32 v115, v115
    v_exp_f32 v116, v116
    v_exp_f32 v117, v117
    s_waitcnt lgkmcnt(0)
    v_mfma_f32_32x32x16_bf16 v[64:79], v[40:43], v[128:131], v[64:79]
    v_exp_f32 v118, v118
    v_exp_f32 v119, v119
    v_exp_f32 v120, v120
    v_exp_f32 v121, v121
    v_smfmac_f32_32x32x32_bf16 v[192:207], v[56:59], v[112:119], v224
    v_exp_f32 v122, v122
    v_exp_f32 v123, v123
    v_exp_f32 v124, v124
    v_exp_f32 v125, v125
    v_mfma_f32_32x32x16_bf16 v[80:95], v[44:47], v[128:131], v[80:95]
    v_exp_f32 v126, v126
    v_exp_f32 v127, v127
    s_waitcnt vmcnt(0)
    s_cmp_ge_u32 s58, s55
    s_cbranch_scc1 NOF3_12
    s_lshl_b32 s64, s59, 2
    s_add_u32 s64, s64, 0xf0c000
    v_lshl_add_u32 v14, v0, 2, s64
    v_mov_b32 v15, 1
    s_mov_b64 exec, 1
    buffer_store_dword v15, v14, s[28:31], 0 offen sc1
    s_mov_b64 exec, -1
NOF3_12:
    s_barrier
    s_setprio 3
    v_exp_f32 v64, v64
    v_exp_f32 v65, v65
    v_smfmac_f32_32x32x32_bf16 v[192:207], v[60:63], v[120:127], v224
    s_mov_b64 exec, s[74:75]
    ds_read_b128 v[48:51], v227 offset:40960
    ds_read_b128 v[52:55], v227 offset:41600
    ds_read_b128 v[56:59], v227 offset:42240
    ds_read_b128 v[60:63], v227 offset:42880
    s_mov_b64 exec, -1
    v_exp_f32 v66, v66
    v_exp_f32 v67, v67
    v_exp_f32 v68, v68
    v_exp_f32 v69, v69
    v_mfma_f32_32x32x4_2b_bf16 v[96:127], v[38:39], v[36:37], 0
    ds_read_b64 v[38:39], v226 offset:40960
    v_exp_f32 v70, v70
    v_exp_f32 v71, v71
    v_exp_f32 v72, v72
    v_exp_f32 v73, v73
    s_add_u32 m0, s88, 81920
    s_add_u32 s69, s97, 81920
    buffer_load_dwordx4 v228, s[28:31], s69 offen offset:0 sc1 lds
    v_exp_f32 v74, v74
    v_exp_f32 v75, v75
    v_exp_f32 v76, v76
    v_exp_f32 v77, v77
    v_smfmac_f32_32x32x32_bf16 v[144:159], v[208:211], v[64:71], v224
    v_exp_f32 v78, v78
    v_exp_f32 v79, v79
    v_exp_f32 v80, v80
    v_exp_f32 v81, v81
    v_smfmac_f32_32x32x32_bf16 v[144:159], v[212:215], v[72:79], v224
    v_exp_f32 v82, v82
    v_exp_f32 v83, v83
    buffer_load_dwordx4 v228, s[28:31], s69 offen offset:1024 sc1 lds
    v_exp_f32 v84, v84
    v_exp_f32 v85, v85
    v_mfma_f32_32x32x16_bf16 v[96:111], v[40:43], v[32:35], v[96:111]
    ds_read_b128 v[40:43], v225 offset:40960
    v_exp_f32 v86, v86
    v_exp_f32 v87, v87
    v_exp_f32 v88, v88
    v_exp_f32 v89, v89
    v_smfmac_f32_32x32x32_bf16 v[144:159], v[216:219], v[80:87], v224
    v_exp_f32 v90, v90
    v_exp_f32 v91, v91
    v_exp_f32 v92, v92
    v_exp_f32 v93, v93
    v_mfma_f32_32x32x16_bf16 v[112:127], v[44:47], v[32:35], v[112:127]
    ds_read_b128 v[44:47], v225 offset:41984
    v_exp_f32 v94, v94
    v_exp_f32 v95, v95
    v_exp_f32 v96, v96
    v_exp_f32 v97, v97
    s_waitcnt lgkmcnt(2)
    v_smfmac_f32_32x32x32_bf16 v[144:159], v[220:223], v[88:95], v224
    v_exp_f32 v98, v98
    v_exp_f32 v99, v99
    v_exp_f32 v100, v100
    v_exp_f32 v101, v101
    v_mfma_f32_32x32x4_2b_bf16 v[64:95], v[38:39], v[132:133], 0
    v_exp_f32 v102, v102
    v_exp_f32 v103, v103
    v_exp_f32 v104, v104
    v_exp_f32 v105, v105
    buffer_load_dwordx4 v228, s[28:31], s69 offen offset:2048 sc1 lds
    v_exp_f32 v106, v106
    v_exp_f32 v107, v107
    v_exp_f32 v108, v108
    v_exp_f32 v109, v109
    v_smfmac_f32_32x32x32_bf16 v[192:207], v[208:211], v[96:103], v224
    v_exp_f32 v110, v110
    v_exp_f32 v111, v111
    v_exp_f32 v112, v112
    v_exp_f32 v113, v113
    v_smfmac_f32_32x32x32_bf16 v[192:207], v[212:215], v[104:111], v224
    v_exp_f32 v114, v114
    v_exp_f32 v115, v115
    buffer_load_dwordx4 v228, s[28:31], s69 offen offset:3072 sc1 lds
    v_exp_f32 v116, v116
    v_exp_f32 v117, v117
    s_waitcnt lgkmcnt(0)
    v_mfma_f32_32x32x16_bf16 v[64:79], v[40:43], v[128:131], v[64:79]
    v_exp_f32 v118, v118
    v_exp_f32 v119, v119
    v_exp_f32 v120, v120
    v_exp_f32 v121, v121
    v_smfmac_f32_32x32x32_bf16 v[192:207], v[216:219], v[112:119], v224
    v_exp_f32 v122, v122
    v_exp_f32 v123, v123
    v_exp_f32 v124, v124
    v_exp_f32 v125, v125
    v_mfma_f32_32x32x16_bf16 v[80:95], v[44:47], v[128:131], v[80:95]
    v_exp_f32 v126, v126
    v_exp_f32 v127, v127
    v_exp_f32 v64, v64
    v_exp_f32 v65, v65
    v_smfmac_f32_32x32x32_bf16 v[192:207], v[220:223], v[120:127], v224
    s_mov_b64 exec, s[74:75]
    ds_read_b128 v[208:211], v227 offset:51200
    ds_read_b128 v[212:215], v227 offset:51840
    ds_read_b128 v[216:219], v227 offset:52480
    ds_read_b128 v[220:223], v227 offset:53120
    s_mov_b64 exec, -1
    v_exp_f32 v66, v66
    v_exp_f32 v67, v67
    v_exp_f32 v68, v68
    v_exp_f32 v69, v69
    v_mfma_f32_32x32x4_2b_bf16 v[96:127], v[38:39], v[36:37], 0
    ds_read_b64 v[38:39], v226 offset:51200
    v_exp_f32 v70, v70
    v_exp_f32 v71, v71
    v_exp_f32 v72, v72
    v_exp_f32 v73, v73
    s_add_u32 m0, m0, 4096
    s_add_u32 s69, s69, 4096
    buffer_load_dwordx4 v228, s[28:31], s69 offen offset:0 sc1 lds
    v_exp_f32 v74, v74
    v_exp_f32 v75, v75
    v_exp_f32 v76, v76
    v_exp_f32 v77, v77
    v_smfmac_f32_32x32x32_bf16 v[144:159], v[48:51], v[64:71], v224
    v_exp_f32 v78, v78
    v_exp_f32 v79, v79
    v_exp_f32 v80, v80
    v_exp_f32 v81, v81
    v_smfmac_f32_32x32x32_bf16 v[144:159], v[52:55], v[72:79], v224
    v_exp_f32 v82, v82
    v_exp_f32 v83, v83
    s_add_u32 m0, s88, 122880
    s_add_u32 s69, s97, 122880
    buffer_load_dwordx4 v228, s[28:31], s69 offen offset:0 sc1 lds
    v_exp_f32 v84, v84
    v_exp_f32 v85, v85
    v_mfma_f32_32x32x16_bf16 v[96:111], v[40:43], v[32:35], v[96:111]
    ds_read_b128 v[40:43], v225 offset:51200
    v_exp_f32 v86, v86
    v_exp_f32 v87, v87
    v_exp_f32 v88, v88
    v_exp_f32 v89, v89
    v_smfmac_f32_32x32x32_bf16 v[144:159], v[56:59], v[80:87], v224
    v_exp_f32 v90, v90
    v_exp_f32 v91, v91
    v_exp_f32 v92, v92
    v_exp_f32 v93, v93
    v_mfma_f32_32x32x16_bf16 v[112:127], v[44:47], v[32:35], v[112:127]
    ds_read_b128 v[44:47], v225 offset:52224
    v_exp_f32 v94, v94
    v_exp_f32 v95, v95
    s_setprio 2
    v_exp_f32 v96, v96
    v_exp_f32 v97, v97
    s_waitcnt lgkmcnt(2)
    v_smfmac_f32_32x32x32_bf16 v[144:159], v[60:63], v[88:95], v224
    v_exp_f32 v98, v98
    v_exp_f32 v99, v99
    v_exp_f32 v100, v100
    v_exp_f32 v101, v101
    v_mfma_f32_32x32x4_2b_bf16 v[64:95], v[38:39], v[132:133], 0
    v_exp_f32 v102, v102
    v_exp_f32 v103, v103
    v_exp_f32 v104, v104
    v_exp_f32 v105, v105
    buffer_load_dwordx4 v228, s[28:31], s69 offen offset:1024 sc1 lds
    v_exp_f32 v106, v106
    v_exp_f32 v107, v107
    v_exp_f32 v108, v108
    v_exp_f32 v109, v109
    v_smfmac_f32_32x32x32_bf16 v[192:207], v[48:51], v[96:103], v224
    v_exp_f32 v110, v110
    v_exp_f32 v111, v111
    v_exp_f32 v112, v112
    v_exp_f32 v113, v113
    v_smfmac_f32_32x32x32_bf16 v[192:207], v[52:55], v[104:111], v224
    v_exp_f32 v114, v114
    v_exp_f32 v115, v115
    buffer_load_dwordx4 v228, s[28:31], s69 offen offset:2048 sc1 lds
    v_exp_f32 v116, v116
    v_exp_f32 v117, v117
    s_waitcnt lgkmcnt(0)
    v_mfma_f32_32x32x16_bf16 v[64:79], v[40:43], v[128:131], v[64:79]
    v_exp_f32 v118, v118
    v_exp_f32 v119, v119
    v_exp_f32 v120, v120
    v_exp_f32 v121, v121
    v_smfmac_f32_32x32x32_bf16 v[192:207], v[56:59], v[112:119], v224
    v_exp_f32 v122, v122
    v_exp_f32 v123, v123
    v_exp_f32 v124, v124
    v_exp_f32 v125, v125
    v_mfma_f32_32x32x16_bf16 v[80:95], v[44:47], v[128:131], v[80:95]
    v_exp_f32 v126, v126
    v_exp_f32 v127, v127
    v_exp_f32 v64, v64
    v_exp_f32 v65, v65
    v_smfmac_f32_32x32x32_bf16 v[192:207], v[60:63], v[120:127], v224
    v_add_u32 v227, 61440, v227
    s_mov_b64 exec, s[74:75]
    ds_read_b128 v[48:51], v227 offset:0
    ds_read_b128 v[52:55], v227 offset:640
    ds_read_b128 v[56:59], v227 offset:1280
    ds_read_b128 v[60:63], v227 offset:1920
    s_mov_b64 exec, -1
    v_exp_f32 v66, v66
    v_exp_f32 v67, v67
    v_exp_f32 v68, v68
    v_exp_f32 v69, v69
    v_mfma_f32_32x32x4_2b_bf16 v[96:127], v[38:39], v[36:37], 0
    v_add_u32 v225, 61440, v225
    v_add_u32 v226, 61440, v226
    ds_read_b64 v[38:39], v226 offset:0
    v_exp_f32 v70, v70
    v_exp_f32 v71, v71
    v_exp_f32 v72, v72
    v_exp_f32 v73, v73
    buffer_load_dwordx4 v228, s[28:31], s69 offen offset:3072 sc1 lds
    v_exp_f32 v74, v74
    v_exp_f32 v75, v75
    v_exp_f32 v76, v76
    v_exp_f32 v77, v77
    v_smfmac_f32_32x32x32_bf16 v[144:159], v[208:211], v[64:71], v224
    v_exp_f32 v78, v78
    v_exp_f32 v79, v79
    v_exp_f32 v80, v80
    v_exp_f32 v81, v81
    v_smfmac_f32_32x32x32_bf16 v[144:159], v[212:215], v[72:79], v224
    v_exp_f32 v82, v82
    v_exp_f32 v83, v83
    s_add_u32 m0, m0, 4096
    s_add_u32 s69, s69, 4096
    buffer_load_dwordx4 v228, s[28:31], s69 offen offset:0 sc1 lds
    v_exp_f32 v84, v84
    v_exp_f32 v85, v85
    v_mfma_f32_32x32x16_bf16 v[96:111], v[40:43], v[32:35], v[96:111]
    ds_read_b128 v[40:43], v225 offset:0
    v_exp_f32 v86, v86
    v_exp_f32 v87, v87
    v_exp_f32 v88, v88
    v_exp_f32 v89, v89
    v_smfmac_f32_32x32x32_bf16 v[144:159], v[216:219], v[80:87], v224
    v_exp_f32 v90, v90
    v_exp_f32 v91, v91
    v_exp_f32 v92, v92
    v_exp_f32 v93, v93
    v_mfma_f32_32x32x16_bf16 v[112:127], v[44:47], v[32:35], v[112:127]
    ds_read_b128 v[44:47], v225 offset:1024
    v_exp_f32 v94, v94
    v_exp_f32 v95, v95
    s_setprio 1
    v_exp_f32 v96, v96
    v_exp_f32 v97, v97
    s_waitcnt lgkmcnt(2)
    v_smfmac_f32_32x32x32_bf16 v[144:159], v[220:223], v[88:95], v224
    v_exp_f32 v98, v98
    v_exp_f32 v99, v99
    v_exp_f32 v100, v100
    v_exp_f32 v101, v101
    v_mfma_f32_32x32x4_2b_bf16 v[64:95], v[38:39], v[132:133], 0
    v_exp_f32 v102, v102
    v_exp_f32 v103, v103
    v_exp_f32 v104, v104
    v_exp_f32 v105, v105
    v_exp_f32 v106, v106
    v_exp_f32 v107, v107
    v_exp_f32 v108, v108
    v_exp_f32 v109, v109
    v_smfmac_f32_32x32x32_bf16 v[192:207], v[208:211], v[96:103], v224
    v_exp_f32 v110, v110
    v_exp_f32 v111, v111
    v_exp_f32 v112, v112
    v_exp_f32 v113, v113
    v_smfmac_f32_32x32x32_bf16 v[192:207], v[212:215], v[104:111], v224
    v_exp_f32 v114, v114
    v_exp_f32 v115, v115
    v_exp_f32 v116, v116
    v_exp_f32 v117, v117
    s_waitcnt lgkmcnt(0)
    v_mfma_f32_32x32x16_bf16 v[64:79], v[40:43], v[128:131], v[64:79]
    v_exp_f32 v118, v118
    v_exp_f32 v119, v119
    v_exp_f32 v120, v120
    v_exp_f32 v121, v121
    v_smfmac_f32_32x32x32_bf16 v[192:207], v[216:219], v[112:119], v224
    v_exp_f32 v122, v122
    v_exp_f32 v123, v123
    v_exp_f32 v124, v124
    v_exp_f32 v125, v125
    v_mfma_f32_32x32x16_bf16 v[80:95], v[44:47], v[128:131], v[80:95]
    v_exp_f32 v126, v126
    v_exp_f32 v127, v127
    v_exp_f32 v64, v64
    v_exp_f32 v65, v65
    v_smfmac_f32_32x32x32_bf16 v[192:207], v[220:223], v[120:127], v224
    s_mov_b64 exec, s[74:75]
    ds_read_b128 v[208:211], v227 offset:10240
    ds_read_b128 v[212:215], v227 offset:10880
    ds_read_b128 v[216:219], v227 offset:11520
    ds_read_b128 v[220:223], v227 offset:12160
    s_mov_b64 exec, -1
    v_exp_f32 v66, v66
    v_exp_f32 v67, v67
    v_exp_f32 v68, v68
    v_exp_f32 v69, v69
    v_mfma_f32_32x32x4_2b_bf16 v[96:127], v[38:39], v[36:37], 0
    ds_read_b64 v[38:39], v226 offset:10240
    v_exp_f32 v70, v70
    v_exp_f32 v71, v71
    v_exp_f32 v72, v72
    v_exp_f32 v73, v73
    v_exp_f32 v74, v74
    v_exp_f32 v75, v75
    v_exp_f32 v76, v76
    v_exp_f32 v77, v77
    v_smfmac_f32_32x32x32_bf16 v[144:159], v[48:51], v[64:71], v224
    v_exp_f32 v78, v78
    v_exp_f32 v79, v79
    v_exp_f32 v80, v80
    v_exp_f32 v81, v81
    v_smfmac_f32_32x32x32_bf16 v[144:159], v[52:55], v[72:79], v224
    v_exp_f32 v82, v82
    v_exp_f32 v83, v83
    v_exp_f32 v84, v84
    v_exp_f32 v85, v85
    v_mfma_f32_32x32x16_bf16 v[96:111], v[40:43], v[32:35], v[96:111]
    ds_read_b128 v[40:43], v225 offset:10240
    v_exp_f32 v86, v86
    v_exp_f32 v87, v87
    v_exp_f32 v88, v88
    v_exp_f32 v89, v89
    v_smfmac_f32_32x32x32_bf16 v[144:159], v[56:59], v[80:87], v224
    v_exp_f32 v90, v90
    v_exp_f32 v91, v91
    v_exp_f32 v92, v92
    v_exp_f32 v93, v93
    v_mfma_f32_32x32x16_bf16 v[112:127], v[44:47], v[32:35], v[112:127]
    ds_read_b128 v[44:47], v225 offset:11264
    v_exp_f32 v94, v94
    v_exp_f32 v95, v95
    s_setprio 0
    v_exp_f32 v96, v96
    v_exp_f32 v97, v97
    s_waitcnt lgkmcnt(2)
    v_smfmac_f32_32x32x32_bf16 v[144:159], v[60:63], v[88:95], v224
    v_exp_f32 v98, v98
    v_exp_f32 v99, v99
    v_exp_f32 v100, v100
    v_exp_f32 v101, v101
    v_mfma_f32_32x32x4_2b_bf16 v[64:95], v[38:39], v[132:133], 0
    v_exp_f32 v102, v102
    v_exp_f32 v103, v103
    v_exp_f32 v104, v104
    v_exp_f32 v105, v105
    v_exp_f32 v106, v106
    v_exp_f32 v107, v107
    v_exp_f32 v108, v108
    v_exp_f32 v109, v109
    v_smfmac_f32_32x32x32_bf16 v[192:207], v[48:51], v[96:103], v224
    v_exp_f32 v110, v110
    v_exp_f32 v111, v111
    v_exp_f32 v112, v112
    v_exp_f32 v113, v113
    v_smfmac_f32_32x32x32_bf16 v[192:207], v[52:55], v[104:111], v224
    v_exp_f32 v114, v114
    v_exp_f32 v115, v115
    v_exp_f32 v116, v116
    v_exp_f32 v117, v117
    s_waitcnt lgkmcnt(0)
    v_mfma_f32_32x32x16_bf16 v[64:79], v[40:43], v[128:131], v[64:79]
    v_exp_f32 v118, v118
    v_exp_f32 v119, v119
    v_exp_f32 v120, v120
    v_exp_f32 v121, v121
    v_smfmac_f32_32x32x32_bf16 v[192:207], v[56:59], v[112:119], v224
    v_exp_f32 v122, v122
    v_exp_f32 v123, v123
    v_exp_f32 v124, v124
    v_exp_f32 v125, v125
    v_mfma_f32_32x32x16_bf16 v[80:95], v[44:47], v[128:131], v[80:95]
    v_exp_f32 v126, v126
    v_exp_f32 v127, v127
    s_waitcnt vmcnt(0)
    s_barrier
    s_setprio 3
    v_exp_f32 v64, v64
    v_exp_f32 v65, v65
    v_smfmac_f32_32x32x32_bf16 v[192:207], v[60:63], v[120:127], v224
    s_mov_b64 exec, s[74:75]
    ds_read_b128 v[48:51], v227 offset:20480
    ds_read_b128 v[52:55], v227 offset:21120
    ds_read_b128 v[56:59], v227 offset:21760
    ds_read_b128 v[60:63], v227 offset:22400
    s_mov_b64 exec, -1
    v_exp_f32 v66, v66
    v_exp_f32 v67, v67
    v_exp_f32 v68, v68
    v_exp_f32 v69, v69
    v_mfma_f32_32x32x4_2b_bf16 v[96:127], v[38:39], v[36:37], 0
    ds_read_b64 v[38:39], v226 offset:20480
    v_exp_f32 v70, v70
    v_exp_f32 v71, v71
    v_exp_f32 v72, v72
    v_exp_f32 v73, v73
    s_mov_b32 s32, s4
    s_mov_b32 s33, s5
    s_mov_b32 s34, 0x280000
    s_mov_b32 s35, 0x20000
    buffer_load_dwordx2 v[8:9], v250, s[32:35], 0 offen offset:0
    v_exp_f32 v74, v74
    v_exp_f32 v75, v75
    v_exp_f32 v76, v76
    v_exp_f32 v77, v77
    v_smfmac_f32_32x32x32_bf16 v[144:159], v[208:211], v[64:71], v224
    v_exp_f32 v78, v78
    v_exp_f32 v79, v79
    v_exp_f32 v80, v80
    v_exp_f32 v81, v81
    v_smfmac_f32_32x32x32_bf16 v[144:159], v[212:215], v[72:79], v224
    v_exp_f32 v82, v82
    v_exp_f32 v83, v83
    buffer_load_dwordx2 v[10:11], v250, s[32:35], 0 offen offset:32
    v_exp_f32 v84, v84
    v_exp_f32 v85, v85
    v_mfma_f32_32x32x16_bf16 v[96:111], v[40:43], v[32:35], v[96:111]
    ds_read_b128 v[40:43], v225 offset:20480
    v_exp_f32 v86, v86
    v_exp_f32 v87, v87
    v_exp_f32 v88, v88
    v_exp_f32 v89, v89
    v_smfmac_f32_32x32x32_bf16 v[144:159], v[216:219], v[80:87], v224
    v_exp_f32 v90, v90
    v_exp_f32 v91, v91
    v_exp_f32 v92, v92
    v_exp_f32 v93, v93
    v_mfma_f32_32x32x16_bf16 v[112:127], v[44:47], v[32:35], v[112:127]
    ds_read_b128 v[44:47], v225 offset:21504
    v_exp_f32 v94, v94
    v_exp_f32 v95, v95
    v_exp_f32 v96, v96
    v_exp_f32 v97, v97
    s_waitcnt lgkmcnt(2)
    v_smfmac_f32_32x32x32_bf16 v[144:159], v[220:223], v[88:95], v224
    v_exp_f32 v98, v98
    v_exp_f32 v99, v99
    v_exp_f32 v100, v100
    v_exp_f32 v101, v101
    v_mfma_f32_32x32x4_2b_bf16 v[64:95], v[38:39], v[132:133], 0
    v_exp_f32 v102, v102
    v_exp_f32 v103, v103
    v_exp_f32 v104, v104
    v_exp_f32 v105, v105
    buffer_load_dwordx2 v[12:13], v250, s[32:35], 0 offen offset:64
    v_exp_f32 v106, v106
    v_exp_f32 v107, v107
    v_exp_f32 v108, v108
    v_exp_f32 v109, v109
    v_smfmac_f32_32x32x32_bf16 v[192:207], v[208:211], v[96:103], v224
    v_exp_f32 v110, v110
    v_exp_f32 v111, v111
    v_exp_f32 v112, v112
    v_exp_f32 v113, v113
    v_smfmac_f32_32x32x32_bf16 v[192:207], v[212:215], v[104:111], v224
    v_exp_f32 v114, v114
    v_exp_f32 v115, v115
    buffer_load_dwordx2 v[238:239], v231, s[28:31], 0 offen sc1
    v_exp_f32 v116, v116
    v_exp_f32 v117, v117
    s_waitcnt lgkmcnt(0)
    v_mfma_f32_32x32x16_bf16 v[64:79], v[40:43], v[128:131], v[64:79]
    v_exp_f32 v118, v118
    v_exp_f32 v119, v119
    v_exp_f32 v120, v120
    v_exp_f32 v121, v121
    v_smfmac_f32_32x32x32_bf16 v[192:207], v[216:219], v[112:119], v224
    v_exp_f32 v122, v122
    v_exp_f32 v123, v123
    v_exp_f32 v124, v124
    v_exp_f32 v125, v125
    v_mfma_f32_32x32x16_bf16 v[80:95], v[44:47], v[128:131], v[80:95]
    v_exp_f32 v126, v126
    v_exp_f32 v127, v127
    v_exp_f32 v64, v64
    v_exp_f32 v65, v65
    v_smfmac_f32_32x32x32_bf16 v[192:207], v[220:223], v[120:127], v224
    s_mov_b64 exec, s[74:75]
    ds_read_b128 v[208:211], v227 offset:30720
    ds_read_b128 v[212:215], v227 offset:31360
    ds_read_b128 v[216:219], v227 offset:32000
    ds_read_b128 v[220:223], v227 offset:32640
    s_mov_b64 exec, -1
    v_exp_f32 v66, v66
    v_exp_f32 v67, v67
    v_exp_f32 v68, v68
    v_exp_f32 v69, v69
    v_mfma_f32_32x32x4_2b_bf16 v[96:127], v[38:39], v[36:37], 0
    ds_read_b64 v[38:39], v226 offset:30720
    v_exp_f32 v70, v70
    v_exp_f32 v71, v71
    v_exp_f32 v72, v72
    v_exp_f32 v73, v73
    v_exp_f32 v74, v74
    v_exp_f32 v75, v75
    v_exp_f32 v76, v76
    v_exp_f32 v77, v77
    v_smfmac_f32_32x32x32_bf16 v[144:159], v[48:51], v[64:71], v224
    v_exp_f32 v78, v78
    v_exp_f32 v79, v79
    v_exp_f32 v80, v80
    v_exp_f32 v81, v81
    v_smfmac_f32_32x32x32_bf16 v[144:159], v[52:55], v[72:79], v224
    v_exp_f32 v82, v82
    v_exp_f32 v83, v83
    v_exp_f32 v84, v84
    v_exp_f32 v85, v85
    v_mfma_f32_32x32x16_bf16 v[96:111], v[40:43], v[32:35], v[96:111]
    ds_read_b128 v[40:43], v225 offset:30720
    v_exp_f32 v86, v86
    v_exp_f32 v87, v87
    v_exp_f32 v88, v88
    v_exp_f32 v89, v89
    v_smfmac_f32_32x32x32_bf16 v[144:159], v[56:59], v[80:87], v224
    v_exp_f32 v90, v90
    v_exp_f32 v91, v91
    v_exp_f32 v92, v92
    v_exp_f32 v93, v93
    v_mfma_f32_32x32x16_bf16 v[112:127], v[44:47], v[32:35], v[112:127]
    ds_read_b128 v[44:47], v225 offset:31744
    v_exp_f32 v94, v94
    v_exp_f32 v95, v95
    s_setprio 2
    v_exp_f32 v96, v96
    v_exp_f32 v97, v97
    s_waitcnt lgkmcnt(2)
    v_smfmac_f32_32x32x32_bf16 v[144:159], v[60:63], v[88:95], v224
    v_exp_f32 v98, v98
    v_exp_f32 v99, v99
    v_exp_f32 v100, v100
    v_exp_f32 v101, v101
    v_mfma_f32_32x32x4_2b_bf16 v[64:95], v[38:39], v[132:133], 0
    v_exp_f32 v102, v102
    v_exp_f32 v103, v103
    v_exp_f32 v104, v104
    v_exp_f32 v105, v105
    v_exp_f32 v106, v106
    v_exp_f32 v107, v107
    v_exp_f32 v108, v108
    v_exp_f32 v109, v109
    v_smfmac_f32_32x32x32_bf16 v[192:207], v[48:51], v[96:103], v224
    v_exp_f32 v110, v110
    v_exp_f32 v111, v111
    v_exp_f32 v112, v112
    v_exp_f32 v113, v113
    v_smfmac_f32_32x32x32_bf16 v[192:207], v[52:55], v[104:111], v224
    v_exp_f32 v114, v114
    v_exp_f32 v115, v115
    v_exp_f32 v116, v116
    v_exp_f32 v117, v117
    s_waitcnt lgkmcnt(0)
    v_mfma_f32_32x32x16_bf16 v[64:79], v[40:43], v[128:131], v[64:79]
    v_exp_f32 v118, v118
    v_exp_f32 v119, v119
    v_exp_f32 v120, v120
    v_exp_f32 v121, v121
    v_smfmac_f32_32x32x32_bf16 v[192:207], v[56:59], v[112:119], v224
    v_exp_f32 v122, v122
    v_exp_f32 v123, v123
    v_exp_f32 v124, v124
    v_exp_f32 v125, v125
    v_mfma_f32_32x32x16_bf16 v[80:95], v[44:47], v[128:131], v[80:95]
    v_exp_f32 v126, v126
    v_exp_f32 v127, v127
    v_exp_f32 v64, v64
    v_exp_f32 v65, v65
    v_smfmac_f32_32x32x32_bf16 v[192:207], v[60:63], v[120:127], v224
    s_mov_b64 exec, s[74:75]
    ds_read_b128 v[48:51], v227 offset:40960
    ds_read_b128 v[52:55], v227 offset:41600
    ds_read_b128 v[56:59], v227 offset:42240
    ds_read_b128 v[60:63], v227 offset:42880
    s_mov_b64 exec, -1
    v_exp_f32 v66, v66
    v_exp_f32 v67, v67
    v_exp_f32 v68, v68
    v_exp_f32 v69, v69
    v_mfma_f32_32x32x4_2b_bf16 v[96:127], v[38:39], v[36:37], 0
    ds_read_b64 v[38:39], v226 offset:40960
    v_exp_f32 v70, v70
    v_exp_f32 v71, v71
    v_exp_f32 v72, v72
    v_exp_f32 v73, v73
    v_exp_f32 v74, v74
    v_exp_f32 v75, v75
    v_exp_f32 v76, v76
    v_exp_f32 v77, v77
    v_smfmac_f32_32x32x32_bf16 v[144:159], v[208:211], v[64:71], v224
    v_exp_f32 v78, v78
    v_exp_f32 v79, v79
    v_exp_f32 v80, v80
    v_exp_f32 v81, v81
    v_smfmac_f32_32x32x32_bf16 v[144:159], v[212:215], v[72:79], v224
    v_exp_f32 v82, v82
    v_exp_f32 v83, v83
    v_exp_f32 v84, v84
    v_exp_f32 v85, v85
    v_mfma_f32_32x32x16_bf16 v[96:111], v[40:43], v[32:35], v[96:111]
    ds_read_b128 v[40:43], v225 offset:40960
    v_exp_f32 v86, v86
    v_exp_f32 v87, v87
    v_exp_f32 v88, v88
    v_exp_f32 v89, v89
    v_smfmac_f32_32x32x32_bf16 v[144:159], v[216:219], v[80:87], v224
    v_exp_f32 v90, v90
    v_exp_f32 v91, v91
    v_exp_f32 v92, v92
    v_exp_f32 v93, v93
    v_mfma_f32_32x32x16_bf16 v[112:127], v[44:47], v[32:35], v[112:127]
    ds_read_b128 v[44:47], v225 offset:41984
    v_exp_f32 v94, v94
    v_exp_f32 v95, v95
    s_setprio 1
    v_exp_f32 v96, v96
    v_exp_f32 v97, v97
    s_waitcnt lgkmcnt(2)
    v_smfmac_f32_32x32x32_bf16 v[144:159], v[220:223], v[88:95], v224
    v_exp_f32 v98, v98
    v_exp_f32 v99, v99
    v_exp_f32 v100, v100
    v_exp_f32 v101, v101
    v_mfma_f32_32x32x4_2b_bf16 v[64:95], v[38:39], v[132:133], 0
    v_exp_f32 v102, v102
    v_exp_f32 v103, v103
    v_exp_f32 v104, v104
    v_exp_f32 v105, v105
    v_exp_f32 v106, v106
    v_exp_f32 v107, v107
    v_exp_f32 v108, v108
    v_exp_f32 v109, v109
    v_smfmac_f32_32x32x32_bf16 v[192:207], v[208:211], v[96:103], v224
    v_exp_f32 v110, v110
    v_exp_f32 v111, v111
    v_exp_f32 v112, v112
    v_exp_f32 v113, v113
    v_smfmac_f32_32x32x32_bf16 v[192:207], v[212:215], v[104:111], v224
    v_exp_f32 v114, v114
    v_exp_f32 v115, v115
    v_exp_f32 v116, v116
    v_exp_f32 v117, v117
    s_waitcnt lgkmcnt(0)
    v_mfma_f32_32x32x16_bf16 v[64:79], v[40:43], v[128:131], v[64:79]
    v_exp_f32 v118, v118
    v_exp_f32 v119, v119
    v_exp_f32 v120, v120
    v_exp_f32 v121, v121
    v_smfmac_f32_32x32x32_bf16 v[192:207], v[216:219], v[112:119], v224
    v_exp_f32 v122, v122
    v_exp_f32 v123, v123
    v_exp_f32 v124, v124
    v_exp_f32 v125, v125
    v_mfma_f32_32x32x16_bf16 v[80:95], v[44:47], v[128:131], v[80:95]
    v_exp_f32 v126, v126
    v_exp_f32 v127, v127
    v_exp_f32 v64, v64
    v_exp_f32 v65, v65
    v_smfmac_f32_32x32x32_bf16 v[192:207], v[220:223], v[120:127], v224
    s_mov_b64 exec, s[74:75]
    ds_read_b128 v[208:211], v227 offset:51200
    ds_read_b128 v[212:215], v227 offset:51840
    ds_read_b128 v[216:219], v227 offset:52480
    ds_read_b128 v[220:223], v227 offset:53120
    s_mov_b64 exec, -1
    v_exp_f32 v66, v66
    v_exp_f32 v67, v67
    v_exp_f32 v68, v68
    v_exp_f32 v69, v69
    v_mfma_f32_32x32x4_2b_bf16 v[96:127], v[38:39], v[36:37], 0
    ds_read_b64 v[38:39], v226 offset:51200
    v_exp_f32 v70, v70
    v_exp_f32 v71, v71
    v_exp_f32 v72, v72
    v_exp_f32 v73, v73
    v_exp_f32 v74, v74
    v_exp_f32 v75, v75
    v_exp_f32 v76, v76
    v_exp_f32 v77, v77
    v_smfmac_f32_32x32x32_bf16 v[144:159], v[48:51], v[64:71], v224
    v_exp_f32 v78, v78
    v_exp_f32 v79, v79
    v_exp_f32 v80, v80
    v_exp_f32 v81, v81
    v_smfmac_f32_32x32x32_bf16 v[144:159], v[52:55], v[72:79], v224
    v_exp_f32 v82, v82
    v_exp_f32 v83, v83
    v_exp_f32 v84, v84
    v_exp_f32 v85, v85
    v_mfma_f32_32x32x16_bf16 v[96:111], v[40:43], v[32:35], v[96:111]
    ds_read_b128 v[40:43], v225 offset:51200
    v_exp_f32 v86, v86
    v_exp_f32 v87, v87
    v_exp_f32 v88, v88
    v_exp_f32 v89, v89
    v_smfmac_f32_32x32x32_bf16 v[144:159], v[56:59], v[80:87], v224
    v_exp_f32 v90, v90
    v_exp_f32 v91, v91
    v_exp_f32 v92, v92
    v_exp_f32 v93, v93
    v_mfma_f32_32x32x16_bf16 v[112:127], v[44:47], v[32:35], v[112:127]
    ds_read_b128 v[44:47], v225 offset:52224
    v_exp_f32 v94, v94
    v_exp_f32 v95, v95
    s_setprio 0
    v_exp_f32 v96, v96
    v_exp_f32 v97, v97
    s_waitcnt lgkmcnt(2)
    v_smfmac_f32_32x32x32_bf16 v[144:159], v[60:63], v[88:95], v224
    v_exp_f32 v98, v98
    v_exp_f32 v99, v99
    v_exp_f32 v100, v100
    v_exp_f32 v101, v101
    v_mfma_f32_32x32x4_2b_bf16 v[64:95], v[38:39], v[132:133], 0
    v_exp_f32 v102, v102
    v_exp_f32 v103, v103
    v_exp_f32 v104, v104
    v_exp_f32 v105, v105
    v_exp_f32 v106, v106
    v_exp_f32 v107, v107
    v_exp_f32 v108, v108
    v_exp_f32 v109, v109
    v_smfmac_f32_32x32x32_bf16 v[192:207], v[48:51], v[96:103], v224
    v_exp_f32 v110, v110
    v_exp_f32 v111, v111
    v_exp_f32 v112, v112
    v_exp_f32 v113, v113
    v_smfmac_f32_32x32x32_bf16 v[192:207], v[52:55], v[104:111], v224
    v_exp_f32 v114, v114
    v_exp_f32 v115, v115
    v_exp_f32 v116, v116
    v_exp_f32 v117, v117
    s_waitcnt lgkmcnt(0)
    v_mfma_f32_32x32x16_bf16 v[64:79], v[40:43], v[128:131], v[64:79]
    v_exp_f32 v118, v118
    v_exp_f32 v119, v119
    v_exp_f32 v120, v120
    v_exp_f32 v121, v121
    v_smfmac_f32_32x32x32_bf16 v[192:207], v[56:59], v[112:119], v224
    v_exp_f32 v122, v122
    v_exp_f32 v123, v123
    v_exp_f32 v124, v124
    v_exp_f32 v125, v125
    v_mfma_f32_32x32x16_bf16 v[80:95], v[44:47], v[128:131], v[80:95]
    v_exp_f32 v126, v126
    v_exp_f32 v127, v127
    s_barrier
    s_mov_b32 s32, s8
    s_mov_b32 s33, s9
    s_mov_b32 s34, 0xc8000
    s_mov_b32 s35, 0x20000
    s_setprio 3
    v_exp_f32 v64, v64
    v_exp_f32 v65, v65
    v_smfmac_f32_32x32x32_bf16 v[192:207], v[60:63], v[120:127], v224
    v_add_u32 v227, 61440, v227
    s_mov_b64 exec, s[74:75]
    ds_read_b128 v[48:51], v227 offset:0
    ds_read_b128 v[52:55], v227 offset:640
    ds_read_b128 v[56:59], v227 offset:1280
    ds_read_b128 v[60:63], v227 offset:1920
    s_mov_b64 exec, -1
    v_exp_f32 v66, v66
    v_exp_f32 v67, v67
    v_exp_f32 v68, v68
    v_exp_f32 v69, v69
    v_mfma_f32_32x32x4_2b_bf16 v[96:127], v[38:39], v[36:37], 0
    v_add_u32 v225, 61440, v225
    v_add_u32 v226, 61440, v226
    ds_read_b64 v[38:39], v226 offset:0
    v_exp_f32 v70, v70
    v_exp_f32 v71, v71
    v_exp_f32 v72, v72
    v_exp_f32 v73, v73
    s_waitcnt vmcnt(0)
    v_min_u32 v238, v238, v239
    v_cmp_ne_u32 vcc, 0, v238
    s_nop 1
    s_cmp_eq_u64 vcc, exec
    s_cbranch_scc1 F3OK_13
    s_mov_b32 s62, 0
POLL_14:
    buffer_load_dwordx2 v[238:239], v231, s[28:31], 0 offen offset:0 sc1
    s_waitcnt vmcnt(0)
    v_min_u32 v238, v238, v239
    v_cmp_ne_u32 vcc, 0, v238
    s_nop 1
    s_cmp_eq_u64 vcc, exec
    s_cbranch_scc1 POLLD_15
    s_add_u32 s62, s62, 1
    s_cmp_lt_u32 s62, 200000
    s_cbranch_scc0 POLLD_15
    s_sleep 1
    s_branch POLL_14
POLLD_15:
F3OK_13:
    s_mul_i32 s69, s3, 1280
    s_add_u32 m0, s69, 102400
    s_mov_b32 s69, 31744
    buffer_load_dwordx4 v232, s[28:31], 0 offen sc1 lds
    s_mov_b64 exec, 0xffff
    buffer_load_dwordx4 v232, s[28:31], s69 offen offset:1024 sc1 lds
    s_mov_b64 exec, -1
    v_exp_f32 v74, v74
    v_exp_f32 v75, v75
    v_exp_f32 v76, v76
    v_exp_f32 v77, v77
    v_smfmac_f32_32x32x32_bf16 v[144:159], v[208:211], v[64:71], v224
    v_exp_f32 v78, v78
    v_exp_f32 v79, v79
    v_exp_f32 v80, v80
    v_exp_f32 v81, v81
    v_smfmac_f32_32x32x32_bf16 v[144:159], v[212:215], v[72:79], v224
    v_exp_f32 v82, v82
    v_exp_f32 v83, v83
    s_mul_i32 s68, s3, 13312
    s_add_u32 m0, s68, 0
    s_mov_b32 s69, 0
    buffer_load_dwordx4 v233, s[32:35], s69 offen lds
    v_exp_f32 v84, v84
    v_exp_f32 v85, v85
    v_mfma_f32_32x32x16_bf16 v[96:111], v[40:43], v[32:35], v[96:111]
    ds_read_b128 v[40:43], v225 offset:0
    v_exp_f32 v86, v86
    v_exp_f32 v87, v87
    v_exp_f32 v88, v88
    v_exp_f32 v89, v89
    v_smfmac_f32_32x32x32_bf16 v[144:159], v[216:219], v[80:87], v224
    v_exp_f32 v90, v90
    v_exp_f32 v91, v91
    v_exp_f32 v92, v92
    v_exp_f32 v93, v93
    v_mfma_f32_32x32x16_bf16 v[112:127], v[44:47], v[32:35], v[112:127]
    ds_read_b128 v[44:47], v225 offset:1024
    v_exp_f32 v94, v94
    v_exp_f32 v95, v95
    v_exp_f32 v96, v96
    v_exp_f32 v97, v97
    s_waitcnt lgkmcnt(2)
    v_smfmac_f32_32x32x32_bf16 v[144:159], v[220:223], v[88:95], v224
    v_exp_f32 v98, v98
    v_exp_f32 v99, v99
    v_exp_f32 v100, v100
    v_exp_f32 v101, v101
    v_mfma_f32_32x32x4_2b_bf16 v[64:95], v[38:39], v[132:133], 0
    v_exp_f32 v102, v102
    v_exp_f32 v103, v103
    v_exp_f32 v104, v104
    v_exp_f32 v105, v105
    s_add_u32 m0, m0, 1024
    s_nop 0
    buffer_load_dwordx4 v234, s[32:35], s69 offen lds
    v_exp_f32 v106, v106
    v_exp_f32 v107, v107
    v_exp_f32 v108, v108
    v_exp_f32 v109, v109
    v_smfmac_f32_32x32x32_bf16 v[192:207], v[208:211], v[96:103], v224
    v_exp_f32 v110, v110
    v_exp_f32 v111, v111
    v_exp_f32 v112, v112
    v_exp_f32 v113, v113
    v_smfmac_f32_32x32x32_bf16 v[192:207], v[212:215], v[104:111], v224
    v_exp_f32 v114, v114
    v_exp_f32 v115, v115
    s_add_u32 m0, m0, 1024
    s_nop 0
    buffer_load_dwordx4 v235, s[32:35], s69 offen lds
    v_exp_f32 v116, v116
    v_exp_f32 v117, v117
    s_waitcnt lgkmcnt(0)
    v_mfma_f32_32x32x16_bf16 v[64:79], v[40:43], v[128:131], v[64:79]
    v_exp_f32 v118, v118
    v_exp_f32 v119, v119
    v_exp_f32 v120, v120
    v_exp_f32 v121, v121
    v_smfmac_f32_32x32x32_bf16 v[192:207], v[216:219], v[112:119], v224
    v_exp_f32 v122, v122
    v_exp_f32 v123, v123
    v_exp_f32 v124, v124
    v_exp_f32 v125, v125
    v_mfma_f32_32x32x16_bf16 v[80:95], v[44:47], v[128:131], v[80:95]
    v_exp_f32 v126, v126
    v_exp_f32 v127, v127
    v_exp_f32 v64, v64
    v_exp_f32 v65, v65
    v_smfmac_f32_32x32x32_bf16 v[192:207], v[220:223], v[120:127], v224
    s_mov_b64 exec, s[74:75]
    ds_read_b128 v[208:211], v227 offset:10240
    ds_read_b128 v[212:215], v227 offset:10880
    ds_read_b128 v[216:219], v227 offset:11520
    ds_read_b128 v[220:223], v227 offset:12160
    s_mov_b64 exec, -1
    v_exp_f32 v66, v66
    v_exp_f32 v67, v67
    v_exp_f32 v68, v68
    v_exp_f32 v69, v69
    v_mfma_f32_32x32x4_2b_bf16 v[96:127], v[38:39], v[36:37], 0
    ds_read_b64 v[38:39], v226 offset:10240
    v_exp_f32 v70, v70
    v_exp_f32 v71, v71
    v_exp_f32 v72, v72
    v_exp_f32 v73, v73
    s_add_u32 m0, m0, 1024
    s_nop 0
    buffer_load_dwordx4 v236, s[32:35], s69 offen lds
    v_exp_f32 v74, v74
    v_exp_f32 v75, v75
    v_exp_f32 v76, v76
    v_exp_f32 v77, v77
    v_smfmac_f32_32x32x32_bf16 v[144:159], v[48:51], v[64:71], v224
    v_exp_f32 v78, v78
    v_exp_f32 v79, v79
    v_exp_f32 v80, v80
    v_exp_f32 v81, v81
    v_smfmac_f32_32x32x32_bf16 v[144:159], v[52:55], v[72:79], v224
    v_exp_f32 v82, v82
    v_exp_f32 v83, v83
    s_add_u32 m0, m0, 1024
    s_nop 0
    buffer_load_dwordx4 v237, s[32:35], s69 offen lds
    v_exp_f32 v84, v84
    v_exp_f32 v85, v85
    v_mfma_f32_32x32x16_bf16 v[96:111], v[40:43], v[32:35], v[96:111]
    ds_read_b128 v[40:43], v225 offset:10240
    v_exp_f32 v86, v86
    v_exp_f32 v87, v87
    v_exp_f32 v88, v88
    v_exp_f32 v89, v89
    v_smfmac_f32_32x32x32_bf16 v[144:159], v[56:59], v[80:87], v224
    v_exp_f32 v90, v90
    v_exp_f32 v91, v91
    v_exp_f32 v92, v92
    v_exp_f32 v93, v93
    v_mfma_f32_32x32x16_bf16 v[112:127], v[44:47], v[32:35], v[112:127]
    ds_read_b128 v[44:47], v225 offset:11264
    v_exp_f32 v94, v94
    v_exp_f32 v95, v95
    s_setprio 2
    v_exp_f32 v96, v96
    v_exp_f32 v97, v97
    s_waitcnt lgkmcnt(2)
    v_smfmac_f32_32x32x32_bf16 v[144:159], v[60:63], v[88:95], v224
    v_exp_f32 v98, v98
    v_exp_f32 v99, v99
    v_exp_f32 v100, v100
    v_exp_f32 v101, v101
    v_mfma_f32_32x32x4_2b_bf16 v[64:95], v[38:39], v[132:133], 0
    v_exp_f32 v102, v102
    v_exp_f32 v103, v103
    v_exp_f32 v104, v104
    v_exp_f32 v105, v105
    s_add_u32 m0, m0, 1024
    s_mov_b32 s69, 40960
    buffer_load_dwordx4 v233, s[32:35], s69 offen lds
    v_exp_f32 v106, v106
    v_exp_f32 v107, v107
    v_exp_f32 v108, v108
    v_exp_f32 v109, v109
    v_smfmac_f32_32x32x32_bf16 v[192:207], v[48:51], v[96:103], v224
    v_exp_f32 v110, v110
    v_exp_f32 v111, v111
    v_exp_f32 v112, v112
    v_exp_f32 v113, v113
    v_smfmac_f32_32x32x32_bf16 v[192:207], v[52:55], v[104:111], v224
    v_exp_f32 v114, v114
    v_exp_f32 v115, v115
    s_add_u32 m0, m0, 1024
    s_nop 0
    buffer_load_dwordx4 v234, s[32:35], s69 offen lds
    v_exp_f32 v116, v116
    v_exp_f32 v117, v117
    s_waitcnt lgkmcnt(0)
    v_mfma_f32_32x32x16_bf16 v[64:79], v[40:43], v[128:131], v[64:79]
    v_exp_f32 v118, v118
    v_exp_f32 v119, v119
    v_exp_f32 v120, v120
    v_exp_f32 v121, v121
    v_smfmac_f32_32x32x32_bf16 v[192:207], v[56:59], v[112:119], v224
    v_exp_f32 v122, v122
    v_exp_f32 v123, v123
    v_exp_f32 v124, v124
    v_exp_f32 v125, v125
    v_mfma_f32_32x32x16_bf16 v[80:95], v[44:47], v[128:131], v[80:95]
    v_exp_f32 v126, v126
    v_exp_f32 v127, v127
    v_exp_f32 v64, v64
    v_exp_f32 v65, v65
    v_smfmac_f32_32x32x32_bf16 v[192:207], v[60:63], v[120:127], v224
    s_mov_b64 exec, s[74:75]
    ds_read_b128 v[48:51], v227 offset:20480
    ds_read_b128 v[52:55], v227 offset:21120
    ds_read_b128 v[56:59], v227 offset:21760
    ds_read_b128 v[60:63], v227 offset:22400
    s_mov_b64 exec, -1
    v_exp_f32 v66, v66
    v_exp_f32 v67, v67
    v_exp_f32 v68, v68
    v_exp_f32 v69, v69
    v_mfma_f32_32x32x4_2b_bf16 v[96:127], v[38:39], v[36:37], 0
    ds_read_b64 v[38:39], v226 offset:20480
    v_exp_f32 v70, v70
    v_exp_f32 v71, v71
    v_exp_f32 v72, v72
    v_exp_f32 v73, v73
    s_add_u32 m0, m0, 1024
    s_nop 0
    buffer_load_dwordx4 v235, s[32:35], s69 offen lds
    v_exp_f32 v74, v74
    v_exp_f32 v75, v75
    v_exp_f32 v76, v76
    v_exp_f32 v77, v77
    v_smfmac_f32_32x32x32_bf16 v[144:159], v[208:211], v[64:71], v224
    v_exp_f32 v78, v78
    v_exp_f32 v79, v79
    v_exp_f32 v80, v80
    v_exp_f32 v81, v81
    v_smfmac_f32_32x32x32_bf16 v[144:159], v[212:215], v[72:79], v224
    v_exp_f32 v82, v82
    v_exp_f32 v83, v83
    s_add_u32 m0, m0, 1024
    s_nop 0
    buffer_load_dwordx4 v236, s[32:35], s69 offen lds
    v_exp_f32 v84, v84
    v_exp_f32 v85, v85
    v_mfma_f32_32x32x16_bf16 v[96:111], v[40:43], v[32:35], v[96:111]
    ds_read_b128 v[40:43], v225 offset:20480
    v_exp_f32 v86, v86
    v_exp_f32 v87, v87
    v_exp_f32 v88, v88
    v_exp_f32 v89, v89
    v_smfmac_f32_32x32x32_bf16 v[144:159], v[216:219], v[80:87], v224
    v_exp_f32 v90, v90
    v_exp_f32 v91, v91
    v_exp_f32 v92, v92
    v_exp_f32 v93, v93
    v_mfma_f32_32x32x16_bf16 v[112:127], v[44:47], v[32:35], v[112:127]
    ds_read_b128 v[44:47], v225 offset:21504
    v_exp_f32 v94, v94
    v_exp_f32 v95, v95
    s_setprio 1
    v_exp_f32 v96, v96
    v_exp_f32 v97, v97
    s_waitcnt lgkmcnt(2)
    v_smfmac_f32_32x32x32_bf16 v[144:159], v[220:223], v[88:95], v224
    v_exp_f32 v98, v98
    v_exp_f32 v99, v99
    v_exp_f32 v100, v100
    v_exp_f32 v101, v101
    v_mfma_f32_32x32x4_2b_bf16 v[64:95], v[38:39], v[132:133], 0
    v_exp_f32 v102, v102
    v_exp_f32 v103, v103
    v_exp_f32 v104, v104
    v_exp_f32 v105, v105
    s_add_u32 m0, m0, 1024
    s_cmp_eq_u32 s3, 7
    s_cbranch_scc1 NOWO_25
    buffer_load_dwordx4 v237, s[32:35], s69 offen lds
NOWO_25:
    v_exp_f32 v106, v106
    v_exp_f32 v107, v107
    v_exp_f32 v108, v108
    v_exp_f32 v109, v109
    v_smfmac_f32_32x32x32_bf16 v[192:207], v[208:211], v[96:103], v224
    v_exp_f32 v110, v110
    v_exp_f32 v111, v111
    v_exp_f32 v112, v112
    v_exp_f32 v113, v113
    v_smfmac_f32_32x32x32_bf16 v[192:207], v[212:215], v[104:111], v224
    v_exp_f32 v114, v114
    v_exp_f32 v115, v115
    s_add_u32 m0, m0, 1024
    s_mov_b32 s69, 81920
    s_cmp_eq_u32 s3, 7
    s_cbranch_scc1 NOWO_26
    buffer_load_dwordx4 v233, s[32:35], s69 offen lds
NOWO_26:
    v_exp_f32 v116, v116
    v_exp_f32 v117, v117
    s_waitcnt lgkmcnt(0)
    v_mfma_f32_32x32x16_bf16 v[64:79], v[40:43], v[128:131], v[64:79]
    v_exp_f32 v118, v118
    v_exp_f32 v119, v119
    v_exp_f32 v120, v120
    v_exp_f32 v121, v121
    v_smfmac_f32_32x32x32_bf16 v[192:207], v[216:219], v[112:119], v224
    v_exp_f32 v122, v122
    v_exp_f32 v123, v123
    v_exp_f32 v124, v124
    v_exp_f32 v125, v125
    v_mfma_f32_32x32x16_bf16 v[80:95], v[44:47], v[128:131], v[80:95]
    v_exp_f32 v126, v126
    v_exp_f32 v127, v127
    v_exp_f32 v64, v64
    v_exp_f32 v65, v65
    v_smfmac_f32_32x32x32_bf16 v[192:207], v[220:223], v[120:127], v224
    s_mov_b64 exec, s[74:75]
    ds_read_b128 v[208:211], v227 offset:30720
    ds_read_b128 v[212:215], v227 offset:31360
    ds_read_b128 v[216:219], v227 offset:32000
    ds_read_b128 v[220:223], v227 offset:32640
    s_mov_b64 exec, -1
    v_exp_f32 v66, v66
    v_exp_f32 v67, v67
    v_exp_f32 v68, v68
    v_exp_f32 v69, v69
    v_mfma_f32_32x32x4_2b_bf16 v[96:127], v[38:39], v[36:37], 0
    ds_read_b64 v[38:39], v226 offset:30720
    v_exp_f32 v70, v70
    v_exp_f32 v71, v71
    v_exp_f32 v72, v72
    v_exp_f32 v73, v73
    s_add_u32 m0, m0, 1024
    s_cmp_eq_u32 s3, 7
    s_cbranch_scc1 NOWO_27
    buffer_load_dwordx4 v234, s[32:35], s69 offen lds
NOWO_27:
    v_exp_f32 v74, v74
    v_exp_f32 v75, v75
    v_exp_f32 v76, v76
    v_exp_f32 v77, v77
    v_smfmac_f32_32x32x32_bf16 v[144:159], v[48:51], v[64:71], v224
    v_exp_f32 v78, v78
    v_exp_f32 v79, v79
    v_exp_f32 v80, v80
    v_exp_f32 v81, v81
    v_smfmac_f32_32x32x32_bf16 v[144:159], v[52:55], v[72:79], v224
    v_exp_f32 v82, v82
    v_exp_f32 v83, v83
    s_add_u32 m0, m0, 1024
    s_cmp_eq_u32 s3, 7
    s_cbranch_scc1 NOWO_28
    buffer_load_dwordx4 v235, s[32:35], s69 offen lds
NOWO_28:
    v_exp_f32 v84, v84
    v_exp_f32 v85, v85
    v_mfma_f32_32x32x16_bf16 v[96:111], v[40:43], v[32:35], v[96:111]
    ds_read_b128 v[40:43], v225 offset:30720
    v_exp_f32 v86, v86
    v_exp_f32 v87, v87
    v_exp_f32 v88, v88
    v_exp_f32 v89, v89
    v_smfmac_f32_32x32x32_bf16 v[144:159], v[56:59], v[80:87], v224
    v_exp_f32 v90, v90
    v_exp_f32 v91, v91
    v_exp_f32 v92, v92
    v_exp_f32 v93, v93
    v_mfma_f32_32x32x16_bf16 v[112:127], v[44:47], v[32:35], v[112:127]
    ds_read_b128 v[44:47], v225 offset:31744
    v_exp_f32 v94, v94
    v_exp_f32 v95, v95
    s_setprio 0
    v_exp_f32 v96, v96
    v_exp_f32 v97, v97
    s_waitcnt lgkmcnt(2)
    v_smfmac_f32_32x32x32_bf16 v[144:159], v[60:63], v[88:95], v224
    v_exp_f32 v98, v98
    v_exp_f32 v99, v99
    v_exp_f32 v100, v100
    v_exp_f32 v101, v101
    v_mfma_f32_32x32x4_2b_bf16 v[64:95], v[38:39], v[132:133], 0
    v_exp_f32 v102, v102
    v_exp_f32 v103, v103
    v_exp_f32 v104, v104
    v_exp_f32 v105, v105
    v_exp_f32 v106, v106
    v_exp_f32 v107, v107
    v_exp_f32 v108, v108
    v_exp_f32 v109, v109
    v_smfmac_f32_32x32x32_bf16 v[192:207], v[48:51], v[96:103], v224
    v_exp_f32 v110, v110
    v_exp_f32 v111, v111
    v_exp_f32 v112, v112
    v_exp_f32 v113, v113
    v_smfmac_f32_32x32x32_bf16 v[192:207], v[52:55], v[104:111], v224
    v_exp_f32 v114, v114
    v_exp_f32 v115, v115
    v_exp_f32 v116, v116
    v_exp_f32 v117, v117
    s_waitcnt lgkmcnt(0)
    v_mfma_f32_32x32x16_bf16 v[64:79], v[40:43], v[128:131], v[64:79]
    v_exp_f32 v118, v118
    v_exp_f32 v119, v119
    v_exp_f32 v120, v120
    v_exp_f32 v121, v121
    v_smfmac_f32_32x32x32_bf16 v[192:207], v[56:59], v[112:119], v224
    v_exp_f32 v122, v122
    v_exp_f32 v123, v123
    v_exp_f32 v124, v124
    v_exp_f32 v125, v125
    v_mfma_f32_32x32x16_bf16 v[80:95], v[44:47], v[128:131], v[80:95]
    v_exp_f32 v126, v126
    v_exp_f32 v127, v127
    s_barrier
    s_setprio 1
    v_exp_f32 v64, v64
    v_exp_f32 v65, v65
    v_smfmac_f32_32x32x32_bf16 v[192:207], v[60:63], v[120:127], v224
    v_exp_f32 v66, v66
    v_exp_f32 v67, v67
    v_exp_f32 v68, v68
    v_exp_f32 v69, v69
    v_mfma_f32_32x32x4_2b_bf16 v[96:127], v[38:39], v[36:37], 0
    v_exp_f32 v70, v70
    v_exp_f32 v71, v71
    v_exp_f32 v72, v72
    v_exp_f32 v73, v73
    v_exp_f32 v74, v74
    v_exp_f32 v75, v75
    v_exp_f32 v76, v76
    v_exp_f32 v77, v77
    v_smfmac_f32_32x32x32_bf16 v[144:159], v[208:211], v[64:71], v224
    v_exp_f32 v78, v78
    v_exp_f32 v79, v79
    v_exp_f32 v80, v80
    v_exp_f32 v81, v81
    v_smfmac_f32_32x32x32_bf16 v[144:159], v[212:215], v[72:79], v224
    v_exp_f32 v82, v82
    v_exp_f32 v83, v83
    v_exp_f32 v84, v84
    v_exp_f32 v85, v85
    v_mfma_f32_32x32x16_bf16 v[96:111], v[40:43], v[32:35], v[96:111]
    v_exp_f32 v86, v86
    v_exp_f32 v87, v87
    v_exp_f32 v88, v88
    v_exp_f32 v89, v89
    v_smfmac_f32_32x32x32_bf16 v[144:159], v[216:219], v[80:87], v224
    v_exp_f32 v90, v90
    v_exp_f32 v91, v91
    v_exp_f32 v92, v92
    v_exp_f32 v93, v93
    v_mfma_f32_32x32x16_bf16 v[112:127], v[44:47], v[32:35], v[112:127]
    v_exp_f32 v94, v94
    v_exp_f32 v95, v95
    s_setprio 0
    v_exp_f32 v96, v96
    v_exp_f32 v97, v97
    v_smfmac_f32_32x32x32_bf16 v[144:159], v[220:223], v[88:95], v224
    v_exp_f32 v98, v98
    v_exp_f32 v99, v99
    v_exp_f32 v100, v100
    v_exp_f32 v101, v101
    v_exp_f32 v102, v102
    v_exp_f32 v103, v103
    v_exp_f32 v104, v104
    v_exp_f32 v105, v105
    v_exp_f32 v106, v106
    v_exp_f32 v107, v107
    v_exp_f32 v108, v108
    v_exp_f32 v109, v109
    v_smfmac_f32_32x32x32_bf16 v[192:207], v[208:211], v[96:103], v224
    v_exp_f32 v110, v110
    v_exp_f32 v111, v111
    ds_write_b128 v252, v[144:147] offset:0
    v_exp_f32 v112, v112
    v_exp_f32 v113, v113
    v_smfmac_f32_32x32x32_bf16 v[192:207], v[212:215], v[104:111], v224
    v_exp_f32 v114, v114
    v_exp_f32 v115, v115
    ds_write_b128 v252, v[148:151] offset:1024
    v_exp_f32 v116, v116
    v_exp_f32 v117, v117
    v_exp_f32 v118, v118
    v_exp_f32 v119, v119
    ds_write_b128 v252, v[152:155] offset:2048
    v_exp_f32 v120, v120
    v_exp_f32 v121, v121
    v_smfmac_f32_32x32x32_bf16 v[192:207], v[216:219], v[112:119], v224
    v_exp_f32 v122, v122
    v_exp_f32 v123, v123
    ds_write_b32 v252, v156 offset:3072
    v_exp_f32 v124, v124
    v_exp_f32 v125, v125
    v_exp_f32 v126, v126
    v_exp_f32 v127, v127
    s_nop 1
    v_smfmac_f32_32x32x32_bf16 v[192:207], v[220:223], v[120:127], v224
    s_setprio 0
    s_waitcnt lgkmcnt(0)
    s_barrier
    ds_read_b32 v156, v241 offset:3072
    ds_read_b128 v[144:147], v241 offset:0
    ds_read_b128 v[148:151], v241 offset:1024
    ds_read_b128 v[152:155], v241 offset:2048
    v_lshlrev_b32 v2, 3, v0
    s_mov_b32 s66, 0x21800000
    s_mov_b32 s67, 0x5d800000
    s_mov_b32 s68, 0x7f7fffff
    s_nop 0
    s_waitcnt lgkmcnt(3)
    v_add_f32 v204, v204, v156
    s_waitcnt lgkmcnt(2)
    v_add_f32 v192, v192, v144
    v_add_f32 v193, v193, v145
    v_add_f32 v194, v194, v146
    v_add_f32 v195, v195, v147
    s_waitcnt lgkmcnt(1)
    v_add_f32 v196, v196, v148
    v_add_f32 v197, v197, v149
    v_add_f32 v198, v198, v150
    v_add_f32 v199, v199, v151
    s_waitcnt lgkmcnt(0)
    v_add_f32 v200, v200, v152
    v_add_f32 v201, v201, v153
    v_add_f32 v202, v202, v154
    v_add_f32 v203, v203, v155
L_NORM:
    v_rcp_f32 v20, v204
    v_cmp_le_f32 vcc, s66, v204
    v_cmp_ge_f32 s[72:73], s67, v204
    v_mul_f32 v192, v192, v20
    v_mul_f32 v193, v193, v20
    v_mul_f32 v194, v194, v20
    v_mul_f32 v195, v195, v20
    v_mul_f32 v196, v196, v20
    v_mul_f32 v197, v197, v20
    v_mul_f32 v198, v198, v20
    v_mul_f32 v199, v199, v20
    v_cvt_pk_bf16_f32 v24, v192, v193
    v_cvt_pk_bf16_f32 v25, v194, v195
    v_cvt_pk_bf16_f32 v26, v196, v197
    v_cvt_pk_bf16_f32 v27, v198, v199
    buffer_store_dwordx4 v[24:27], v228, s[28:31], s89 offen sc1
    v_mul_f32 v200, v200, v20
    v_mul_f32 v201, v201, v20
    v_mul_f32 v202, v202, v20
    v_mul_f32 v203, v203, v20
    v_cvt_pk_bf16_f32 v28, v200, v201
    v_cvt_pk_bf16_f32 v29, v202, v203
    s_mov_b32 exec_hi, 0
    buffer_store_dwordx2 v[28:29], v2, s[28:31], s90 offen sc1
    s_mov_b32 exec_hi, -1
    v_add_f32 v16, abs(v192), abs(v196)
    v_add_f32 v17, abs(v193), abs(v197)
    v_add_f32 v18, abs(v194), abs(v198)
    v_add_f32 v19, abs(v195), abs(v199)
    v_add_f32 v16, v16, abs(v200)
    v_add_f32 v17, v17, abs(v201)
    v_add_f32 v18, v18, abs(v202)
    v_add_f32 v19, v19, abs(v203)
    v_add_f32 v16, v16, v17
    v_add_f32 v18, v18, v19
    s_and_b64 s[72:73], s[72:73], vcc
    v_add_f32 v16, v16, v18
    v_cmp_ge_f32 vcc, s68, v16
    s_nop 1
    s_and_b64 s[72:73], s[72:73], vcc
    s_cmp_eq_u64 s[72:73], exec
    s_cbranch_scc1 L_NORM_OK
    s_cmp_eq_u32 s63, 0
    s_cbranch_scc1 L_SLOW
L_NORM_OK:
    s_mov_b32 s32, s24
    s_mov_b32 s33, s25
    s_mov_b32 s34, 0x280000
    s_mov_b32 s35, 0x20000
    s_lshl_b32 s64, s60, 2
    s_add_u32 s64, s64, 145408
    v_mov_b32 v229, s64
    v_mov_b32 v230, 0
    ds_write_b32 v229, v230
    s_waitcnt vmcnt(0) lgkmcnt(0)
    s_barrier
    s_cmp_lg_u32 s3, 0
    s_cbranch_scc1 NOF4_29
    v_lshl_add_u32 v2, v0, 2, s91
    v_mov_b32 v3, 1
    s_mov_b64 exec, 1
    buffer_store_dword v3, v2, s[28:31], 0 offen sc1
    s_mov_b64 exec, -1
NOF4_29:
    buffer_load_dword v14, v251, s[28:31], 0 offen sc1
    ds_read_b64_tr_b16 v[56:57], v244 offset:0
    ds_read_b64_tr_b16 v[58:59], v244 offset:1280
    ds_read_b64_tr_b16 v[60:61], v244 offset:32
    ds_read_b64_tr_b16 v[62:63], v244 offset:1312
    ds_read_b64_tr_b16 v[64:65], v245 offset:64
    ds_read_b64_tr_b16 v[66:67], v245 offset:1344
    ds_read_b64_tr_b16 v[68:69], v245 offset:96
    ds_read_b64_tr_b16 v[70:71], v245 offset:1376
    ds_read_b64_tr_b16 v[72:73], v245 offset:128
    ds_read_b64_tr_b16 v[74:75], v245 offset:1408
    ds_read_b64_tr_b16 v[76:77], v244 offset:6400
    ds_read_b64_tr_b16 v[78:79], v244 offset:7680
    ds_read_b64_tr_b16 v[80:81], v244 offset:6432
    ds_read_b64_tr_b16 v[82:83], v244 offset:7712
    ds_read_b64_tr_b16 v[84:85], v245 offset:6464
    ds_read_b64_tr_b16 v[86:87], v245 offset:7744
    ds_read_b64_tr_b16 v[88:89], v245 offset:6496
    ds_read_b64_tr_b16 v[90:91], v245 offset:7776
    ds_read_b64_tr_b16 v[92:93], v245 offset:6528
    ds_read_b64_tr_b16 v[94:95], v245 offset:7808
    ds_read_b64_tr_b16 v[96:97], v244 offset:12800
    ds_read_b64_tr_b16 v[98:99], v244 offset:14080
    ds_read_b64_tr_b16 v[100:101], v244 offset:12832
    ds_read_b64_tr_b16 v[102:103], v244 offset:14112
    ds_read_b64_tr_b16 v[104:105], v245 offset:12864
    ds_read_b64_tr_b16 v[106:107], v245 offset:14144
    ds_read_b64_tr_b16 v[108:109], v245 offset:12896
    ds_read_b64_tr_b16 v[110:111], v245 offset:14176
    ds_read_b64_tr_b16 v[112:113], v245 offset:12928
    ds_read_b64_tr_b16 v[114:115], v245 offset:14208
    ds_read_b64_tr_b16 v[116:117], v244 offset:19200
    ds_read_b64_tr_b16 v[118:119], v244 offset:20480
    ds_read_b64_tr_b16 v[120:121], v244 offset:19232
    ds_read_b64_tr_b16 v[122:123], v244 offset:20512
    ds_read_b64_tr_b16 v[124:125], v245 offset:19264
    ds_read_b64_tr_b16 v[126:127], v245 offset:20544
    ds_read_b64_tr_b16 v[128:129], v245 offset:19296
    ds_read_b64_tr_b16 v[130:131], v245 offset:20576
    ds_read_b64_tr_b16 v[132:133], v245 offset:19328
    ds_read_b64_tr_b16 v[134:135], v245 offset:20608
    ds_read_b64_tr_b16 v[136:137], v244 offset:25600
    ds_read_b64_tr_b16 v[138:139], v244 offset:26880
    ds_read_b64_tr_b16 v[140:141], v244 offset:25632
    ds_read_b64_tr_b16 v[142:143], v244 offset:26912
    ds_read_b64_tr_b16 v[144:145], v245 offset:25664
    ds_read_b64_tr_b16 v[146:147], v245 offset:26944
    ds_read_b64_tr_b16 v[148:149], v245 offset:25696
    ds_read_b64_tr_b16 v[150:151], v245 offset:26976
    ds_read_b64_tr_b16 v[152:153], v245 offset:25728
    ds_read_b64_tr_b16 v[154:155], v245 offset:27008
    ds_read_b64_tr_b16 v[156:157], v244 offset:32000
    ds_read_b64_tr_b16 v[158:159], v244 offset:33280
    ds_read_b64_tr_b16 v[160:161], v244 offset:32032
    ds_read_b64_tr_b16 v[162:163], v244 offset:33312
    ds_read_b64_tr_b16 v[164:165], v245 offset:32064
    ds_read_b64_tr_b16 v[166:167], v245 offset:33344
    ds_read_b64_tr_b16 v[168:169], v245 offset:32096
    ds_read_b64_tr_b16 v[170:171], v245 offset:33376
    ds_read_b64_tr_b16 v[172:173], v245 offset:32128
    ds_read_b64_tr_b16 v[174:175], v245 offset:33408
    ds_read_b64_tr_b16 v[176:177], v244 offset:38400
    ds_read_b64_tr_b16 v[178:179], v244 offset:39680
    ds_read_b64_tr_b16 v[180:181], v244 offset:38432
    ds_read_b64_tr_b16 v[182:183], v244 offset:39712
    ds_read_b64_tr_b16 v[184:185], v245 offset:38464
    ds_read_b64_tr_b16 v[186:187], v245 offset:39744
    ds_read_b64_tr_b16 v[188:189], v245 offset:38496
    ds_read_b64_tr_b16 v[190:191], v245 offset:39776
    ds_read_b64_tr_b16 v[192:193], v245 offset:38528
    ds_read_b64_tr_b16 v[194:195], v245 offset:39808
    ds_read_b64_tr_b16 v[196:197], v244 offset:44800
    ds_read_b64_tr_b16 v[198:199], v244 offset:46080
    ds_read_b64_tr_b16 v[200:201], v244 offset:44832
    ds_read_b64_tr_b16 v[202:203], v244 offset:46112
    ds_read_b64_tr_b16 v[204:205], v245 offset:44864
    ds_read_b64_tr_b16 v[206:207], v245 offset:46144
    ds_read_b64_tr_b16 v[208:209], v245 offset:44896
    ds_read_b64_tr_b16 v[210:211], v245 offset:46176
    ds_read_b64_tr_b16 v[212:213], v245 offset:44928
    ds_read_b64_tr_b16 v[214:215], v245 offset:46208
    ds_read_b64_tr_b16 v[2:3], v254 offset:0
    ds_read_b64_tr_b16 v[4:5], v254 offset:2048
    ds_read_b64_tr_b16 v[6:7], v254 offset:4096
    s_waitcnt lgkmcnt(2)
    v_lshlrev_b32 v16, 16, v8
    v_and_b32 v17, 0xffff0000, v8
    v_lshlrev_b32 v18, 16, v9
    v_and_b32 v19, 0xffff0000, v9
    v_lshlrev_b32 v20, 16, v2
    v_and_b32 v21, 0xffff0000, v2
    v_lshlrev_b32 v22, 16, v3
    v_and_b32 v23, 0xffff0000, v3
    v_mul_f32 v216, v16, v20
    v_mul_f32 v217, v17, v21
    v_mul_f32 v218, v18, v22
    v_mul_f32 v219, v19, v23
    s_waitcnt lgkmcnt(1)
    v_lshlrev_b32 v16, 16, v10
    v_and_b32 v17, 0xffff0000, v10
    v_lshlrev_b32 v18, 16, v11
    v_and_b32 v19, 0xffff0000, v11
    v_lshlrev_b32 v20, 16, v4
    v_and_b32 v21, 0xffff0000, v4
    v_lshlrev_b32 v22, 16, v5
    v_and_b32 v23, 0xffff0000, v5
    v_mul_f32 v220, v16, v20
    v_mul_f32 v221, v17, v21
    v_mul_f32 v222, v18, v22
    v_mul_f32 v223, v19, v23
    s_waitcnt lgkmcnt(0)
    v_lshlrev_b32 v16, 16, v12
    v_and_b32 v17, 0xffff0000, v12
    v_lshlrev_b32 v18, 16, v13
    v_and_b32 v19, 0xffff0000, v13
    v_lshlrev_b32 v20, 16, v6
    v_and_b32 v21, 0xffff0000, v6
    v_lshlrev_b32 v22, 16, v7
    v_and_b32 v23, 0xffff0000, v7
    v_mul_f32 v2, v16, v20
    v_mul_f32 v3, v17, v21
    v_mul_f32 v4, v18, v22
    v_mul_f32 v5, v19, v23
    v_lshrrev_b32 v16, 4, v0
    v_and_b32 v16, 1, v16
    v_mul_u32_u24 v16, 24, v16
    v_add_u32 v15, v16, v250
    v_mov_b32 v6, v229
    s_mov_b64 s[98:99], 0xffff
    s_mov_b32 s62, 0
    s_cmp_lg_u32 s61, 0
    s_cbranch_scc1 GN_31
GW_30:
    s_mov_b64 exec, s[98:99]
    buffer_load_dword v7, v255, s[28:31], 0 offen sc1
    s_waitcnt vmcnt(0)
    v_cmp_eq_u32 vcc, 0, v7
    s_add_u32 s62, s62, 1
    s_mov_b64 exec, -1
    s_mov_b64 s[98:99], vcc
    s_cmp_ge_u32 s62, 200000
    s_cselect_b32 s98, 0, s98
    s_and_b32 s64, s98, 0xff
    s_cselect_b32 s70, 0, 1
    s_and_b32 s64, s98, 0xff00
    s_cselect_b32 s64, 0, 2
    s_or_b32 s70, s70, s64
    s_and_b32 s64, s70, 3
    s_cbranch_scc1 GW_30P
    s_sleep 2
    s_branch GW_30
GW_30P:
    v_mov_b32 v7, s70
    ds_write_b32 v6, v7
    s_branch GD_32
GN_31:
    ds_read_b32 v7, v6
    s_waitcnt lgkmcnt(0)
    v_readfirstlane_b32 s70, v7
    s_add_u32 s62, s62, 1
    s_cmp_ge_u32 s62, 8000000
    s_cselect_b32 s70, 3, s70
    s_and_b32 s64, s70, 3
    s_cbranch_scc1 GD_32
    s_sleep 1
    s_branch GN_31
GD_32:
    s_cmp_lg_u32 s70, 3
    s_cbranch_scc1 L_P3_PART
    s_mov_b32 s64, 0
    buffer_load_dwordx4 v[16:19], v248, s[28:31], s64 offen sc1
    s_mov_b32 s64, 131072
    buffer_load_dwordx4 v[20:23], v248, s[28:31], s64 offen sc1
    s_mov_b32 s64, 262144
    buffer_load_dwordx4 v[24:27], v248, s[28:31], s64 offen sc1
    s_mov_b32 s64, 393216
    buffer_load_dwordx4 v[28:31], v248, s[28:31], s64 offen sc1
    s_mov_b32 s64, 0
    buffer_load_dwordx2 v[32:33], v249, s[28:31], s64 offen sc1
    s_mov_b32 s64, 65536
    buffer_load_dwordx2 v[34:35], v249, s[28:31], s64 offen sc1
    s_mov_b32 s64, 524288
    buffer_load_dwordx4 v[36:39], v248, s[28:31], s64 offen sc1
    s_mov_b32 s64, 655360
    buffer_load_dwordx4 v[40:43], v248, s[28:31], s64 offen sc1
    s_mov_b32 s64, 786432
    buffer_load_dwordx4 v[44:47], v248, s[28:31], s64 offen sc1
    s_mov_b32 s64, 917504
    buffer_load_dwordx4 v[48:51], v248, s[28:31], s64 offen sc1
    s_mov_b32 s64, 131072
    buffer_load_dwordx2 v[52:53], v249, s[28:31], s64 offen sc1
    s_mov_b32 s64, 196608
    buffer_load_dwordx2 v[54:55], v249, s[28:31], s64 offen sc1
    s_waitcnt vmcnt(11)
    v_mfma_f32_16x16x32_bf16 v[224:227], v[56:59], v[16:19], 0
    v_mfma_f32_16x16x32_bf16 v[228:231], v[60:63], v[16:19], 0
    v_mfma_f32_16x16x32_bf16 v[232:235], v[64:67], v[16:19], 0
    v_mfma_f32_16x16x32_bf16 v[236:239], v[68:71], v[16:19], 0
    v_mfma_f32_16x16x32_bf16 v[240:243], v[72:75], v[16:19], 0
    ds_read_b64_tr_b16 v[56:57], v246 offset:0
    ds_read_b64_tr_b16 v[58:59], v246 offset:12800
    ds_read_b64_tr_b16 v[60:61], v246 offset:32
    ds_read_b64_tr_b16 v[62:63], v246 offset:12832
    ds_read_b64_tr_b16 v[64:65], v247 offset:64
    ds_read_b64_tr_b16 v[66:67], v247 offset:12864
    ds_read_b64_tr_b16 v[68:69], v247 offset:96
    ds_read_b64_tr_b16 v[70:71], v247 offset:12896
    ds_read_b64_tr_b16 v[72:73], v247 offset:128
    ds_read_b64_tr_b16 v[74:75], v247 offset:12928
    s_waitcnt vmcnt(10)
    v_mfma_f32_16x16x32_bf16 v[224:227], v[76:79], v[20:23], v[224:227]
    v_mfma_f32_16x16x32_bf16 v[228:231], v[80:83], v[20:23], v[228:231]
    v_mfma_f32_16x16x32_bf16 v[232:235], v[84:87], v[20:23], v[232:235]
    v_mfma_f32_16x16x32_bf16 v[236:239], v[88:91], v[20:23], v[236:239]
    v_mfma_f32_16x16x32_bf16 v[240:243], v[92:95], v[20:23], v[240:243]
    ds_read_b64_tr_b16 v[76:77], v246 offset:25600
    ds_read_b64_tr_b16 v[78:79], v246 offset:38400
    ds_read_b64_tr_b16 v[80:81], v246 offset:25632
    ds_read_b64_tr_b16 v[82:83], v246 offset:38432
    ds_read_b64_tr_b16 v[84:85], v247 offset:25664
    ds_read_b64_tr_b16 v[86:87], v247 offset:38464
    ds_read_b64_tr_b16 v[88:89], v247 offset:25696
    ds_read_b64_tr_b16 v[90:91], v247 offset:38496
    ds_read_b64_tr_b16 v[92:93], v247 offset:25728
    ds_read_b64_tr_b16 v[94:95], v247 offset:38528
    s_waitcnt vmcnt(9)
    v_mfma_f32_16x16x32_bf16 v[224:227], v[96:99], v[24:27], v[224:227]
    v_mfma_f32_16x16x32_bf16 v[228:231], v[100:103], v[24:27], v[228:231]
    v_mfma_f32_16x16x32_bf16 v[232:235], v[104:107], v[24:27], v[232:235]
    v_mfma_f32_16x16x32_bf16 v[236:239], v[108:111], v[24:27], v[236:239]
    v_mfma_f32_16x16x32_bf16 v[240:243], v[112:115], v[24:27], v[240:243]
    s_waitcnt vmcnt(8)
    v_mfma_f32_16x16x32_bf16 v[224:227], v[116:119], v[28:31], v[224:227]
    v_mfma_f32_16x16x32_bf16 v[228:231], v[120:123], v[28:31], v[228:231]
    v_mfma_f32_16x16x32_bf16 v[232:235], v[124:127], v[28:31], v[232:235]
    v_mfma_f32_16x16x32_bf16 v[236:239], v[128:131], v[28:31], v[236:239]
    v_mfma_f32_16x16x32_bf16 v[240:243], v[132:135], v[28:31], v[240:243]
    s_waitcnt vmcnt(6)
    s_waitcnt lgkmcnt(14)
    v_mfma_f32_16x16x32_bf16 v[232:235], v[64:67], v[32:35], v[232:235]
    s_waitcnt lgkmcnt(12)
    v_mfma_f32_16x16x32_bf16 v[236:239], v[68:71], v[32:35], v[236:239]
    s_waitcnt lgkmcnt(10)
    v_mfma_f32_16x16x32_bf16 v[240:243], v[72:75], v[32:35], v[240:243]
    v_mfma_f32_16x16x32_bf16 v[224:227], v[56:59], v[32:35], v[224:227]
    v_mfma_f32_16x16x32_bf16 v[228:231], v[60:63], v[32:35], v[228:231]
    s_waitcnt vmcnt(5)
    v_mfma_f32_16x16x32_bf16 v[96:99], v[136:139], v[36:39], 0
    v_mfma_f32_16x16x32_bf16 v[100:103], v[140:143], v[36:39], 0
    v_mfma_f32_16x16x32_bf16 v[104:107], v[144:147], v[36:39], 0
    v_mfma_f32_16x16x32_bf16 v[108:111], v[148:151], v[36:39], 0
    v_mfma_f32_16x16x32_bf16 v[112:115], v[152:155], v[36:39], 0
    s_waitcnt vmcnt(4)
    v_mfma_f32_16x16x32_bf16 v[96:99], v[156:159], v[40:43], v[96:99]
    v_mfma_f32_16x16x32_bf16 v[100:103], v[160:163], v[40:43], v[100:103]
    v_mfma_f32_16x16x32_bf16 v[104:107], v[164:167], v[40:43], v[104:107]
    v_mfma_f32_16x16x32_bf16 v[108:111], v[168:171], v[40:43], v[108:111]
    v_mfma_f32_16x16x32_bf16 v[112:115], v[172:175], v[40:43], v[112:115]
    s_waitcnt vmcnt(3)
    v_mfma_f32_16x16x32_bf16 v[96:99], v[176:179], v[44:47], v[96:99]
    v_mfma_f32_16x16x32_bf16 v[100:103], v[180:183], v[44:47], v[100:103]
    v_mfma_f32_16x16x32_bf16 v[104:107], v[184:187], v[44:47], v[104:107]
    v_mfma_f32_16x16x32_bf16 v[108:111], v[188:191], v[44:47], v[108:111]
    v_mfma_f32_16x16x32_bf16 v[112:115], v[192:195], v[44:47], v[112:115]
    s_waitcnt vmcnt(2)
    v_mfma_f32_16x16x32_bf16 v[96:99], v[196:199], v[48:51], v[96:99]
    v_mfma_f32_16x16x32_bf16 v[100:103], v[200:203], v[48:51], v[100:103]
    v_mfma_f32_16x16x32_bf16 v[104:107], v[204:207], v[48:51], v[104:107]
    v_mfma_f32_16x16x32_bf16 v[108:111], v[208:211], v[48:51], v[108:111]
    v_mfma_f32_16x16x32_bf16 v[112:115], v[212:215], v[48:51], v[112:115]
    s_waitcnt vmcnt(0)
    s_waitcnt lgkmcnt(4)
    v_mfma_f32_16x16x32_bf16 v[104:107], v[84:87], v[52:55], v[104:107]
    s_waitcnt lgkmcnt(2)
    v_mfma_f32_16x16x32_bf16 v[108:111], v[88:91], v[52:55], v[108:111]
    s_waitcnt lgkmcnt(0)
    v_mfma_f32_16x16x32_bf16 v[112:115], v[92:95], v[52:55], v[112:115]
    v_mfma_f32_16x16x32_bf16 v[96:99], v[76:79], v[52:55], v[96:99]
    v_mfma_f32_16x16x32_bf16 v[100:103], v[80:83], v[52:55], v[100:103]
    s_nop 3
    v_add_f32 v232, v232, v104
    v_add_f32 v233, v233, v105
    v_add_f32 v234, v234, v106
    v_add_f32 v235, v235, v107
    v_add_f32 v236, v236, v108
    v_add_f32 v237, v237, v109
    v_add_f32 v238, v238, v110
    v_add_f32 v239, v239, v111
    v_add_f32 v240, v240, v112
    v_add_f32 v241, v241, v113
    v_add_f32 v242, v242, v114
    v_add_f32 v243, v243, v115
    v_add_f32 v224, v224, v96
    v_add_f32 v225, v225, v97
    v_add_f32 v226, v226, v98
    v_add_f32 v227, v227, v99
    v_add_f32 v228, v228, v100
    v_add_f32 v229, v229, v101
    v_add_f32 v230, v230, v102
    v_add_f32 v231, v231, v103
L_P3_SUM:
    ds_write_b128 v252, v[232:235] offset:0
    ds_write_b128 v252, v[236:239] offset:1024
    ds_write_b128 v252, v[240:243] offset:2048
    v_sub_f32 v224, v224, v216
    v_sub_f32 v225, v225, v217
    v_sub_f32 v226, v226, v218
    v_sub_f32 v227, v227, v219
    v_sub_f32 v228, v228, v220
    v_sub_f32 v229, v229, v221
    v_sub_f32 v230, v230, v222
    v_sub_f32 v231, v231, v223
    v_sub_f32 v232, v232, v2
    v_sub_f32 v233, v233, v3
    v_sub_f32 v234, v234, v4
    v_sub_f32 v235, v235, v5
    s_waitcnt lgkmcnt(0)
    s_barrier
    ds_read_b128 v[16:19], v253 offset:0
    ds_read_b128 v[20:23], v253 offset:1024
    ds_read_b128 v[24:27], v253 offset:2048
    s_waitcnt lgkmcnt(2)
    v_add_f32 v16, v16, v224
    v_add_f32 v17, v17, v225
    v_add_f32 v18, v18, v226
    v_add_f32 v19, v19, v227
    v_fmac_f32 v216, v14, v16
    v_fmac_f32 v217, v14, v17
    v_fmac_f32 v218, v14, v18
    v_fmac_f32 v219, v14, v19
    v_cvt_pk_bf16_f32 v32, v216, v217
    v_cvt_pk_bf16_f32 v33, v218, v219
    s_waitcnt lgkmcnt(1)
    v_add_f32 v20, v20, v228
    v_add_f32 v21, v21, v229
    v_add_f32 v22, v22, v230
    v_add_f32 v23, v23, v231
    v_fmac_f32 v220, v14, v20
    v_fmac_f32 v221, v14, v21
    v_fmac_f32 v222, v14, v22
    v_fmac_f32 v223, v14, v23
    v_cvt_pk_bf16_f32 v34, v220, v221
    v_cvt_pk_bf16_f32 v35, v222, v223
    s_nop 1
    v_permlane16_swap_b32 v32, v34
    v_permlane16_swap_b32 v33, v35
    buffer_store_dwordx4 v[32:35], v15, s[32:35], 0 offen
    s_cmp_lg_u32 s60, 0
    s_cbranch_scc1 L_FIN
    s_waitcnt lgkmcnt(0)
    v_add_f32 v24, v24, v232
    v_add_f32 v25, v25, v233
    v_add_f32 v26, v26, v234
    v_add_f32 v27, v27, v235
    v_fmac_f32 v2, v14, v24
    v_fmac_f32 v3, v14, v25
    v_fmac_f32 v4, v14, v26
    v_fmac_f32 v5, v14, v27
    v_cvt_pk_bf16_f32 v36, v2, v3
    v_cvt_pk_bf16_f32 v37, v4, v5
    buffer_store_dwordx2 v[36:37], v250, s[32:35], 0 offen offset:64
L_FIN:
L_END:
    s_endpgm
L_P3_PART:
    s_cmp_eq_u32 s70, 2
    s_cbranch_scc1 L_P3_B
    s_mov_b32 s64, 0
    buffer_load_dwordx4 v[16:19], v248, s[28:31], s64 offen sc1
    s_mov_b32 s64, 131072
    buffer_load_dwordx4 v[20:23], v248, s[28:31], s64 offen sc1
    s_mov_b32 s64, 262144
    buffer_load_dwordx4 v[24:27], v248, s[28:31], s64 offen sc1
    s_mov_b32 s64, 393216
    buffer_load_dwordx4 v[28:31], v248, s[28:31], s64 offen sc1
    s_mov_b32 s64, 0
    buffer_load_dwordx2 v[32:33], v249, s[28:31], s64 offen sc1
    s_mov_b32 s64, 65536
    buffer_load_dwordx2 v[34:35], v249, s[28:31], s64 offen sc1
    ds_read_b64_tr_b16 v[36:37], v246 offset:0
    ds_read_b64_tr_b16 v[38:39], v246 offset:12800
    ds_read_b64_tr_b16 v[40:41], v246 offset:32
    ds_read_b64_tr_b16 v[42:43], v246 offset:12832
    ds_read_b64_tr_b16 v[44:45], v247 offset:64
    ds_read_b64_tr_b16 v[46:47], v247 offset:12864
    ds_read_b64_tr_b16 v[48:49], v247 offset:96
    ds_read_b64_tr_b16 v[50:51], v247 offset:12896
    ds_read_b64_tr_b16 v[52:53], v247 offset:128
    ds_read_b64_tr_b16 v[54:55], v247 offset:12928
    s_waitcnt vmcnt(5)
    v_mfma_f32_16x16x32_bf16 v[224:227], v[56:59], v[16:19], 0
    v_mfma_f32_16x16x32_bf16 v[228:231], v[60:63], v[16:19], 0
    v_mfma_f32_16x16x32_bf16 v[232:235], v[64:67], v[16:19], 0
    v_mfma_f32_16x16x32_bf16 v[236:239], v[68:71], v[16:19], 0
    v_mfma_f32_16x16x32_bf16 v[240:243], v[72:75], v[16:19], 0
    s_waitcnt vmcnt(4)
    v_mfma_f32_16x16x32_bf16 v[224:227], v[76:79], v[20:23], v[224:227]
    v_mfma_f32_16x16x32_bf16 v[228:231], v[80:83], v[20:23], v[228:231]
    v_mfma_f32_16x16x32_bf16 v[232:235], v[84:87], v[20:23], v[232:235]
    v_mfma_f32_16x16x32_bf16 v[236:239], v[88:91], v[20:23], v[236:239]
    v_mfma_f32_16x16x32_bf16 v[240:243], v[92:95], v[20:23], v[240:243]
    s_waitcnt vmcnt(3)
    v_mfma_f32_16x16x32_bf16 v[224:227], v[96:99], v[24:27], v[224:227]
    v_mfma_f32_16x16x32_bf16 v[228:231], v[100:103], v[24:27], v[228:231]
    v_mfma_f32_16x16x32_bf16 v[232:235], v[104:107], v[24:27], v[232:235]
    v_mfma_f32_16x16x32_bf16 v[236:239], v[108:111], v[24:27], v[236:239]
    v_mfma_f32_16x16x32_bf16 v[240:243], v[112:115], v[24:27], v[240:243]
    s_waitcnt vmcnt(2)
    v_mfma_f32_16x16x32_bf16 v[224:227], v[116:119], v[28:31], v[224:227]
    v_mfma_f32_16x16x32_bf16 v[228:231], v[120:123], v[28:31], v[228:231]
    v_mfma_f32_16x16x32_bf16 v[232:235], v[124:127], v[28:31], v[232:235]
    v_mfma_f32_16x16x32_bf16 v[236:239], v[128:131], v[28:31], v[236:239]
    v_mfma_f32_16x16x32_bf16 v[240:243], v[132:135], v[28:31], v[240:243]
    s_waitcnt vmcnt(0)
    s_waitcnt lgkmcnt(4)
    v_mfma_f32_16x16x32_bf16 v[232:235], v[44:47], v[32:35], v[232:235]
    s_waitcnt lgkmcnt(2)
    v_mfma_f32_16x16x32_bf16 v[236:239], v[48:51], v[32:35], v[236:239]
    s_waitcnt lgkmcnt(0)
    v_mfma_f32_16x16x32_bf16 v[240:243], v[52:55], v[32:35], v[240:243]
    v_mfma_f32_16x16x32_bf16 v[224:227], v[36:39], v[32:35], v[224:227]
    v_mfma_f32_16x16x32_bf16 v[228:231], v[40:43], v[32:35], v[228:231]
    s_nop 7
    v_mov_b32 v56, v224
    v_mov_b32 v57, v225
    v_mov_b32 v58, v226
    v_mov_b32 v59, v227
    v_mov_b32 v60, v228
    v_mov_b32 v61, v229
    v_mov_b32 v62, v230
    v_mov_b32 v63, v231
    v_mov_b32 v64, v232
    v_mov_b32 v65, v233
    v_mov_b32 v66, v234
    v_mov_b32 v67, v235
    v_mov_b32 v68, v236
    v_mov_b32 v69, v237
    v_mov_b32 v70, v238
    v_mov_b32 v71, v239
    v_mov_b32 v72, v240
    v_mov_b32 v73, v241
    v_mov_b32 v74, v242
    v_mov_b32 v75, v243
    s_mov_b32 s62, 0
    s_cmp_lg_u32 s61, 0
    s_cbranch_scc1 GN_34
GW_33:
    s_mov_b64 exec, s[98:99]
    buffer_load_dword v7, v255, s[28:31], 0 offen sc1
    s_waitcnt vmcnt(0)
    v_cmp_eq_u32 vcc, 0, v7
    s_add_u32 s62, s62, 1
    s_mov_b64 exec, -1
    s_mov_b64 s[98:99], vcc
    s_cmp_ge_u32 s62, 200000
    s_cselect_b32 s98, 0, s98
    s_and_b32 s64, s98, 0xff
    s_cselect_b32 s70, 0, 1
    s_and_b32 s64, s98, 0xff00
    s_cselect_b32 s64, 0, 2
    s_or_b32 s70, s70, s64
    s_and_b32 s64, s70, 2
    s_cbranch_scc1 GW_33P
    s_sleep 2
    s_branch GW_33
GW_33P:
    v_mov_b32 v7, s70
    ds_write_b32 v6, v7
    s_branch GD_35
GN_34:
    ds_read_b32 v7, v6
    s_waitcnt lgkmcnt(0)
    v_readfirstlane_b32 s70, v7
    s_add_u32 s62, s62, 1
    s_cmp_ge_u32 s62, 8000000
    s_cselect_b32 s70, 3, s70
    s_and_b32 s64, s70, 2
    s_cbranch_scc1 GD_35
    s_sleep 1
    s_branch GN_34
GD_35:
    s_mov_b32 s64, 524288
    buffer_load_dwordx4 v[16:19], v248, s[28:31], s64 offen sc1
    s_mov_b32 s64, 655360
    buffer_load_dwordx4 v[20:23], v248, s[28:31], s64 offen sc1
    s_mov_b32 s64, 786432
    buffer_load_dwordx4 v[24:27], v248, s[28:31], s64 offen sc1
    s_mov_b32 s64, 917504
    buffer_load_dwordx4 v[28:31], v248, s[28:31], s64 offen sc1
    s_mov_b32 s64, 131072
    buffer_load_dwordx2 v[32:33], v249, s[28:31], s64 offen sc1
    s_mov_b32 s64, 196608
    buffer_load_dwordx2 v[34:35], v249, s[28:31], s64 offen sc1
    ds_read_b64_tr_b16 v[36:37], v246 offset:25600
    ds_read_b64_tr_b16 v[38:39], v246 offset:38400
    ds_read_b64_tr_b16 v[40:41], v246 offset:25632
    ds_read_b64_tr_b16 v[42:43], v246 offset:38432
    ds_read_b64_tr_b16 v[44:45], v247 offset:25664
    ds_read_b64_tr_b16 v[46:47], v247 offset:38464
    ds_read_b64_tr_b16 v[48:49], v247 offset:25696
    ds_read_b64_tr_b16 v[50:51], v247 offset:38496
    ds_read_b64_tr_b16 v[52:53], v247 offset:25728
    ds_read_b64_tr_b16 v[54:55], v247 offset:38528
    s_waitcnt vmcnt(5)
    v_mfma_f32_16x16x32_bf16 v[224:227], v[136:139], v[16:19], 0
    v_mfma_f32_16x16x32_bf16 v[228:231], v[140:143], v[16:19], 0
    v_mfma_f32_16x16x32_bf16 v[232:235], v[144:147], v[16:19], 0
    v_mfma_f32_16x16x32_bf16 v[236:239], v[148:151], v[16:19], 0
    v_mfma_f32_16x16x32_bf16 v[240:243], v[152:155], v[16:19], 0
    s_waitcnt vmcnt(4)
    v_mfma_f32_16x16x32_bf16 v[224:227], v[156:159], v[20:23], v[224:227]
    v_mfma_f32_16x16x32_bf16 v[228:231], v[160:163], v[20:23], v[228:231]
    v_mfma_f32_16x16x32_bf16 v[232:235], v[164:167], v[20:23], v[232:235]
    v_mfma_f32_16x16x32_bf16 v[236:239], v[168:171], v[20:23], v[236:239]
    v_mfma_f32_16x16x32_bf16 v[240:243], v[172:175], v[20:23], v[240:243]
    s_waitcnt vmcnt(3)
    v_mfma_f32_16x16x32_bf16 v[224:227], v[176:179], v[24:27], v[224:227]
    v_mfma_f32_16x16x32_bf16 v[228:231], v[180:183], v[24:27], v[228:231]
    v_mfma_f32_16x16x32_bf16 v[232:235], v[184:187], v[24:27], v[232:235]
    v_mfma_f32_16x16x32_bf16 v[236:239], v[188:191], v[24:27], v[236:239]
    v_mfma_f32_16x16x32_bf16 v[240:243], v[192:195], v[24:27], v[240:243]
    s_waitcnt vmcnt(2)
    v_mfma_f32_16x16x32_bf16 v[224:227], v[196:199], v[28:31], v[224:227]
    v_mfma_f32_16x16x32_bf16 v[228:231], v[200:203], v[28:31], v[228:231]
    v_mfma_f32_16x16x32_bf16 v[232:235], v[204:207], v[28:31], v[232:235]
    v_mfma_f32_16x16x32_bf16 v[236:239], v[208:211], v[28:31], v[236:239]
    v_mfma_f32_16x16x32_bf16 v[240:243], v[212:215], v[28:31], v[240:243]
    s_waitcnt vmcnt(0)
    s_waitcnt lgkmcnt(4)
    v_mfma_f32_16x16x32_bf16 v[232:235], v[44:47], v[32:35], v[232:235]
    s_waitcnt lgkmcnt(2)
    v_mfma_f32_16x16x32_bf16 v[236:239], v[48:51], v[32:35], v[236:239]
    s_waitcnt lgkmcnt(0)
    v_mfma_f32_16x16x32_bf16 v[240:243], v[52:55], v[32:35], v[240:243]
    v_mfma_f32_16x16x32_bf16 v[224:227], v[36:39], v[32:35], v[224:227]
    v_mfma_f32_16x16x32_bf16 v[228:231], v[40:43], v[32:35], v[228:231]
    s_nop 3
    v_add_f32 v232, v232, v64
    v_add_f32 v233, v233, v65
    v_add_f32 v234, v234, v66
    v_add_f32 v235, v235, v67
    v_add_f32 v236, v236, v68
    v_add_f32 v237, v237, v69
    v_add_f32 v238, v238, v70
    v_add_f32 v239, v239, v71
    v_add_f32 v240, v240, v72
    v_add_f32 v241, v241, v73
    v_add_f32 v242, v242, v74
    v_add_f32 v243, v243, v75
    v_add_f32 v224, v224, v56
    v_add_f32 v225, v225, v57
    v_add_f32 v226, v226, v58
    v_add_f32 v227, v227, v59
    v_add_f32 v228, v228, v60
    v_add_f32 v229, v229, v61
    v_add_f32 v230, v230, v62
    v_add_f32 v231, v231, v63
    s_branch L_P3_SUM
L_P3_B:
    s_mov_b32 s64, 524288
    buffer_load_dwordx4 v[16:19], v248, s[28:31], s64 offen sc1
    s_mov_b32 s64, 655360
    buffer_load_dwordx4 v[20:23], v248, s[28:31], s64 offen sc1
    s_mov_b32 s64, 786432
    buffer_load_dwordx4 v[24:27], v248, s[28:31], s64 offen sc1
    s_mov_b32 s64, 917504
    buffer_load_dwordx4 v[28:31], v248, s[28:31], s64 offen sc1
    s_mov_b32 s64, 131072
    buffer_load_dwordx2 v[32:33], v249, s[28:31], s64 offen sc1
    s_mov_b32 s64, 196608
    buffer_load_dwordx2 v[34:35], v249, s[28:31], s64 offen sc1
    ds_read_b64_tr_b16 v[36:37], v246 offset:25600
    ds_read_b64_tr_b16 v[38:39], v246 offset:38400
    ds_read_b64_tr_b16 v[40:41], v246 offset:25632
    ds_read_b64_tr_b16 v[42:43], v246 offset:38432
    ds_read_b64_tr_b16 v[44:45], v247 offset:25664
    ds_read_b64_tr_b16 v[46:47], v247 offset:38464
    ds_read_b64_tr_b16 v[48:49], v247 offset:25696
    ds_read_b64_tr_b16 v[50:51], v247 offset:38496
    ds_read_b64_tr_b16 v[52:53], v247 offset:25728
    ds_read_b64_tr_b16 v[54:55], v247 offset:38528
    s_waitcnt vmcnt(5)
    v_mfma_f32_16x16x32_bf16 v[224:227], v[136:139], v[16:19], 0
    v_mfma_f32_16x16x32_bf16 v[228:231], v[140:143], v[16:19], 0
    v_mfma_f32_16x16x32_bf16 v[232:235], v[144:147], v[16:19], 0
    v_mfma_f32_16x16x32_bf16 v[236:239], v[148:151], v[16:19], 0
    v_mfma_f32_16x16x32_bf16 v[240:243], v[152:155], v[16:19], 0
    s_waitcnt vmcnt(4)
    v_mfma_f32_16x16x32_bf16 v[224:227], v[156:159], v[20:23], v[224:227]
    v_mfma_f32_16x16x32_bf16 v[228:231], v[160:163], v[20:23], v[228:231]
    v_mfma_f32_16x16x32_bf16 v[232:235], v[164:167], v[20:23], v[232:235]
    v_mfma_f32_16x16x32_bf16 v[236:239], v[168:171], v[20:23], v[236:239]
    v_mfma_f32_16x16x32_bf16 v[240:243], v[172:175], v[20:23], v[240:243]
    s_waitcnt vmcnt(3)
    v_mfma_f32_16x16x32_bf16 v[224:227], v[176:179], v[24:27], v[224:227]
    v_mfma_f32_16x16x32_bf16 v[228:231], v[180:183], v[24:27], v[228:231]
    v_mfma_f32_16x16x32_bf16 v[232:235], v[184:187], v[24:27], v[232:235]
    v_mfma_f32_16x16x32_bf16 v[236:239], v[188:191], v[24:27], v[236:239]
    v_mfma_f32_16x16x32_bf16 v[240:243], v[192:195], v[24:27], v[240:243]
    s_waitcnt vmcnt(2)
    v_mfma_f32_16x16x32_bf16 v[224:227], v[196:199], v[28:31], v[224:227]
    v_mfma_f32_16x16x32_bf16 v[228:231], v[200:203], v[28:31], v[228:231]
    v_mfma_f32_16x16x32_bf16 v[232:235], v[204:207], v[28:31], v[232:235]
    v_mfma_f32_16x16x32_bf16 v[236:239], v[208:211], v[28:31], v[236:239]
    v_mfma_f32_16x16x32_bf16 v[240:243], v[212:215], v[28:31], v[240:243]
    s_waitcnt vmcnt(0)
    s_waitcnt lgkmcnt(4)
    v_mfma_f32_16x16x32_bf16 v[232:235], v[44:47], v[32:35], v[232:235]
    s_waitcnt lgkmcnt(2)
    v_mfma_f32_16x16x32_bf16 v[236:239], v[48:51], v[32:35], v[236:239]
    s_waitcnt lgkmcnt(0)
    v_mfma_f32_16x16x32_bf16 v[240:243], v[52:55], v[32:35], v[240:243]
    v_mfma_f32_16x16x32_bf16 v[224:227], v[36:39], v[32:35], v[224:227]
    v_mfma_f32_16x16x32_bf16 v[228:231], v[40:43], v[32:35], v[228:231]
    s_nop 7
    v_mov_b32 v136, v224
    v_mov_b32 v137, v225
    v_mov_b32 v138, v226
    v_mov_b32 v139, v227
    v_mov_b32 v140, v228
    v_mov_b32 v141, v229
    v_mov_b32 v142, v230
    v_mov_b32 v143, v231
    v_mov_b32 v144, v232
    v_mov_b32 v145, v233
    v_mov_b32 v146, v234
    v_mov_b32 v147, v235
    v_mov_b32 v148, v236
    v_mov_b32 v149, v237
    v_mov_b32 v150, v238
    v_mov_b32 v151, v239
    v_mov_b32 v152, v240
    v_mov_b32 v153, v241
    v_mov_b32 v154, v242
    v_mov_b32 v155, v243
    s_mov_b32 s62, 0
    s_cmp_lg_u32 s61, 0
    s_cbranch_scc1 GN_37
GW_36:
    s_mov_b64 exec, s[98:99]
    buffer_load_dword v7, v255, s[28:31], 0 offen sc1
    s_waitcnt vmcnt(0)
    v_cmp_eq_u32 vcc, 0, v7
    s_add_u32 s62, s62, 1
    s_mov_b64 exec, -1
    s_mov_b64 s[98:99], vcc
    s_cmp_ge_u32 s62, 200000
    s_cselect_b32 s98, 0, s98
    s_and_b32 s64, s98, 0xff
    s_cselect_b32 s70, 0, 1
    s_and_b32 s64, s98, 0xff00
    s_cselect_b32 s64, 0, 2
    s_or_b32 s70, s70, s64
    s_and_b32 s64, s70, 1
    s_cbranch_scc1 GW_36P
    s_sleep 2
    s_branch GW_36
GW_36P:
    v_mov_b32 v7, s70
    ds_write_b32 v6, v7
    s_branch GD_38
GN_37:
    ds_read_b32 v7, v6
    s_waitcnt lgkmcnt(0)
    v_readfirstlane_b32 s70, v7
    s_add_u32 s62, s62, 1
    s_cmp_ge_u32 s62, 8000000
    s_cselect_b32 s70, 3, s70
    s_and_b32 s64, s70, 1
    s_cbranch_scc1 GD_38
    s_sleep 1
    s_branch GN_37
GD_38:
    s_mov_b32 s64, 0
    buffer_load_dwordx4 v[16:19], v248, s[28:31], s64 offen sc1
    s_mov_b32 s64, 131072
    buffer_load_dwordx4 v[20:23], v248, s[28:31], s64 offen sc1
    s_mov_b32 s64, 262144
    buffer_load_dwordx4 v[24:27], v248, s[28:31], s64 offen sc1
    s_mov_b32 s64, 393216
    buffer_load_dwordx4 v[28:31], v248, s[28:31], s64 offen sc1
    s_mov_b32 s64, 0
    buffer_load_dwordx2 v[32:33], v249, s[28:31], s64 offen sc1
    s_mov_b32 s64, 65536
    buffer_load_dwordx2 v[34:35], v249, s[28:31], s64 offen sc1
    ds_read_b64_tr_b16 v[36:37], v246 offset:0
    ds_read_b64_tr_b16 v[38:39], v246 offset:12800
    ds_read_b64_tr_b16 v[40:41], v246 offset:32
    ds_read_b64_tr_b16 v[42:43], v246 offset:12832
    ds_read_b64_tr_b16 v[44:45], v247 offset:64
    ds_read_b64_tr_b16 v[46:47], v247 offset:12864
    ds_read_b64_tr_b16 v[48:49], v247 offset:96
    ds_read_b64_tr_b16 v[50:51], v247 offset:12896
    ds_read_b64_tr_b16 v[52:53], v247 offset:128
    ds_read_b64_tr_b16 v[54:55], v247 offset:12928
    s_waitcnt vmcnt(5)
    v_mfma_f32_16x16x32_bf16 v[224:227], v[56:59], v[16:19], 0
    v_mfma_f32_16x16x32_bf16 v[228:231], v[60:63], v[16:19], 0
    v_mfma_f32_16x16x32_bf16 v[232:235], v[64:67], v[16:19], 0
    v_mfma_f32_16x16x32_bf16 v[236:239], v[68:71], v[16:19], 0
    v_mfma_f32_16x16x32_bf16 v[240:243], v[72:75], v[16:19], 0
    s_waitcnt vmcnt(4)
    v_mfma_f32_16x16x32_bf16 v[224:227], v[76:79], v[20:23], v[224:227]
    v_mfma_f32_16x16x32_bf16 v[228:231], v[80:83], v[20:23], v[228:231]
    v_mfma_f32_16x16x32_bf16 v[232:235], v[84:87], v[20:23], v[232:235]
    v_mfma_f32_16x16x32_bf16 v[236:239], v[88:91], v[20:23], v[236:239]
    v_mfma_f32_16x16x32_bf16 v[240:243], v[92:95], v[20:23], v[240:243]
    s_waitcnt vmcnt(3)
    v_mfma_f32_16x16x32_bf16 v[224:227], v[96:99], v[24:27], v[224:227]
    v_mfma_f32_16x16x32_bf16 v[228:231], v[100:103], v[24:27], v[228:231]
    v_mfma_f32_16x16x32_bf16 v[232:235], v[104:107], v[24:27], v[232:235]
    v_mfma_f32_16x16x32_bf16 v[236:239], v[108:111], v[24:27], v[236:239]
    v_mfma_f32_16x16x32_bf16 v[240:243], v[112:115], v[24:27], v[240:243]
    s_waitcnt vmcnt(2)
    v_mfma_f32_16x16x32_bf16 v[224:227], v[116:119], v[28:31], v[224:227]
    v_mfma_f32_16x16x32_bf16 v[228:231], v[120:123], v[28:31], v[228:231]
    v_mfma_f32_16x16x32_bf16 v[232:235], v[124:127], v[28:31], v[232:235]
    v_mfma_f32_16x16x32_bf16 v[236:239], v[128:131], v[28:31], v[236:239]
    v_mfma_f32_16x16x32_bf16 v[240:243], v[132:135], v[28:31], v[240:243]
    s_waitcnt vmcnt(0)
    s_waitcnt lgkmcnt(4)
    v_mfma_f32_16x16x32_bf16 v[232:235], v[44:47], v[32:35], v[232:235]
    s_waitcnt lgkmcnt(2)
    v_mfma_f32_16x16x32_bf16 v[236:239], v[48:51], v[32:35], v[236:239]
    s_waitcnt lgkmcnt(0)
    v_mfma_f32_16x16x32_bf16 v[240:243], v[52:55], v[32:35], v[240:243]
    v_mfma_f32_16x16x32_bf16 v[224:227], v[36:39], v[32:35], v[224:227]
    v_mfma_f32_16x16x32_bf16 v[228:231], v[40:43], v[32:35], v[228:231]
    s_nop 3
    v_add_f32 v232, v232, v144
    v_add_f32 v233, v233, v145
    v_add_f32 v234, v234, v146
    v_add_f32 v235, v235, v147
    v_add_f32 v236, v236, v148
    v_add_f32 v237, v237, v149
    v_add_f32 v238, v238, v150
    v_add_f32 v239, v239, v151
    v_add_f32 v240, v240, v152
    v_add_f32 v241, v241, v153
    v_add_f32 v242, v242, v154
    v_add_f32 v243, v243, v155
    v_add_f32 v224, v224, v136
    v_add_f32 v225, v225, v137
    v_add_f32 v226, v226, v138
    v_add_f32 v227, v227, v139
    v_add_f32 v228, v228, v140
    v_add_f32 v229, v229, v141
    v_add_f32 v230, v230, v142
    v_add_f32 v231, v231, v143
    s_branch L_P3_SUM
L_SETUP:
    s_cmp_ge_u32 s49, 30
    s_cselect_b32 s93, 1, 10
    s_mov_b32 s94, 0
    s_lshr_b32 s64, s49, 3
    s_lshl_b32 s65, s48, 2
    s_add_u32 s56, s64, s65
    s_and_b32 s57, s49, 7
    s_lshr_b32 s60, s3, 2
    s_and_b32 s61, s3, 3
    s_mov_b32 s63, 0
    s_mov_b32 s74, 0x000fffff
    s_mov_b32 s75, 0x000fffff
    s_mov_b32 s72, 0x11000000
    s_mov_b32 s73, 0x11000000
    v_mov_b32 v192, 0x3f803f80
    v_cndmask_b32 v240, 0, v192, s[72:73]
    v_mov_b32 v224, 0xdddddddd
    v_lshlrev_b32 v225, 4, v0
    v_lshlrev_b32 v228, 4, v0
    v_lshlrev_b32 v192, 3, v0
    v_add_u32 v226, 2048, v192
    v_and_b32 v193, 31, v0
    v_lshrrev_b32 v194, 5, v0
    v_mul_u32_u24 v194, 320, v194
    v_lshl_add_u32 v194, v193, 4, v194
    v_add_u32 v227, 2560, v194
    s_mul_i32 s64, s60, 5120
    v_add_u32 v225, s64, v225
    v_add_u32 v226, s64, v226
    v_add_u32 v227, s64, v227
    s_mul_i32 s64, s61, 2560
    s_add_u32 s64, s64, 81920
    s_lshl_b32 s66, s60, 10
    s_add_u32 s66, s66, s64
    v_add_u32 v229, s66, v228
    s_lshl_b32 s65, s60, 8
    s_add_u32 s65, s65, s64
    v_lshl_add_u32 v230, v193, 3, s65
    s_xor_b32 s67, s60, 1
    s_lshl_b32 s66, s67, 10
    s_add_u32 s66, s66, s64
    v_add_u32 v242, s66, v228
    s_lshl_b32 s65, s67, 8
    s_add_u32 s65, s65, s64
    v_lshl_add_u32 v243, v193, 3, s65
    s_mul_i32 s87, s56, 163840
    s_mul_i32 s88, s3, 5120
    s_add_u32 s97, s88, s87
    s_lshl_b32 s64, s56, 16
    s_lshl_b32 s65, s57, 2
    s_add_u32 s65, s65, s61
    s_lshl_b32 s65, s65, 1
    s_add_u32 s65, s65, s60
    s_lshl_b32 s66, s65, 10
    s_add_u32 s64, s64, s66
    s_add_u32 s89, s64, 0xc80000
    s_lshl_b32 s66, s56, 14
    s_lshl_b32 s65, s65, 8
    s_add_u32 s65, s65, s66
    s_add_u32 s90, s65, 0xe80000
    s_lshl_b32 s64, s57, 11
    s_lshl_b32 s65, s56, 6
    s_add_u32 s64, s64, s65
    s_add_u32 s91, s64, 0xf08000
    s_mul_i32 s64, s57, 320
    s_add_u32 s64, s64, 0xf0c000
    v_lshl_add_u32 v231, v0, 3, s64
    s_lshr_b32 s64, s56, 1
    s_lshl_b32 s64, s64, 6
    s_add_u32 s64, s64, 0xf0d000
    v_mov_b32 v192, s64
    s_mov_b32 s72, 0
    s_mov_b32 s73, 0xffffff00
    v_cndmask_b32 v231, v231, v192, s[72:73]
    s_mul_i32 s64, s3, 832
    s_mul_i32 s65, s57, 160
    s_add_u32 s66, s64, 0
    v_add_u32 v192, s66, v0
    v_mul_u32_u24 v193, 52429, v192
    v_lshrrev_b32 v193, 19, v193
    v_mul_u32_u24 v193, 1120, v193
    v_lshl_add_u32 v193, v192, 4, v193
    v_add_u32 v233, s65, v193
    s_add_u32 s66, s64, 64
    v_add_u32 v192, s66, v0
    v_mul_u32_u24 v193, 52429, v192
    v_lshrrev_b32 v193, 19, v193
    v_mul_u32_u24 v193, 1120, v193
    v_lshl_add_u32 v193, v192, 4, v193
    v_add_u32 v234, s65, v193
    s_add_u32 s66, s64, 128
    v_add_u32 v192, s66, v0
    v_mul_u32_u24 v193, 52429, v192
    v_lshrrev_b32 v193, 19, v193
    v_mul_u32_u24 v193, 1120, v193
    v_lshl_add_u32 v193, v192, 4, v193
    v_add_u32 v235, s65, v193
    s_add_u32 s66, s64, 192
    v_add_u32 v192, s66, v0
    v_mul_u32_u24 v193, 52429, v192
    v_lshrrev_b32 v193, 19, v193
    v_mul_u32_u24 v193, 1120, v193
    v_lshl_add_u32 v193, v192, 4, v193
    v_add_u32 v236, s65, v193
    s_add_u32 s66, s64, 256
    v_add_u32 v192, s66, v0
    v_mul_u32_u24 v193, 52429, v192
    v_lshrrev_b32 v193, 19, v193
    v_mul_u32_u24 v193, 1120, v193
    v_lshl_add_u32 v193, v192, 4, v193
    v_add_u32 v237, s65, v193
    s_mul_i32 s64, s57, 80
    s_mul_i32 s65, s3, 10
    s_add_u32 s64, s64, s65
    v_lshrrev_b32 v192, 3, v0
    v_add_u32 v192, s64, v192
    v_lshlrev_b32 v192, 12, v192
    v_and_b32 v193, 7, v0
    v_lshl_add_u32 v192, v193, 4, v192
    s_lshl_b32 s64, s56, 7
    s_add_u32 s64, s64, 0xa00000
    v_add_u32 v232, s64, v192
    v_lshrrev_b32 v192, 4, v0
    v_lshrrev_b32 v193, 2, v0
    v_and_b32 v193, 3, v193
    v_and_b32 v194, 3, v0
    v_lshlrev_b32 v194, 3, v194
    v_and_b32 v195, 15, v0
    v_and_b32 v196, 1, v192
    s_mul_i32 s66, s60, 51296
    s_mul_i32 s67, s60, 51136
    v_lshrrev_b32 v197, 1, v192
    v_mul_u32_u24 v197, 20, v197
    v_lshl_add_u32 v197, v196, 2, v197
    v_add_u32 v197, v197, v193
    v_mul_u32_u24 v197, 160, v197
    v_add_u32 v197, v197, v194
    v_add_u32 v244, s66, v197
    v_add_u32 v245, s67, v197
    v_mul_u32_u24 v197, 20, v192
    v_add3_u32 v197, v197, v193, 16
    v_mul_u32_u24 v197, 160, v197
    v_add_u32 v197, v197, v194
    v_add_u32 v246, s66, v197
    v_add_u32 v247, s67, v197
    s_lshl_b32 s66, s60, 20
    s_lshl_b32 s67, s56, 11
    s_add_u32 s66, s66, s67
    s_lshr_b32 s67, s61, 1
    s_lshl_b32 s68, s67, 10
    s_add_u32 s66, s66, s68
    s_and_b32 s68, s61, 1
    s_lshl_b32 s68, s68, 8
    s_add_u32 s66, s66, s68
    s_add_u32 s66, s66, 0xc80000
    v_lshrrev_b32 v197, 1, v192
    v_lshlrev_b32 v197, 16, v197
    v_lshl_add_u32 v197, v196, 9, v197
    v_lshl_add_u32 v197, v195, 4, v197
    v_add_u32 v248, s66, v197
    s_lshl_b32 s66, s60, 18
    s_lshl_b32 s68, s56, 9
    s_add_u32 s66, s66, s68
    s_lshl_b32 s68, s61, 7
    s_add_u32 s66, s66, s68
    s_add_u32 s66, s66, 0xe80000
    v_lshlrev_b32 v197, 14, v192
    v_lshl_add_u32 v197, v195, 3, v197
    v_add_u32 v249, s66, v197
    s_lshr_b32 s66, s56, 2
    s_lshl_b32 s66, s66, 11
    s_add_u32 s66, s66, 0xf08000
    s_lshl_b32 s67, s60, 10
    s_add_u32 s66, s66, s67
    v_lshl_add_u32 v255, v195, 6, s66
    s_lshl_b32 s64, s56, 6
    s_lshl_b32 s65, s61, 4
    s_add_u32 s64, s64, s65
    v_add_u32 v197, s64, v195
    v_lshlrev_b32 v251, 2, v197
    v_add_u32 v251, 0xf0e000, v251
    v_mul_u32_u24 v197, 1280, v197
    v_lshl_add_u32 v197, v192, 3, v197
    s_mul_i32 s64, s57, 160
    s_mul_i32 s65, s60, 96
    s_add_u32 s64, s64, s65
    v_add_u32 v250, s64, v197
    s_lshl_b32 s64, s3, 12
    s_add_u32 s64, s64, 112640
    v_add_u32 v252, s64, v228
    s_xor_b32 s64, s3, 4
    s_lshl_b32 s64, s64, 12
    s_add_u32 s65, s64, 112640
    v_add_u32 v241, s65, v228
    s_lshl_b32 s65, s60, 10
    s_add_u32 s65, s65, s64
    s_add_u32 s65, s65, 112640
    v_add_u32 v253, s65, v228
    v_lshl_add_u32 v254, v192, 2, v193
    v_lshl_add_u32 v254, v254, 7, v194
    s_mul_i32 s64, s60, 6144
    s_lshl_b32 s65, s61, 5
    s_add_u32 s64, s64, s65
    s_add_u32 s64, s64, 102400
    v_add_u32 v254, s64, v254
    s_setpc_b64 s[52:53]
L_SIDE:
    s_cmp_ge_u32 s49, 30
    s_cbranch_scc1 L_S_NT
    s_lshr_b32 s64, s58, 1
    s_lshl_b32 s78, s100, 1
    s_add_u32 s78, s78, s64
    s_mov_b32 s71, 162048
    s_cmp_lg_u32 s3, 6
    s_cbranch_scc1 L_S_GO
    s_cmp_lt_u32 s95, 32
    s_cselect_b32 s65, s55, 0
    s_cmp_lg_u32 s65, 2
    s_cbranch_scc1 L_W6
    s_add_u32 s78, s95, 608
    s_add_u32 s100, s95, 256
    s_mov_b32 s101, 1
    s_mov_b32 s71, 162056
L_S_GO:
    s_and_b32 s64, s78, 63
    s_lshr_b32 s65, s78, 6
    s_lshl_b32 s69, s100, 6
    s_add_u32 s69, s69, 0xfa0000
    s_lshl_b32 s64, s64, 5
    s_lshl_b32 s65, s65, 7
    v_lshrrev_b32 v16, 3, v0
    v_and_b32 v17, 7, v0
    v_lshl_add_u32 v16, v16, 2, s64
    v_lshl_add_u32 v18, v17, 4, s65
    v_mul_u32_u24 v19, 1280, v16
    v_add_u32 v11, v19, v18
    v_subrev_u32 v10, 3840, v11
    v_lshlrev_b32 v12, 2, v18
    v_lshlrev_b32 v18, 11, v18
    v_lshlrev_b32 v16, 1, v16
    v_sub_u32 v18, v18, v16
    v_add_u32 v13, 0x780ff8, v18
    s_waitcnt lgkmcnt(0)
    s_mov_b32 s40, s12
    s_mov_b32 s41, s13
    s_mov_b32 s42, 0x280000
    s_mov_b32 s43, 0x20000
    s_mov_b32 s44, s14
    s_mov_b32 s45, s15
    s_mov_b32 s46, 0x280000
    s_mov_b32 s47, 0x20000
    s_mov_b32 s36, s16
    s_mov_b32 s37, s17
    s_mov_b32 s38, 0x1400
    s_mov_b32 s39, 0x20000
    buffer_load_dwordx4 v[28:31], v11, s[40:43], 0 offen offset:0 nt
    buffer_load_dwordx4 v[32:35], v11, s[40:43], 0 offen offset:1280 nt
    buffer_load_dwordx4 v[36:39], v11, s[40:43], 0 offen offset:2560 nt
    buffer_load_dwordx4 v[40:43], v11, s[40:43], 0 offen offset:3840 nt
    buffer_load_dwordx4 v[176:179], v11, s[44:47], 0 offen offset:0 nt
    buffer_load_dwordx4 v[180:183], v11, s[44:47], 0 offen offset:1280 nt
    buffer_load_dwordx4 v[184:187], v11, s[44:47], 0 offen offset:2560 nt
    buffer_load_dwordx4 v[188:191], v11, s[44:47], 0 offen offset:3840 nt
    buffer_load_dwordx4 v[16:19], v10, s[40:43], 0 offen offset:0 nt
    buffer_load_dwordx4 v[20:23], v10, s[40:43], 0 offen offset:1280 nt
    buffer_load_dwordx4 v[24:27], v10, s[40:43], 0 offen offset:2560 nt
    buffer_load_dwordx4 v[116:119], v12, s[36:39], 0 offen offset:0
    buffer_load_dwordx4 v[120:123], v12, s[36:39], 0 offen offset:16
    buffer_load_dwordx4 v[124:127], v12, s[36:39], 0 offen offset:32
    buffer_load_dwordx4 v[128:131], v12, s[36:39], 0 offen offset:48
    s_cmp_ge_u32 s58, s55
    s_cbranch_scc1 H7_39
    s_min_u32 s64, s58, 2
    s_add_u32 s59, s54, s64
    s_min_u32 s59, s59, 639
    s_mul_i32 s64, s64, 21248
    s_add_u32 s70, s64, 98304
    s_lshl_b32 s65, s59, 1
    v_mov_b32 v156, s65
    s_lshl_b32 s65, s59, 12
    v_lshl_add_u32 v14, v0, 4, s65
    v_lshl_add_u32 v15, v0, 4, s70
    s_mov_b32 s44, s18
    s_mov_b32 s45, s19
    s_mov_b32 s46, 0x280000
    s_mov_b32 s47, 0x20000
    s_mov_b32 m0, s70
    s_nop 0
    buffer_load_dwordx4 v14, s[44:47], 0 offen offset:0 nt lds
    buffer_load_dwordx4 v14, s[44:47], 0 offen offset:1024 nt lds
    buffer_load_dwordx4 v14, s[44:47], 0 offen offset:2048 nt lds
    buffer_load_dwordx4 v14, s[44:47], 0 offen offset:3072 nt lds
    s_mov_b32 s40, s20
    s_mov_b32 s41, s21
    s_mov_b32 s42, 0x500
    s_mov_b32 s43, 0x20000
    buffer_load_ushort v156, v156, s[40:43], 0 offen
H7_39:
    s_mov_b32 s28, s10
    s_mov_b32 s29, s11
    s_mov_b32 s30, 0x1000000
    s_mov_b32 s31, 0x20000
    s_call_b64 s[52:53], L_SETUP
    v_mov_b32 v44, 162048
    v_mov_b32 v46, 0
    v_mov_b32 v47, 0
    ds_write_b64 v44, v[46:47]
    ds_write_b64 v44, v[46:47] offset:8
    ds_write_b32 v44, v46 offset:16
    v_and_b32 v46, 1, v0
    v_lshlrev_b32 v46, 7, v46
    s_waitcnt lgkmcnt(0)
    s_mul_i32 s64, s58, 21248
    s_add_u32 s64, s64, 106624
    s_cmp_eq_u32 s3, 7
    s_cselect_b32 s64, 114944, s64
    v_and_b32 v76, 7, v0
    v_lshrrev_b32 v77, 3, v0
    v_sub_u32 v77, 7, v77
    v_lshrrev_b32 v78, 1, v77
    v_xor_b32 v78, v78, v76
    v_lshlrev_b32 v78, 4, v78
    v_and_b32 v77, 1, v77
    v_lshl_add_u32 v78, v77, 3, v78
    v_lshl_add_u32 v78, v76, 9, v78
    v_add_u32 v10, s64, v78
    v_xor_b32 v12, 64, v10
    v_lshrrev_b32 v76, 5, v0
    v_and_b32 v77, 31, v0
    v_xor_b32 v77, v77, v76
    v_lshlrev_b32 v77, 4, v77
    v_lshl_add_u32 v76, v76, 9, v77
    v_add_u32 v11, s64, v76
    s_lshr_b32 s65, s78, 6
    s_lshl_b32 s65, s65, 18
    s_and_b32 s64, s78, 63
    s_lshl_b32 s64, s64, 6
    s_sub_u32 s65, s65, s64
    s_add_u32 s65, s65, 0x780fc0
    v_lshrrev_b32 v76, 2, v0
    v_lshlrev_b32 v76, 12, v76
    v_and_b32 v77, 3, v0
    v_lshl_add_u32 v76, v77, 4, v76
    v_add_u32 v13, s65, v76
    s_cmp_ge_u32 s94, s93
    s_cbranch_scc1 NB_40
    s_barrier
    s_add_u32 s94, s94, 1
NB_40:
EW_41:
    s_mov_b32 s65, 1
EX_42:
    s_getreg_b32 s64, hwreg(HW_REG_IB_STS)
    s_and_b32 s64, s64, 0x00c0000f
    s_cbranch_scc0 EWD_43
    s_cmp_ge_u32 s94, s93
    s_cbranch_scc1 EWD_43
    s_barrier
    s_add_u32 s94, s94, 1
    s_branch EW_41
EWD_43:
    s_waitcnt vmcnt(0)
    v_lshlrev_b32 v76, 16, v16
    v_and_b32 v77, 0xffff0000, v16
    v_lshlrev_b32 v78, 16, v20
    v_and_b32 v79, 0xffff0000, v20
    v_lshlrev_b32 v80, 16, v24
    v_and_b32 v81, 0xffff0000, v24
    v_lshlrev_b32 v82, 16, v28
    v_and_b32 v83, 0xffff0000, v28
    v_lshlrev_b32 v84, 16, v32
    v_and_b32 v85, 0xffff0000, v32
    v_lshlrev_b32 v86, 16, v36
    v_and_b32 v87, 0xffff0000, v36
    v_lshlrev_b32 v88, 16, v40
    v_and_b32 v89, 0xffff0000, v40
    v_lshlrev_b32 v90, 16, v176
    v_and_b32 v91, 0xffff0000, v176
    v_lshlrev_b32 v92, 16, v180
    v_and_b32 v93, 0xffff0000, v180
    v_lshlrev_b32 v94, 16, v184
    v_and_b32 v95, 0xffff0000, v184
    v_lshlrev_b32 v96, 16, v188
    v_and_b32 v97, 0xffff0000, v188
    v_lshlrev_b32 v98, 16, v116
    v_lshlrev_b32 v99, 16, v118
    v_and_b32 v100, 0xffff0000, v116
    v_and_b32 v101, 0xffff0000, v118
    v_lshlrev_b32 v102, 16, v117
    v_lshlrev_b32 v103, 16, v119
    v_and_b32 v104, 0xffff0000, v117
    v_and_b32 v105, 0xffff0000, v119
    v_pk_mul_f32 v[106:107], v[76:77], v[104:105]
    v_pk_mul_f32 v[108:109], v[78:79], v[104:105]
    v_pk_mul_f32 v[110:111], v[80:81], v[104:105]
    v_pk_mul_f32 v[112:113], v[82:83], v[104:105]
    v_pk_fma_f32 v[106:107], v[78:79], v[102:103], v[106:107]
    v_pk_fma_f32 v[108:109], v[80:81], v[102:103], v[108:109]
    v_pk_fma_f32 v[110:111], v[82:83], v[102:103], v[110:111]
    v_pk_fma_f32 v[112:113], v[84:85], v[102:103], v[112:113]
    v_pk_fma_f32 v[106:107], v[80:81], v[100:101], v[106:107]
    v_pk_fma_f32 v[108:109], v[82:83], v[100:101], v[108:109]
    v_pk_fma_f32 v[110:111], v[84:85], v[100:101], v[110:111]
    v_pk_fma_f32 v[112:113], v[86:87], v[100:101], v[112:113]
    v_pk_fma_f32 v[106:107], v[82:83], v[98:99], v[106:107]
    v_pk_fma_f32 v[108:109], v[84:85], v[98:99], v[108:109]
    v_pk_fma_f32 v[110:111], v[86:87], v[98:99], v[110:111]
    v_pk_fma_f32 v[112:113], v[88:89], v[98:99], v[112:113]
    v_pk_mul_f32 v[106:107], v[106:107], v[90:91]
    v_pk_mul_f32 v[108:109], v[108:109], v[92:93]
    v_pk_mul_f32 v[110:111], v[110:111], v[94:95]
    v_pk_mul_f32 v[112:113], v[112:113], v[96:97]
    v_cvt_pk_bf16_f32 v160, v112, v110
    v_cvt_pk_bf16_f32 v161, v108, v106
    v_cvt_pk_bf16_f32 v162, v113, v111
    v_cvt_pk_bf16_f32 v163, v109, v107
    v_lshlrev_b32 v76, 16, v17
    v_and_b32 v77, 0xffff0000, v17
    v_lshlrev_b32 v78, 16, v21
    v_and_b32 v79, 0xffff0000, v21
    v_lshlrev_b32 v80, 16, v25
    v_and_b32 v81, 0xffff0000, v25
    v_lshlrev_b32 v82, 16, v29
    v_and_b32 v83, 0xffff0000, v29
    v_lshlrev_b32 v84, 16, v33
    v_and_b32 v85, 0xffff0000, v33
    v_lshlrev_b32 v86, 16, v37
    v_and_b32 v87, 0xffff0000, v37
    v_lshlrev_b32 v88, 16, v41
    v_and_b32 v89, 0xffff0000, v41
    v_lshlrev_b32 v90, 16, v177
    v_and_b32 v91, 0xffff0000, v177
    v_lshlrev_b32 v92, 16, v181
    v_and_b32 v93, 0xffff0000, v181
    v_lshlrev_b32 v94, 16, v185
    v_and_b32 v95, 0xffff0000, v185
    v_lshlrev_b32 v96, 16, v189
    v_and_b32 v97, 0xffff0000, v189
    v_lshlrev_b32 v98, 16, v120
    v_lshlrev_b32 v99, 16, v122
    v_and_b32 v100, 0xffff0000, v120
    v_and_b32 v101, 0xffff0000, v122
    v_lshlrev_b32 v102, 16, v121
    v_lshlrev_b32 v103, 16, v123
    v_and_b32 v104, 0xffff0000, v121
    v_and_b32 v105, 0xffff0000, v123
    v_pk_mul_f32 v[106:107], v[76:77], v[104:105]
    v_pk_mul_f32 v[108:109], v[78:79], v[104:105]
    v_pk_mul_f32 v[110:111], v[80:81], v[104:105]
    v_pk_mul_f32 v[112:113], v[82:83], v[104:105]
    v_pk_fma_f32 v[106:107], v[78:79], v[102:103], v[106:107]
    v_pk_fma_f32 v[108:109], v[80:81], v[102:103], v[108:109]
    v_pk_fma_f32 v[110:111], v[82:83], v[102:103], v[110:111]
    v_pk_fma_f32 v[112:113], v[84:85], v[102:103], v[112:113]
    v_pk_fma_f32 v[106:107], v[80:81], v[100:101], v[106:107]
    v_pk_fma_f32 v[108:109], v[82:83], v[100:101], v[108:109]
    v_pk_fma_f32 v[110:111], v[84:85], v[100:101], v[110:111]
    v_pk_fma_f32 v[112:113], v[86:87], v[100:101], v[112:113]
    v_pk_fma_f32 v[106:107], v[82:83], v[98:99], v[106:107]
    v_pk_fma_f32 v[108:109], v[84:85], v[98:99], v[108:109]
    v_pk_fma_f32 v[110:111], v[86:87], v[98:99], v[110:111]
    v_pk_fma_f32 v[112:113], v[88:89], v[98:99], v[112:113]
    v_pk_mul_f32 v[106:107], v[106:107], v[90:91]
    v_pk_mul_f32 v[108:109], v[108:109], v[92:93]
    v_pk_mul_f32 v[110:111], v[110:111], v[94:95]
    v_pk_mul_f32 v[112:113], v[112:113], v[96:97]
    v_cvt_pk_bf16_f32 v164, v112, v110
    v_cvt_pk_bf16_f32 v165, v108, v106
    v_cvt_pk_bf16_f32 v166, v113, v111
    v_cvt_pk_bf16_f32 v167, v109, v107
    s_cmp_ge_u32 s94, s93
    s_cbranch_scc1 NB_44
    s_barrier
    s_add_u32 s94, s94, 1
NB_44:
    v_lshlrev_b32 v76, 16, v18
    v_and_b32 v77, 0xffff0000, v18
    v_lshlrev_b32 v78, 16, v22
    v_and_b32 v79, 0xffff0000, v22
    v_lshlrev_b32 v80, 16, v26
    v_and_b32 v81, 0xffff0000, v26
    v_lshlrev_b32 v82, 16, v30
    v_and_b32 v83, 0xffff0000, v30
    v_lshlrev_b32 v84, 16, v34
    v_and_b32 v85, 0xffff0000, v34
    v_lshlrev_b32 v86, 16, v38
    v_and_b32 v87, 0xffff0000, v38
    v_lshlrev_b32 v88, 16, v42
    v_and_b32 v89, 0xffff0000, v42
    v_lshlrev_b32 v90, 16, v178
    v_and_b32 v91, 0xffff0000, v178
    v_lshlrev_b32 v92, 16, v182
    v_and_b32 v93, 0xffff0000, v182
    v_lshlrev_b32 v94, 16, v186
    v_and_b32 v95, 0xffff0000, v186
    v_lshlrev_b32 v96, 16, v190
    v_and_b32 v97, 0xffff0000, v190
    v_lshlrev_b32 v98, 16, v124
    v_lshlrev_b32 v99, 16, v126
    v_and_b32 v100, 0xffff0000, v124
    v_and_b32 v101, 0xffff0000, v126
    v_lshlrev_b32 v102, 16, v125
    v_lshlrev_b32 v103, 16, v127
    v_and_b32 v104, 0xffff0000, v125
    v_and_b32 v105, 0xffff0000, v127
    v_pk_mul_f32 v[106:107], v[76:77], v[104:105]
    v_pk_mul_f32 v[108:109], v[78:79], v[104:105]
    v_pk_mul_f32 v[110:111], v[80:81], v[104:105]
    v_pk_mul_f32 v[112:113], v[82:83], v[104:105]
    v_pk_fma_f32 v[106:107], v[78:79], v[102:103], v[106:107]
    v_pk_fma_f32 v[108:109], v[80:81], v[102:103], v[108:109]
    v_pk_fma_f32 v[110:111], v[82:83], v[102:103], v[110:111]
    v_pk_fma_f32 v[112:113], v[84:85], v[102:103], v[112:113]
    v_pk_fma_f32 v[106:107], v[80:81], v[100:101], v[106:107]
    v_pk_fma_f32 v[108:109], v[82:83], v[100:101], v[108:109]
    v_pk_fma_f32 v[110:111], v[84:85], v[100:101], v[110:111]
    v_pk_fma_f32 v[112:113], v[86:87], v[100:101], v[112:113]
    v_pk_fma_f32 v[106:107], v[82:83], v[98:99], v[106:107]
    v_pk_fma_f32 v[108:109], v[84:85], v[98:99], v[108:109]
    v_pk_fma_f32 v[110:111], v[86:87], v[98:99], v[110:111]
    v_pk_fma_f32 v[112:113], v[88:89], v[98:99], v[112:113]
    v_pk_mul_f32 v[106:107], v[106:107], v[90:91]
    v_pk_mul_f32 v[108:109], v[108:109], v[92:93]
    v_pk_mul_f32 v[110:111], v[110:111], v[94:95]
    v_pk_mul_f32 v[112:113], v[112:113], v[96:97]
    v_cvt_pk_bf16_f32 v168, v112, v110
    v_cvt_pk_bf16_f32 v169, v108, v106
    v_cvt_pk_bf16_f32 v170, v113, v111
    v_cvt_pk_bf16_f32 v171, v109, v107
    v_lshlrev_b32 v76, 16, v19
    v_and_b32 v77, 0xffff0000, v19
    v_lshlrev_b32 v78, 16, v23
    v_and_b32 v79, 0xffff0000, v23
    v_lshlrev_b32 v80, 16, v27
    v_and_b32 v81, 0xffff0000, v27
    v_lshlrev_b32 v82, 16, v31
    v_and_b32 v83, 0xffff0000, v31
    v_lshlrev_b32 v84, 16, v35
    v_and_b32 v85, 0xffff0000, v35
    v_lshlrev_b32 v86, 16, v39
    v_and_b32 v87, 0xffff0000, v39
    v_lshlrev_b32 v88, 16, v43
    v_and_b32 v89, 0xffff0000, v43
    v_lshlrev_b32 v90, 16, v179
    v_and_b32 v91, 0xffff0000, v179
    v_lshlrev_b32 v92, 16, v183
    v_and_b32 v93, 0xffff0000, v183
    v_lshlrev_b32 v94, 16, v187
    v_and_b32 v95, 0xffff0000, v187
    v_lshlrev_b32 v96, 16, v191
    v_and_b32 v97, 0xffff0000, v191
    v_lshlrev_b32 v98, 16, v128
    v_lshlrev_b32 v99, 16, v130
    v_and_b32 v100, 0xffff0000, v128
    v_and_b32 v101, 0xffff0000, v130
    v_lshlrev_b32 v102, 16, v129
    v_lshlrev_b32 v103, 16, v131
    v_and_b32 v104, 0xffff0000, v129
    v_and_b32 v105, 0xffff0000, v131
    v_pk_mul_f32 v[106:107], v[76:77], v[104:105]
    v_pk_mul_f32 v[108:109], v[78:79], v[104:105]
    v_pk_mul_f32 v[110:111], v[80:81], v[104:105]
    v_pk_mul_f32 v[112:113], v[82:83], v[104:105]
    v_pk_fma_f32 v[106:107], v[78:79], v[102:103], v[106:107]
    v_pk_fma_f32 v[108:109], v[80:81], v[102:103], v[108:109]
    v_pk_fma_f32 v[110:111], v[82:83], v[102:103], v[110:111]
    v_pk_fma_f32 v[112:113], v[84:85], v[102:103], v[112:113]
    v_pk_fma_f32 v[106:107], v[80:81], v[100:101], v[106:107]
    v_pk_fma_f32 v[108:109], v[82:83], v[100:101], v[108:109]
    v_pk_fma_f32 v[110:111], v[84:85], v[100:101], v[110:111]
    v_pk_fma_f32 v[112:113], v[86:87], v[100:101], v[112:113]
    v_pk_fma_f32 v[106:107], v[82:83], v[98:99], v[106:107]
    v_pk_fma_f32 v[108:109], v[84:85], v[98:99], v[108:109]
    v_pk_fma_f32 v[110:111], v[86:87], v[98:99], v[110:111]
    v_pk_fma_f32 v[112:113], v[88:89], v[98:99], v[112:113]
    v_pk_mul_f32 v[106:107], v[106:107], v[90:91]
    v_pk_mul_f32 v[108:109], v[108:109], v[92:93]
    v_pk_mul_f32 v[110:111], v[110:111], v[94:95]
    v_pk_mul_f32 v[112:113], v[112:113], v[96:97]
    v_cvt_pk_bf16_f32 v172, v112, v110
    v_cvt_pk_bf16_f32 v173, v108, v106
    v_cvt_pk_bf16_f32 v174, v113, v111
    v_cvt_pk_bf16_f32 v175, v109, v107
    s_cmp_ge_u32 s94, s93
    s_cbranch_scc1 NB_45
    s_barrier
    s_add_u32 s94, s94, 1
NB_45:
    ds_write_b64 v10, v[160:161] offset:0
    ds_write_b64 v12, v[162:163] offset:0
    ds_write_b64 v10, v[164:165] offset:128
    ds_write_b64 v12, v[166:167] offset:128
    ds_write_b64 v10, v[168:169] offset:256
    ds_write_b64 v12, v[170:171] offset:256
    ds_write_b64 v10, v[172:173] offset:384
    ds_write_b64 v12, v[174:175] offset:384
    v_xor_b32 v77, 32, v11
    v_xor_b32 v78, 64, v11
    v_xor_b32 v79, 96, v11
    s_waitcnt lgkmcnt(0)
    ds_read_b128 v[160:163], v11 offset:0
    ds_read_b128 v[164:167], v77 offset:1024
    ds_read_b128 v[168:171], v78 offset:2048
    ds_read_b128 v[172:175], v79 offset:3072
    s_mov_b32 s64, 0
    s_waitcnt lgkmcnt(3)
    buffer_store_dwordx4 v[160:163], v13, s[28:31], s64 offen sc1
    s_mov_b32 s64, 65536
    s_waitcnt lgkmcnt(2)
    buffer_store_dwordx4 v[164:167], v13, s[28:31], s64 offen sc1
    s_mov_b32 s64, 131072
    s_waitcnt lgkmcnt(1)
    buffer_store_dwordx4 v[168:171], v13, s[28:31], s64 offen sc1
    s_mov_b32 s64, 196608
    s_waitcnt lgkmcnt(0)
    buffer_store_dwordx4 v[172:175], v13, s[28:31], s64 offen sc1
    s_mov_b32 s40, s26
    s_mov_b32 s41, s27
    s_mov_b32 s42, 0x100
    s_mov_b32 s43, 0x20000
    buffer_load_dword v47, v46, s[40:43], 0 offen sc1
EW_46:
    s_mov_b32 s65, 1
EX_47:
    s_getreg_b32 s64, hwreg(HW_REG_IB_STS)
    s_and_b32 s64, s64, 0x00c0000f
    s_cbranch_scc0 EWD_48
    s_cmp_ge_u32 s94, s93
    s_cbranch_scc1 EWD_48
    s_barrier
    s_add_u32 s94, s94, 1
    s_branch EW_46
EWD_48:
    s_waitcnt vmcnt(0)
    v_mov_b32 v114, s71
    v_mov_b32 v115, 1
    s_mov_b64 exec, 1
    ds_add_rtn_u32 v115, v114, v115 offset:8
    s_waitcnt lgkmcnt(0)
    v_readfirstlane_b32 s64, v115
    s_mov_b64 exec, -1
    s_add_u32 s64, s64, 1
    s_cmp_lg_u32 s64, s101
    s_cbranch_scc1 NL_49
    v_lshl_add_u32 v114, v0, 2, s69
    v_mov_b32 v115, 1
    s_mov_b64 exec, 3
    buffer_store_dword v115, v114, s[28:31], 0 offen sc1
    s_mov_b64 exec, -1
NL_49:
    s_cmp_eq_u32 s3, 7
    s_cbranch_scc1 L_FETCH
    s_cmp_eq_u32 s3, 6
    s_cbranch_scc1 L_IDLE2
L_PREP:
    s_cmp_ge_u32 s94, s93
    s_cbranch_scc1 NB_50
    s_barrier
    s_add_u32 s94, s94, 1
NB_50:
    ds_read_b128 v[132:135], v15 offset:0
    ds_read_b64 v[136:137], v15 offset:16
    ds_read_b128 v[138:141], v15 offset:1024
    ds_read_b64 v[142:143], v15 offset:1040
    ds_read_b128 v[144:147], v15 offset:2048
    ds_read_b64 v[148:149], v15 offset:2064
    ds_read_b128 v[150:153], v15 offset:3072
    ds_read_b64 v[154:155], v15 offset:3088
    v_lshrrev_b32 v22, 4, v0
    s_lshl_b32 s64, s59, 12
    v_lshrrev_b32 v23, 2, v0
    v_and_b32 v23, 3, v23
    v_mul_u32_u24 v23, 4160, v23
    v_lshl_add_u32 v23, v22, 4, v23
    v_and_b32 v24, 3, v0
    v_lshl_add_u32 v23, v24, 3, v23
    v_add_u32 v16, s70, v23
    v_and_b32 v23, 15, v0
    v_lshlrev_b32 v23, 5, v23
    v_lshlrev_b32 v24, 4, v22
    v_sub_u32 v24, v24, v23
    v_add_u32 v24, s70, v24
    v_add_u32 v17, 17120, v24
    v_lshl_add_u32 v23, v22, 3, v23
    v_sub_u32 v24, s70, v23
    v_add_u32 v18, 17144, v24
    s_add_u32 s64, s64, 0xa00000
    v_add_u32 v19, s64, v23
    v_lshlrev_b32 v20, 16, v156
    v_mov_b32 v112, 0
    v_mov_b32 v113, 0
    v_mov_b32 v114, 0
    v_mov_b32 v115, 0
    v_mov_b32 v116, 0
    v_mov_b32 v117, 0
    s_waitcnt lgkmcnt(0)
    v_readlane_b32 s65, v132, 0
    v_readlane_b32 s66, v133, 0
    v_alignbit_b32 v64, v133, v132, 16
    v_alignbit_b32 v65, v134, v133, 16
    v_alignbit_b32 v66, v135, v134, 16
    v_alignbit_b32 v67, v136, v135, 16
    v_mov_b32 v68, v133
    v_mov_b32 v69, v134
    v_mov_b32 v70, v135
    v_mov_b32 v71, v136
    v_alignbit_b32 v72, v134, v133, 16
    v_alignbit_b32 v73, v135, v134, 16
    v_alignbit_b32 v74, v136, v135, 16
    v_alignbit_b32 v75, v137, v136, 16
    v_writelane_b32 v116, s65, 1
    v_writelane_b32 v117, s66, 1
    s_cmp_ge_u32 s94, s93
    s_cbranch_scc1 NB_51
    s_barrier
    s_add_u32 s94, s94, 1
NB_51:
    v_alignbit_b32 v76, v139, v138, 16
    v_alignbit_b32 v77, v140, v139, 16
    v_alignbit_b32 v78, v141, v140, 16
    v_alignbit_b32 v79, v142, v141, 16
    v_mov_b32 v80, v139
    v_mov_b32 v81, v140
    v_mov_b32 v82, v141
    v_mov_b32 v83, v142
    v_alignbit_b32 v84, v140, v139, 16
    v_alignbit_b32 v85, v141, v140, 16
    v_alignbit_b32 v86, v142, v141, 16
    v_alignbit_b32 v87, v143, v142, 16
    v_alignbit_b32 v88, v145, v144, 16
    v_alignbit_b32 v89, v146, v145, 16
    v_alignbit_b32 v90, v147, v146, 16
    v_alignbit_b32 v91, v148, v147, 16
    v_mov_b32 v92, v145
    v_mov_b32 v93, v146
    v_mov_b32 v94, v147
    v_mov_b32 v95, v148
    v_alignbit_b32 v96, v146, v145, 16
    v_alignbit_b32 v97, v147, v146, 16
    v_alignbit_b32 v98, v148, v147, 16
    v_alignbit_b32 v99, v149, v148, 16
    v_alignbit_b32 v100, v151, v150, 16
    v_alignbit_b32 v101, v152, v151, 16
    v_alignbit_b32 v102, v153, v152, 16
    v_alignbit_b32 v103, v154, v153, 16
    v_mov_b32 v104, v151
    v_mov_b32 v105, v152
    v_mov_b32 v106, v153
    v_mov_b32 v107, v154
    v_alignbit_b32 v108, v152, v151, 16
    v_alignbit_b32 v109, v153, v152, 16
    v_alignbit_b32 v110, v154, v153, 16
    v_alignbit_b32 v111, v155, v154, 16
    v_alignbit_b32 v120, v113, v112, 16
    v_alignbit_b32 v121, v114, v113, 16
    v_alignbit_b32 v122, v115, v114, 16
    v_alignbit_b32 v123, v116, v115, 16
    v_mov_b32 v124, v113
    v_mov_b32 v125, v114
    v_mov_b32 v126, v115
    v_mov_b32 v127, v116
    v_alignbit_b32 v128, v114, v113, 16
    v_alignbit_b32 v129, v115, v114, 16
    v_alignbit_b32 v130, v116, v115, 16
    v_alignbit_b32 v131, v117, v116, 16
BR_52:
    s_cmp_ge_u32 s94, s93
    s_cbranch_scc1 BRD_53
    s_barrier
    s_add_u32 s94, s94, 1
    s_branch BR_52
BRD_53:
    s_branch L_CONV
L_W6:
    s_waitcnt lgkmcnt(0)
    s_cmp_lt_u32 s55, 3
    s_cbranch_scc1 L_IDLE
    s_min_u32 s64, s58, 2
    s_add_u32 s59, s54, s64
    s_min_u32 s59, s59, 639
    s_mul_i32 s64, s64, 21248
    s_add_u32 s70, s64, 98304
    s_lshl_b32 s65, s59, 1
    v_mov_b32 v156, s65
    s_lshl_b32 s65, s59, 12
    v_lshl_add_u32 v14, v0, 4, s65
    v_lshl_add_u32 v15, v0, 4, s70
    s_mov_b32 s44, s18
    s_mov_b32 s45, s19
    s_mov_b32 s46, 0x280000
    s_mov_b32 s47, 0x20000
    s_mov_b32 m0, s70
    s_nop 0
    buffer_load_dwordx4 v14, s[44:47], 0 offen offset:0 nt lds
    buffer_load_dwordx4 v14, s[44:47], 0 offen offset:1024 nt lds
    buffer_load_dwordx4 v14, s[44:47], 0 offen offset:2048 nt lds
    buffer_load_dwordx4 v14, s[44:47], 0 offen offset:3072 nt lds
    s_mov_b32 s40, s20
    s_mov_b32 s41, s21
    s_mov_b32 s42, 0x500
    s_mov_b32 s43, 0x20000
    buffer_load_ushort v156, v156, s[40:43], 0 offen
    s_mov_b32 s28, s10
    s_mov_b32 s29, s11
    s_mov_b32 s30, 0x1000000
    s_mov_b32 s31, 0x20000
    s_call_b64 s[52:53], L_SETUP
    s_cmp_ge_u32 s94, s93
    s_cbranch_scc1 NB_54
    s_barrier
    s_add_u32 s94, s94, 1
NB_54:
EW_55:
    s_mov_b32 s65, 1
EX_56:
    s_getreg_b32 s64, hwreg(HW_REG_IB_STS)
    s_and_b32 s64, s64, 0x00c0000f
    s_cbranch_scc0 EWD_57
    s_cmp_ge_u32 s94, s93
    s_cbranch_scc1 EWD_57
    s_barrier
    s_add_u32 s94, s94, 1
    s_branch EW_55
EWD_57:
    s_waitcnt vmcnt(0)
    s_branch L_PREP
L_IDLE:
    s_mov_b32 s28, s10
    s_mov_b32 s29, s11
    s_mov_b32 s30, 0x1000000
    s_mov_b32 s31, 0x20000
    s_call_b64 s[52:53], L_SETUP
L_IDLE2:
    v_mov_b32 v192, 0
    v_mov_b32 v193, 0
    v_mov_b32 v194, 0
    v_mov_b32 v195, 0
    v_mov_b32 v196, 0
    v_mov_b32 v197, 0
    v_mov_b32 v198, 0
    v_mov_b32 v199, 0
    v_mov_b32 v200, 0
    v_mov_b32 v201, 0
    v_mov_b32 v202, 0
    v_mov_b32 v203, 0
    v_mov_b32 v204, 0
    v_mov_b32 v205, 0
    v_mov_b32 v206, 0
    v_mov_b32 v207, 0
    v_mov_b32 v48, v240
    v_mov_b32 v49, v240
    v_mov_b32 v50, v240
    v_mov_b32 v51, v240
    v_mov_b32 v52, v240
    v_mov_b32 v53, v240
    v_mov_b32 v54, v240
    v_mov_b32 v55, v240
    v_mov_b32 v56, v240
    v_mov_b32 v57, v240
    v_mov_b32 v58, v240
    v_mov_b32 v59, v240
    v_mov_b32 v60, v240
    v_mov_b32 v61, v240
    v_mov_b32 v62, v240
    v_mov_b32 v63, v240
    v_mov_b32 v208, v240
    v_mov_b32 v209, v240
    v_mov_b32 v210, v240
    v_mov_b32 v211, v240
    v_mov_b32 v212, v240
    v_mov_b32 v213, v240
    v_mov_b32 v214, v240
    v_mov_b32 v215, v240
    v_mov_b32 v216, v240
    v_mov_b32 v217, v240
    v_mov_b32 v218, v240
    v_mov_b32 v219, v240
    v_mov_b32 v220, v240
    v_mov_b32 v221, v240
    v_mov_b32 v222, v240
    v_mov_b32 v223, v240
BR_58:
    s_cmp_ge_u32 s94, s93
    s_cbranch_scc1 BRD_59
    s_barrier
    s_add_u32 s94, s94, 1
    s_branch BR_58
BRD_59:
    s_branch L_ATT
L_S_NT:
    s_waitcnt lgkmcnt(0)
    s_mov_b32 s28, s10
    s_mov_b32 s29, s11
    s_mov_b32 s30, 0x1000000
    s_mov_b32 s31, 0x20000
L_D_NT0:
    s_call_b64 s[52:53], L_SETUP
L_D_NT:
    s_call_b64 s[52:53], L_SPARE
    s_mov_b32 s94, 1
    s_branch L_IDLE2
L_SPARE:
    s_sub_u32 s64, s100, 180
    s_lshl_b32 s64, s64, 3
    s_add_u32 s78, s64, s3
    s_and_b32 s64, s78, 63
    s_lshr_b32 s65, s78, 6
    s_lshl_b32 s69, s100, 6
    s_add_u32 s69, s69, 0xfa0000
    s_lshl_b32 s64, s64, 5
    s_lshl_b32 s65, s65, 7
    v_lshrrev_b32 v16, 3, v0
    v_and_b32 v17, 7, v0
    v_lshl_add_u32 v16, v16, 2, s64
    v_lshl_add_u32 v18, v17, 4, s65
    v_mul_u32_u24 v19, 1280, v16
    v_add_u32 v11, v19, v18
    v_subrev_u32 v10, 3840, v11
    v_lshlrev_b32 v12, 2, v18
    v_lshlrev_b32 v18, 11, v18
    v_lshlrev_b32 v16, 1, v16
    v_sub_u32 v18, v18, v16
    v_add_u32 v13, 0x780ff8, v18
    s_mov_b32 s40, s12
    s_mov_b32 s41, s13
    s_mov_b32 s42, 0x280000
    s_mov_b32 s43, 0x20000
    s_mov_b32 s44, s14
    s_mov_b32 s45, s15
    s_mov_b32 s46, 0x280000
    s_mov_b32 s47, 0x20000
    s_mov_b32 s36, s16
    s_mov_b32 s37, s17
    s_mov_b32 s38, 0x1400
    s_mov_b32 s39, 0x20000
    buffer_load_dwordx4 v[28:31], v11, s[40:43], 0 offen offset:0 nt
    buffer_load_dwordx4 v[32:35], v11, s[40:43], 0 offen offset:1280 nt
    buffer_load_dwordx4 v[36:39], v11, s[40:43], 0 offen offset:2560 nt
    buffer_load_dwordx4 v[40:43], v11, s[40:43], 0 offen offset:3840 nt
    buffer_load_dwordx4 v[176:179], v11, s[44:47], 0 offen offset:0 nt
    buffer_load_dwordx4 v[180:183], v11, s[44:47], 0 offen offset:1280 nt
    buffer_load_dwordx4 v[184:187], v11, s[44:47], 0 offen offset:2560 nt
    buffer_load_dwordx4 v[188:191], v11, s[44:47], 0 offen offset:3840 nt
    buffer_load_dwordx4 v[16:19], v10, s[40:43], 0 offen offset:0 nt
    buffer_load_dwordx4 v[20:23], v10, s[40:43], 0 offen offset:1280 nt
    buffer_load_dwordx4 v[24:27], v10, s[40:43], 0 offen offset:2560 nt
    buffer_load_dwordx4 v[116:119], v12, s[36:39], 0 offen offset:0
    buffer_load_dwordx4 v[120:123], v12, s[36:39], 0 offen offset:16
    buffer_load_dwordx4 v[124:127], v12, s[36:39], 0 offen offset:32
    buffer_load_dwordx4 v[128:131], v12, s[36:39], 0 offen offset:48
    v_mov_b32 v44, 162048
    v_mov_b32 v46, 0
    v_mov_b32 v47, 0
    ds_write_b64 v44, v[46:47]
    ds_write_b64 v44, v[46:47] offset:8
    s_waitcnt lgkmcnt(0)
    s_barrier
L_SPARE2:
    s_lshl_b32 s64, s3, 12
    v_and_b32 v76, 7, v0
    v_lshrrev_b32 v77, 3, v0
    v_sub_u32 v77, 7, v77
    v_lshrrev_b32 v78, 1, v77
    v_xor_b32 v78, v78, v76
    v_lshlrev_b32 v78, 4, v78
    v_and_b32 v77, 1, v77
    v_lshl_add_u32 v78, v77, 3, v78
    v_lshl_add_u32 v78, v76, 9, v78
    v_add_u32 v10, s64, v78
    v_xor_b32 v12, 64, v10
    v_lshrrev_b32 v76, 5, v0
    v_and_b32 v77, 31, v0
    v_xor_b32 v77, v77, v76
    v_lshlrev_b32 v77, 4, v77
    v_lshl_add_u32 v76, v76, 9, v77
    v_add_u32 v11, s64, v76
    s_lshr_b32 s65, s78, 6
    s_lshl_b32 s65, s65, 18
    s_and_b32 s64, s78, 63
    s_lshl_b32 s64, s64, 6
    s_sub_u32 s65, s65, s64
    s_add_u32 s65, s65, 0x780fc0
    v_lshrrev_b32 v76, 2, v0
    v_lshlrev_b32 v76, 12, v76
    v_and_b32 v77, 3, v0
    v_lshl_add_u32 v76, v77, 4, v76
    v_add_u32 v13, s65, v76
    s_waitcnt vmcnt(0)
    v_lshlrev_b32 v76, 16, v16
    v_and_b32 v77, 0xffff0000, v16
    v_lshlrev_b32 v78, 16, v20
    v_and_b32 v79, 0xffff0000, v20
    v_lshlrev_b32 v80, 16, v24
    v_and_b32 v81, 0xffff0000, v24
    v_lshlrev_b32 v82, 16, v28
    v_and_b32 v83, 0xffff0000, v28
    v_lshlrev_b32 v84, 16, v32
    v_and_b32 v85, 0xffff0000, v32
    v_lshlrev_b32 v86, 16, v36
    v_and_b32 v87, 0xffff0000, v36
    v_lshlrev_b32 v88, 16, v40
    v_and_b32 v89, 0xffff0000, v40
    v_lshlrev_b32 v90, 16, v176
    v_and_b32 v91, 0xffff0000, v176
    v_lshlrev_b32 v92, 16, v180
    v_and_b32 v93, 0xffff0000, v180
    v_lshlrev_b32 v94, 16, v184
    v_and_b32 v95, 0xffff0000, v184
    v_lshlrev_b32 v96, 16, v188
    v_and_b32 v97, 0xffff0000, v188
    v_lshlrev_b32 v98, 16, v116
    v_lshlrev_b32 v99, 16, v118
    v_and_b32 v100, 0xffff0000, v116
    v_and_b32 v101, 0xffff0000, v118
    v_lshlrev_b32 v102, 16, v117
    v_lshlrev_b32 v103, 16, v119
    v_and_b32 v104, 0xffff0000, v117
    v_and_b32 v105, 0xffff0000, v119
    v_pk_mul_f32 v[106:107], v[76:77], v[104:105]
    v_pk_mul_f32 v[108:109], v[78:79], v[104:105]
    v_pk_mul_f32 v[110:111], v[80:81], v[104:105]
    v_pk_mul_f32 v[112:113], v[82:83], v[104:105]
    v_pk_fma_f32 v[106:107], v[78:79], v[102:103], v[106:107]
    v_pk_fma_f32 v[108:109], v[80:81], v[102:103], v[108:109]
    v_pk_fma_f32 v[110:111], v[82:83], v[102:103], v[110:111]
    v_pk_fma_f32 v[112:113], v[84:85], v[102:103], v[112:113]
    v_pk_fma_f32 v[106:107], v[80:81], v[100:101], v[106:107]
    v_pk_fma_f32 v[108:109], v[82:83], v[100:101], v[108:109]
    v_pk_fma_f32 v[110:111], v[84:85], v[100:101], v[110:111]
    v_pk_fma_f32 v[112:113], v[86:87], v[100:101], v[112:113]
    v_pk_fma_f32 v[106:107], v[82:83], v[98:99], v[106:107]
    v_pk_fma_f32 v[108:109], v[84:85], v[98:99], v[108:109]
    v_pk_fma_f32 v[110:111], v[86:87], v[98:99], v[110:111]
    v_pk_fma_f32 v[112:113], v[88:89], v[98:99], v[112:113]
    v_pk_mul_f32 v[106:107], v[106:107], v[90:91]
    v_pk_mul_f32 v[108:109], v[108:109], v[92:93]
    v_pk_mul_f32 v[110:111], v[110:111], v[94:95]
    v_pk_mul_f32 v[112:113], v[112:113], v[96:97]
    v_cvt_pk_bf16_f32 v160, v112, v110
    v_cvt_pk_bf16_f32 v161, v108, v106
    v_cvt_pk_bf16_f32 v162, v113, v111
    v_cvt_pk_bf16_f32 v163, v109, v107
    v_lshlrev_b32 v76, 16, v17
    v_and_b32 v77, 0xffff0000, v17
    v_lshlrev_b32 v78, 16, v21
    v_and_b32 v79, 0xffff0000, v21
    v_lshlrev_b32 v80, 16, v25
    v_and_b32 v81, 0xffff0000, v25
    v_lshlrev_b32 v82, 16, v29
    v_and_b32 v83, 0xffff0000, v29
    v_lshlrev_b32 v84, 16, v33
    v_and_b32 v85, 0xffff0000, v33
    v_lshlrev_b32 v86, 16, v37
    v_and_b32 v87, 0xffff0000, v37
    v_lshlrev_b32 v88, 16, v41
    v_and_b32 v89, 0xffff0000, v41
    v_lshlrev_b32 v90, 16, v177
    v_and_b32 v91, 0xffff0000, v177
    v_lshlrev_b32 v92, 16, v181
    v_and_b32 v93, 0xffff0000, v181
    v_lshlrev_b32 v94, 16, v185
    v_and_b32 v95, 0xffff0000, v185
    v_lshlrev_b32 v96, 16, v189
    v_and_b32 v97, 0xffff0000, v189
    v_lshlrev_b32 v98, 16, v120
    v_lshlrev_b32 v99, 16, v122
    v_and_b32 v100, 0xffff0000, v120
    v_and_b32 v101, 0xffff0000, v122
    v_lshlrev_b32 v102, 16, v121
    v_lshlrev_b32 v103, 16, v123
    v_and_b32 v104, 0xffff0000, v121
    v_and_b32 v105, 0xffff0000, v123
    v_pk_mul_f32 v[106:107], v[76:77], v[104:105]
    v_pk_mul_f32 v[108:109], v[78:79], v[104:105]
    v_pk_mul_f32 v[110:111], v[80:81], v[104:105]
    v_pk_mul_f32 v[112:113], v[82:83], v[104:105]
    v_pk_fma_f32 v[106:107], v[78:79], v[102:103], v[106:107]
    v_pk_fma_f32 v[108:109], v[80:81], v[102:103], v[108:109]
    v_pk_fma_f32 v[110:111], v[82:83], v[102:103], v[110:111]
    v_pk_fma_f32 v[112:113], v[84:85], v[102:103], v[112:113]
    v_pk_fma_f32 v[106:107], v[80:81], v[100:101], v[106:107]
    v_pk_fma_f32 v[108:109], v[82:83], v[100:101], v[108:109]
    v_pk_fma_f32 v[110:111], v[84:85], v[100:101], v[110:111]
    v_pk_fma_f32 v[112:113], v[86:87], v[100:101], v[112:113]
    v_pk_fma_f32 v[106:107], v[82:83], v[98:99], v[106:107]
    v_pk_fma_f32 v[108:109], v[84:85], v[98:99], v[108:109]
    v_pk_fma_f32 v[110:111], v[86:87], v[98:99], v[110:111]
    v_pk_fma_f32 v[112:113], v[88:89], v[98:99], v[112:113]
    v_pk_mul_f32 v[106:107], v[106:107], v[90:91]
    v_pk_mul_f32 v[108:109], v[108:109], v[92:93]
    v_pk_mul_f32 v[110:111], v[110:111], v[94:95]
    v_pk_mul_f32 v[112:113], v[112:113], v[96:97]
    v_cvt_pk_bf16_f32 v164, v112, v110
    v_cvt_pk_bf16_f32 v165, v108, v106
    v_cvt_pk_bf16_f32 v166, v113, v111
    v_cvt_pk_bf16_f32 v167, v109, v107
    v_lshlrev_b32 v76, 16, v18
    v_and_b32 v77, 0xffff0000, v18
    v_lshlrev_b32 v78, 16, v22
    v_and_b32 v79, 0xffff0000, v22
    v_lshlrev_b32 v80, 16, v26
    v_and_b32 v81, 0xffff0000, v26
    v_lshlrev_b32 v82, 16, v30
    v_and_b32 v83, 0xffff0000, v30
    v_lshlrev_b32 v84, 16, v34
    v_and_b32 v85, 0xffff0000, v34
    v_lshlrev_b32 v86, 16, v38
    v_and_b32 v87, 0xffff0000, v38
    v_lshlrev_b32 v88, 16, v42
    v_and_b32 v89, 0xffff0000, v42
    v_lshlrev_b32 v90, 16, v178
    v_and_b32 v91, 0xffff0000, v178
    v_lshlrev_b32 v92, 16, v182
    v_and_b32 v93, 0xffff0000, v182
    v_lshlrev_b32 v94, 16, v186
    v_and_b32 v95, 0xffff0000, v186
    v_lshlrev_b32 v96, 16, v190
    v_and_b32 v97, 0xffff0000, v190
    v_lshlrev_b32 v98, 16, v124
    v_lshlrev_b32 v99, 16, v126
    v_and_b32 v100, 0xffff0000, v124
    v_and_b32 v101, 0xffff0000, v126
    v_lshlrev_b32 v102, 16, v125
    v_lshlrev_b32 v103, 16, v127
    v_and_b32 v104, 0xffff0000, v125
    v_and_b32 v105, 0xffff0000, v127
    v_pk_mul_f32 v[106:107], v[76:77], v[104:105]
    v_pk_mul_f32 v[108:109], v[78:79], v[104:105]
    v_pk_mul_f32 v[110:111], v[80:81], v[104:105]
    v_pk_mul_f32 v[112:113], v[82:83], v[104:105]
    v_pk_fma_f32 v[106:107], v[78:79], v[102:103], v[106:107]
    v_pk_fma_f32 v[108:109], v[80:81], v[102:103], v[108:109]
    v_pk_fma_f32 v[110:111], v[82:83], v[102:103], v[110:111]
    v_pk_fma_f32 v[112:113], v[84:85], v[102:103], v[112:113]
    v_pk_fma_f32 v[106:107], v[80:81], v[100:101], v[106:107]
    v_pk_fma_f32 v[108:109], v[82:83], v[100:101], v[108:109]
    v_pk_fma_f32 v[110:111], v[84:85], v[100:101], v[110:111]
    v_pk_fma_f32 v[112:113], v[86:87], v[100:101], v[112:113]
    v_pk_fma_f32 v[106:107], v[82:83], v[98:99], v[106:107]
    v_pk_fma_f32 v[108:109], v[84:85], v[98:99], v[108:109]
    v_pk_fma_f32 v[110:111], v[86:87], v[98:99], v[110:111]
    v_pk_fma_f32 v[112:113], v[88:89], v[98:99], v[112:113]
    v_pk_mul_f32 v[106:107], v[106:107], v[90:91]
    v_pk_mul_f32 v[108:109], v[108:109], v[92:93]
    v_pk_mul_f32 v[110:111], v[110:111], v[94:95]
    v_pk_mul_f32 v[112:113], v[112:113], v[96:97]
    v_cvt_pk_bf16_f32 v168, v112, v110
    v_cvt_pk_bf16_f32 v169, v108, v106
    v_cvt_pk_bf16_f32 v170, v113, v111
    v_cvt_pk_bf16_f32 v171, v109, v107
    v_lshlrev_b32 v76, 16, v19
    v_and_b32 v77, 0xffff0000, v19
    v_lshlrev_b32 v78, 16, v23
    v_and_b32 v79, 0xffff0000, v23
    v_lshlrev_b32 v80, 16, v27
    v_and_b32 v81, 0xffff0000, v27
    v_lshlrev_b32 v82, 16, v31
    v_and_b32 v83, 0xffff0000, v31
    v_lshlrev_b32 v84, 16, v35
    v_and_b32 v85, 0xffff0000, v35
    v_lshlrev_b32 v86, 16, v39
    v_and_b32 v87, 0xffff0000, v39
    v_lshlrev_b32 v88, 16, v43
    v_and_b32 v89, 0xffff0000, v43
    v_lshlrev_b32 v90, 16, v179
    v_and_b32 v91, 0xffff0000, v179
    v_lshlrev_b32 v92, 16, v183
    v_and_b32 v93, 0xffff0000, v183
    v_lshlrev_b32 v94, 16, v187
    v_and_b32 v95, 0xffff0000, v187
    v_lshlrev_b32 v96, 16, v191
    v_and_b32 v97, 0xffff0000, v191
    v_lshlrev_b32 v98, 16, v128
    v_lshlrev_b32 v99, 16, v130
    v_and_b32 v100, 0xffff0000, v128
    v_and_b32 v101, 0xffff0000, v130
    v_lshlrev_b32 v102, 16, v129
    v_lshlrev_b32 v103, 16, v131
    v_and_b32 v104, 0xffff0000, v129
    v_and_b32 v105, 0xffff0000, v131
    v_pk_mul_f32 v[106:107], v[76:77], v[104:105]
    v_pk_mul_f32 v[108:109], v[78:79], v[104:105]
    v_pk_mul_f32 v[110:111], v[80:81], v[104:105]
    v_pk_mul_f32 v[112:113], v[82:83], v[104:105]
    v_pk_fma_f32 v[106:107], v[78:79], v[102:103], v[106:107]
    v_pk_fma_f32 v[108:109], v[80:81], v[102:103], v[108:109]
    v_pk_fma_f32 v[110:111], v[82:83], v[102:103], v[110:111]
    v_pk_fma_f32 v[112:113], v[84:85], v[102:103], v[112:113]
    v_pk_fma_f32 v[106:107], v[80:81], v[100:101], v[106:107]
    v_pk_fma_f32 v[108:109], v[82:83], v[100:101], v[108:109]
    v_pk_fma_f32 v[110:111], v[84:85], v[100:101], v[110:111]
    v_pk_fma_f32 v[112:113], v[86:87], v[100:101], v[112:113]
    v_pk_fma_f32 v[106:107], v[82:83], v[98:99], v[106:107]
    v_pk_fma_f32 v[108:109], v[84:85], v[98:99], v[108:109]
    v_pk_fma_f32 v[110:111], v[86:87], v[98:99], v[110:111]
    v_pk_fma_f32 v[112:113], v[88:89], v[98:99], v[112:113]
    v_pk_mul_f32 v[106:107], v[106:107], v[90:91]
    v_pk_mul_f32 v[108:109], v[108:109], v[92:93]
    v_pk_mul_f32 v[110:111], v[110:111], v[94:95]
    v_pk_mul_f32 v[112:113], v[112:113], v[96:97]
    v_cvt_pk_bf16_f32 v172, v112, v110
    v_cvt_pk_bf16_f32 v173, v108, v106
    v_cvt_pk_bf16_f32 v174, v113, v111
    v_cvt_pk_bf16_f32 v175, v109, v107
    ds_write_b64 v10, v[160:161] offset:0
    ds_write_b64 v12, v[162:163] offset:0
    ds_write_b64 v10, v[164:165] offset:128
    ds_write_b64 v12, v[166:167] offset:128
    ds_write_b64 v10, v[168:169] offset:256
    ds_write_b64 v12, v[170:171] offset:256
    ds_write_b64 v10, v[172:173] offset:384
    ds_write_b64 v12, v[174:175] offset:384
    v_xor_b32 v77, 32, v11
    v_xor_b32 v78, 64, v11
    v_xor_b32 v79, 96, v11
    s_waitcnt lgkmcnt(0)
    ds_read_b128 v[160:163], v11 offset:0
    ds_read_b128 v[164:167], v77 offset:1024
    ds_read_b128 v[168:171], v78 offset:2048
    ds_read_b128 v[172:175], v79 offset:3072
    s_mov_b32 s64, 0
    s_waitcnt lgkmcnt(3)
    buffer_store_dwordx4 v[160:163], v13, s[28:31], s64 offen sc1
    s_mov_b32 s64, 65536
    s_waitcnt lgkmcnt(2)
    buffer_store_dwordx4 v[164:167], v13, s[28:31], s64 offen sc1
    s_mov_b32 s64, 131072
    s_waitcnt lgkmcnt(1)
    buffer_store_dwordx4 v[168:171], v13, s[28:31], s64 offen sc1
    s_mov_b32 s64, 196608
    s_waitcnt lgkmcnt(0)
    buffer_store_dwordx4 v[172:175], v13, s[28:31], s64 offen sc1
L_SPARE3:
    s_waitcnt vmcnt(0)
    v_mov_b32 v114, 162048
    v_mov_b32 v115, 1
    s_mov_b64 exec, 1
    ds_add_rtn_u32 v115, v114, v115 offset:8
    s_waitcnt lgkmcnt(0)
    v_readfirstlane_b32 s64, v115
    s_mov_b64 exec, -1
    s_add_u32 s64, s64, 1
    s_cmp_lg_u32 s64, s101
    s_cbranch_scc1 NL_60
    v_lshl_add_u32 v114, v0, 2, s69
    v_mov_b32 v115, 1
    s_mov_b64 exec, 3
    buffer_store_dword v115, v114, s[28:31], 0 offen sc1
    s_mov_b64 exec, -1
NL_60:
    s_setpc_b64 s[52:53]
L_FETCH:
    s_setprio 0
    v_lshlrev_b32 v228, 4, v0
    v_cmp_le_u32 vcc, 0x80, v47
    s_nop 1
    s_cmp_eq_u64 vcc, exec
    s_cbranch_scc1 CNTOK_61
    s_mov_b32 s62, 0
EP_62:
    buffer_load_dword v47, v46, s[40:43], 0 offen offset:0 sc1
EW_64:
    s_mov_b32 s65, 1
EX_65:
    s_getreg_b32 s64, hwreg(HW_REG_IB_STS)
    s_and_b32 s64, s64, 0x00c0000f
    s_cbranch_scc0 EWD_66
    s_cmp_ge_u32 s94, s93
    s_cbranch_scc1 EWD_66
    s_barrier
    s_add_u32 s94, s94, 1
    s_branch EW_64
EWD_66:
    s_waitcnt vmcnt(0)
    v_cmp_le_u32 vcc, 0x80, v47
    s_nop 1
    s_cmp_eq_u64 vcc, exec
    s_cbranch_scc1 EPD_63
    s_add_u32 s62, s62, 1
    s_cmp_lt_u32 s62, 200000
    s_cbranch_scc0 EPD_63
    s_sleep 1
    s_branch EP_62
EPD_63:
CNTOK_61:
    s_andn2_b32 s65, s54, 63
    s_add_u32 s66, s54, s55
    s_sub_u32 s66, s66, 1
    s_or_b32 s66, s66, 63
    s_lshr_b32 s67, s65, 3
    s_add_u32 s67, s67, 180
    s_lshr_b32 s68, s65, 1
    s_cmp_ge_u32 s65, 480
    s_cselect_b32 s68, s67, s68
    s_sub_u32 s67, s65, 352
    s_cmp_ge_u32 s65, 608
    s_cselect_b32 s65, s67, s68
    s_lshr_b32 s67, s66, 3
    s_add_u32 s67, s67, 180
    s_lshr_b32 s68, s66, 1
    s_cmp_ge_u32 s66, 480
    s_cselect_b32 s68, s67, s68
    s_sub_u32 s67, s66, 352
    s_cmp_ge_u32 s66, 608
    s_cselect_b32 s66, s67, s68
    v_add_u32 v9, s65, v0
    v_min_u32 v9, s66, v9
    v_lshlrev_b32 v9, 6, v9
    v_add_u32 v9, 0xfa0000, v9
PG_67:
    s_cmp_ge_u32 s94, 9
    s_cbranch_scc1 PGD_68
    s_cmp_ge_u32 s94, s93
    s_cbranch_scc1 PGD_68
    s_barrier
    s_add_u32 s94, s94, 1
    s_branch PG_67
PGD_68:
    s_mov_b32 s62, 0
    s_mov_b64 s[72:73], -1
MP_69:
    s_mov_b64 exec, s[72:73]
    s_cbranch_execz MS_71
    buffer_load_dword v16, v9, s[28:31], 0 offen sc1
MS_71:
    s_mov_b64 exec, -1
EW_72:
    s_mov_b32 s65, 1
EX_73:
    s_getreg_b32 s64, hwreg(HW_REG_IB_STS)
    s_and_b32 s64, s64, 0x00c0000f
    s_cbranch_scc0 EWD_74
    s_cmp_ge_u32 s94, s93
    s_cbranch_scc1 EWD_74
    s_barrier
    s_add_u32 s94, s94, 1
    s_branch EW_72
EWD_74:
    s_waitcnt vmcnt(0)
    v_cmp_eq_u32 vcc, 0, v16
    s_nop 1
    s_and_b64 s[72:73], s[72:73], vcc
    s_cbranch_scc0 MPD_70
    s_add_u32 s62, s62, 1
    s_cmp_lt_u32 s62, 200000
    s_cbranch_scc0 MPD_70
    s_sleep 2
    s_branch MP_69
MPD_70:
    s_lshl_b32 s66, s54, 12
    s_add_u32 s66, s66, 0x780000
    s_mov_b32 m0, 114944
    s_add_u32 s65, s66, 0
    buffer_load_dwordx4 v228, s[28:31], s65 offen offset:0 sc1 lds
    buffer_load_dwordx4 v228, s[28:31], s65 offen offset:1024 sc1 lds
    buffer_load_dwordx4 v228, s[28:31], s65 offen offset:2048 sc1 lds
    buffer_load_dwordx4 v228, s[28:31], s65 offen offset:3072 sc1 lds
    s_mov_b32 m0, 136192
    s_add_u32 s65, s66, 4096
    buffer_load_dwordx4 v228, s[28:31], s65 offen offset:0 sc1 lds
    buffer_load_dwordx4 v228, s[28:31], s65 offen offset:1024 sc1 lds
    buffer_load_dwordx4 v228, s[28:31], s65 offen offset:2048 sc1 lds
    buffer_load_dwordx4 v228, s[28:31], s65 offen offset:3072 sc1 lds
    s_cmp_lt_u32 s55, 3
    s_cbranch_scc1 NOU_77
    s_mov_b32 m0, 157440
    s_add_u32 s65, s66, 8192
    buffer_load_dwordx4 v228, s[28:31], s65 offen offset:0 sc1 lds
    buffer_load_dwordx4 v228, s[28:31], s65 offen offset:1024 sc1 lds
    buffer_load_dwordx4 v228, s[28:31], s65 offen offset:2048 sc1 lds
    buffer_load_dwordx4 v228, s[28:31], s65 offen offset:3072 sc1 lds
NOU_77:
    v_mov_b32 v45, 1
EW_78:
    s_mov_b32 s65, 1
EX_79:
    s_getreg_b32 s64, hwreg(HW_REG_IB_STS)
    s_and_b32 s64, s64, 0x00c0000f
    s_cbranch_scc0 EWD_80
    s_cmp_ge_u32 s94, s93
    s_cbranch_scc1 EWD_80
    s_barrier
    s_add_u32 s94, s94, 1
    s_branch EW_78
EWD_80:
    s_waitcnt vmcnt(0)
    ds_write_b32 v44, v45
BR_81:
    s_cmp_ge_u32 s94, s93
    s_cbranch_scc1 BRD_82
    s_barrier
    s_add_u32 s94, s94, 1
    s_branch BR_81
BRD_82:
    v_mov_b32 v192, 0
    v_mov_b32 v193, 0
    v_mov_b32 v194, 0
    v_mov_b32 v195, 0
    v_mov_b32 v196, 0
    v_mov_b32 v197, 0
    v_mov_b32 v198, 0
    v_mov_b32 v199, 0
    v_mov_b32 v200, 0
    v_mov_b32 v201, 0
    v_mov_b32 v202, 0
    v_mov_b32 v203, 0
    v_mov_b32 v204, 0
    v_mov_b32 v205, 0
    v_mov_b32 v206, 0
    v_mov_b32 v207, 0
    v_mov_b32 v48, v240
    v_mov_b32 v49, v240
    v_mov_b32 v50, v240
    v_mov_b32 v51, v240
    v_mov_b32 v52, v240
    v_mov_b32 v53, v240
    v_mov_b32 v54, v240
    v_mov_b32 v55, v240
    v_mov_b32 v56, v240
    v_mov_b32 v57, v240
    v_mov_b32 v58, v240
    v_mov_b32 v59, v240
    v_mov_b32 v60, v240
    v_mov_b32 v61, v240
    v_mov_b32 v62, v240
    v_mov_b32 v63, v240
    v_mov_b32 v208, v240
    v_mov_b32 v209, v240
    v_mov_b32 v210, v240
    v_mov_b32 v211, v240
    v_mov_b32 v212, v240
    v_mov_b32 v213, v240
    v_mov_b32 v214, v240
    v_mov_b32 v215, v240
    v_mov_b32 v216, v240
    v_mov_b32 v217, v240
    v_mov_b32 v218, v240
    v_mov_b32 v219, v240
    v_mov_b32 v220, v240
    v_mov_b32 v221, v240
    v_mov_b32 v222, v240
    v_mov_b32 v223, v240
    s_branch L_ATT
L_COMPUTE:
    s_cmp_lg_u32 s3, 1
    s_cbranch_scc1 NOPF_83
    s_getpc_b64 s[66:67]
L_PC:
    s_sub_u32 s66, s66, L_PC-gated_mix__mha_block__ssm_conv_h3__prompt_kernel
    s_subb_u32 s67, s67, 0
    s_and_b32 s64, s49, 7
    s_lshl_b32 s64, s64, 13
    v_lshl_add_u32 v10, v0, 7, s64
    v_min_u32 v10, L_CODE_END-gated_mix__mha_block__ssm_conv_h3__prompt_kernel-4, v10
    global_load_dword v31, v10, s[66:67]
NOPF_83:
    s_cmp_ge_u32 s49, 30
    s_cselect_b32 s93, 1, 10
    s_mov_b32 s94, 0
    s_lshr_b32 s64, s49, 3
    s_lshl_b32 s65, s48, 2
    s_add_u32 s56, s64, s65
    s_and_b32 s57, s49, 7
    s_lshr_b32 s60, s3, 2
    s_and_b32 s61, s3, 3
    s_mov_b32 s63, 0
    s_mov_b32 s74, 0x000fffff
    s_mov_b32 s75, 0x000fffff
    s_lshl_b32 s64, s50, 10
    s_lshl_b32 s65, s51, 6
    s_add_u32 s64, s64, s65
    s_add_u32 s92, s64, 0xf04000
    s_lshl_b32 s64, s48, 1
    s_add_u32 s64, s64, s49
    s_sub_u32 s71, s64, 30
    s_lshl_b32 s64, s71, 6
    s_add_u32 s64, s64, 0xf0d000
    s_cmp_ge_u32 s49, 30
    s_cselect_b32 s92, s64, s92
    s_waitcnt lgkmcnt(0)
    s_mov_b32 s28, s10
    s_mov_b32 s29, s11
    s_mov_b32 s30, 0x1000000
    s_mov_b32 s31, 0x20000
    s_cmp_lg_u32 s3, 0
    s_cbranch_scc1 NOZ_84
    s_lshl_b32 s64, s100, 6
    s_add_u32 s64, s64, 0xfa0000
    v_mov_b32 v12, s64
    v_and_b32 v10, 3, v0
    v_lshlrev_b32 v11, 2, v10
    v_add_u32 v13, s92, v11
    s_mov_b32 s72, 0xf
    s_mov_b32 s73, 0
    v_cndmask_b32 v12, v12, v13, s[72:73]
    s_lshl_b32 s64, s54, 2
    s_add_u32 s64, s64, 0xf0c000
    v_add_u32 v13, s64, v11
    s_lshl_b32 s72, 16, s55
    s_sub_u32 s72, s72, 16
    v_cndmask_b32 v12, v12, v13, s[72:73]
    s_lshl_b32 s64, s57, 11
    s_lshl_b32 s65, s56, 6
    s_add_u32 s64, s64, s65
    s_add_u32 s64, s64, 0xf08000
    v_mov_b32 v13, s64
    s_mov_b32 s72, 0x100
    v_cndmask_b32 v12, v12, v13, s[72:73]
    s_lshl_b32 s64, s95, 6
    s_add_u32 s64, s64, 0xfa4000
    v_mov_b32 v13, s64
    s_cmp_lt_u32 s95, 32
    s_cselect_b32 s65, s55, 0
    s_cmp_eq_u32 s65, 2
    s_cselect_b32 s72, 0x200, 0
    v_cndmask_b32 v12, v12, v13, s[72:73]
    v_mov_b32 v13, 0
    s_mov_b32 exec_lo, 0x3ff
    s_mov_b32 exec_hi, 0
    buffer_store_dword v13, v12, s[28:31], 0 offen sc1
    s_mov_b64 exec, 1
    s_mov_b32 s32, s26
    s_mov_b32 s33, s27
    s_mov_b32 s34, 0x100
    s_mov_b32 s35, 0x20000
    s_and_b32 s64, s2, 1
    s_lshl_b32 s64, s64, 7
    v_mov_b32 v12, s64
    v_mov_b32 v13, 1
    s_waitcnt vmcnt(0)
    buffer_atomic_add v13, v12, s[32:35], 0 offen sc1
    s_mov_b64 exec, -1
NOZ_84:
    s_call_b64 s[52:53], L_SETUP
    v_mov_b32 v192, 0
    v_mov_b32 v193, 0
    v_mov_b32 v194, 0
    v_mov_b32 v195, 0
    v_mov_b32 v196, 0
    v_mov_b32 v197, 0
    v_mov_b32 v198, 0
    v_mov_b32 v199, 0
    v_mov_b32 v200, 0
    v_mov_b32 v201, 0
    v_mov_b32 v202, 0
    v_mov_b32 v203, 0
    v_mov_b32 v204, 0
    v_mov_b32 v205, 0
    v_mov_b32 v206, 0
    v_mov_b32 v207, 0
    v_mov_b32 v208, v240
    v_mov_b32 v209, v240
    v_mov_b32 v210, v240
    v_mov_b32 v211, v240
    v_mov_b32 v212, v240
    v_mov_b32 v213, v240
    v_mov_b32 v214, v240
    v_mov_b32 v215, v240
    v_mov_b32 v216, v240
    v_mov_b32 v217, v240
    v_mov_b32 v218, v240
    v_mov_b32 v219, v240
    v_mov_b32 v220, v240
    v_mov_b32 v221, v240
    v_mov_b32 v222, v240
    v_mov_b32 v223, v240
    s_cmp_eq_u32 s3, 0
    s_cbranch_scc1 L_C_NW
    s_waitcnt vmcnt(0)
L_C_NW:
    s_cmp_ge_u32 s49, 30
    s_cbranch_scc1 L_C_NOTILE
    s_and_b32 s64, s3, 1
    s_lshl_b32 s64, s64, 13
    v_and_b32 v8, 31, v0
    v_lshrrev_b32 v9, 5, v0
    v_lshrrev_b32 v10, 1, v8
    v_and_b32 v10, 7, v10
    v_xor_b32 v10, v10, v9
    v_lshlrev_b32 v8, 7, v8
    v_add_u32 v8, s64, v8
    v_xor_b32 v11, 0, v10
    v_lshl_add_u32 v2, v11, 4, v8
    v_xor_b32 v11, 2, v10
    v_lshl_add_u32 v3, v11, 4, v8
    v_xor_b32 v11, 4, v10
    v_lshl_add_u32 v4, v11, 4, v8
    v_xor_b32 v11, 6, v10
    v_lshl_add_u32 v5, v11, 4, v8
    v_lshrrev_b32 v8, 2, v0
    v_and_b32 v8, 3, v8
    v_lshrrev_b32 v9, 5, v0
    v_lshl_add_u32 v9, v9, 3, v8
    v_lshlrev_b32 v9, 8, v9
    v_lshrrev_b32 v10, 4, v0
    v_and_b32 v10, 1, v10
    v_lshlrev_b32 v10, 1, v10
    v_lshrrev_b32 v11, 1, v0
    v_and_b32 v11, 1, v11
    v_or_b32 v10, v10, v11
    v_and_b32 v11, 1, v0
    v_lshlrev_b32 v11, 3, v11
    v_add_u32 v9, v9, v11
    v_add_u32 v9, 49152, v9
    s_and_b32 s64, s3, 2
    s_add_u32 s65, s64, 0
    v_xor_b32 v11, s65, v8
    v_lshl_add_u32 v11, v11, 2, v10
    v_lshl_add_u32 v6, v11, 4, v9
    s_add_u32 s65, s64, 1
    v_xor_b32 v11, s65, v8
    v_lshl_add_u32 v11, v11, 2, v10
    v_lshl_add_u32 v7, v11, 4, v9
    s_setprio 3
    s_cmp_ge_u32 s50, 10
    s_cbranch_scc1 L_C_VTILE
    s_mov_b32 s65, 81920
    s_mov_b32 s68, 2560
    s_cmp_ge_u32 s50, 5
    s_cselect_b32 s65, 163840, s65
    s_cselect_b32 s68, 5120, s68
    s_cselect_b32 s64, 0, 0x500000
    s_cselect_b32 s69, 5, 0
    s_cselect_b64 s[72:73], -1, 0
    s_cselect_b32 s86, 1.0, 0x3ea52b5c
    s_sub_u32 s69, s50, s69
    s_lshl_b32 s67, s69, 4
    s_and_b32 s69, s3, 2
    s_lshl_b32 s69, s69, 2
    s_add_u32 s67, s67, s69
    s_lshl_b32 s69, s51, 1
    s_and_b32 s70, s3, 1
    s_add_u32 s69, s69, s70
    s_mul_i32 s69, s69, s68
    s_add_u32 s64, s64, s69
    v_and_b32 v8, 31, v0
    v_and_b32 v9, 0x13, v0
    v_and_b32 v10, 4, v0
    v_lshl_or_b32 v9, v10, 1, v9
    v_and_b32 v10, 8, v0
    v_lshrrev_b32 v10, 1, v10
    v_or_b32 v9, v9, v10
    v_cndmask_b32 v8, v8, v9, s[72:73]
    v_lshrrev_b32 v9, 5, v0
    v_lshlrev_b32 v10, 3, v9
    v_lshl_add_u32 v12, v8, 4, v10
    v_add_u32 v13, 1024, v12
    v_mul_lo_u32 v10, v9, s65
    v_lshl_add_u32 v14, v8, 3, v10
    v_add_u32 v14, 1024, v14
    v_add_u32 v15, 256, v14
    s_add_u32 s68, s67, 0
    s_mul_i32 s69, s68, 205
    s_lshr_b32 s69, s69, 10
    s_mul_i32 s70, s69, 5
    s_sub_u32 s68, s68, s70
    s_lshl_b32 s69, s69, 1
    s_mul_i32 s69, s69, s65
    s_add_u32 s69, s69, s64
    s_lshl_b32 s70, s68, 9
    s_add_u32 s69, s69, s70
    s_sub_u32 s70, s65, 1536
    s_cmp_ge_u32 s68, 3
    s_cselect_b32 s70, s70, 0
    s_add_u32 s78, s69, s70
    s_cmp_eq_u32 s68, 2
    s_cselect_b64 s[72:73], -1, 0
    v_cndmask_b32 v136, v12, v14, s[72:73]
    v_cndmask_b32 v137, v13, v15, s[72:73]
    s_add_u32 s68, s67, 1
    s_mul_i32 s69, s68, 205
    s_lshr_b32 s69, s69, 10
    s_mul_i32 s70, s69, 5
    s_sub_u32 s68, s68, s70
    s_lshl_b32 s69, s69, 1
    s_mul_i32 s69, s69, s65
    s_add_u32 s69, s69, s64
    s_lshl_b32 s70, s68, 9
    s_add_u32 s69, s69, s70
    s_sub_u32 s70, s65, 1536
    s_cmp_ge_u32 s68, 3
    s_cselect_b32 s70, s70, 0
    s_add_u32 s79, s69, s70
    s_cmp_eq_u32 s68, 2
    s_cselect_b64 s[72:73], -1, 0
    v_cndmask_b32 v138, v12, v14, s[72:73]
    v_cndmask_b32 v139, v13, v15, s[72:73]
    s_add_u32 s68, s67, 2
    s_mul_i32 s69, s68, 205
    s_lshr_b32 s69, s69, 10
    s_mul_i32 s70, s69, 5
    s_sub_u32 s68, s68, s70
    s_lshl_b32 s69, s69, 1
    s_mul_i32 s69, s69, s65
    s_add_u32 s69, s69, s64
    s_lshl_b32 s70, s68, 9
    s_add_u32 s69, s69, s70
    s_sub_u32 s70, s65, 1536
    s_cmp_ge_u32 s68, 3
    s_cselect_b32 s70, s70, 0
    s_add_u32 s80, s69, s70
    s_cmp_eq_u32 s68, 2
    s_cselect_b64 s[72:73], -1, 0
    v_cndmask_b32 v140, v12, v14, s[72:73]
    v_cndmask_b32 v141, v13, v15, s[72:73]
    s_add_u32 s68, s67, 3
    s_mul_i32 s69, s68, 205
    s_lshr_b32 s69, s69, 10
    s_mul_i32 s70, s69, 5
    s_sub_u32 s68, s68, s70
    s_lshl_b32 s69, s69, 1
    s_mul_i32 s69, s69, s65
    s_add_u32 s69, s69, s64
    s_lshl_b32 s70, s68, 9
    s_add_u32 s69, s69, s70
    s_sub_u32 s70, s65, 1536
    s_cmp_ge_u32 s68, 3
    s_cselect_b32 s70, s70, 0
    s_add_u32 s81, s69, s70
    s_cmp_eq_u32 s68, 2
    s_cselect_b64 s[72:73], -1, 0
    v_cndmask_b32 v142, v12, v14, s[72:73]
    v_cndmask_b32 v143, v13, v15, s[72:73]
    s_add_u32 s68, s67, 4
    s_mul_i32 s69, s68, 205
    s_lshr_b32 s69, s69, 10
    s_mul_i32 s70, s69, 5
    s_sub_u32 s68, s68, s70
    s_lshl_b32 s69, s69, 1
    s_mul_i32 s69, s69, s65
    s_add_u32 s69, s69, s64
    s_lshl_b32 s70, s68, 9
    s_add_u32 s69, s69, s70
    s_sub_u32 s70, s65, 1536
    s_cmp_ge_u32 s68, 3
    s_cselect_b32 s70, s70, 0
    s_add_u32 s82, s69, s70
    s_cmp_eq_u32 s68, 2
    s_cselect_b64 s[72:73], -1, 0
    v_cndmask_b32 v144, v12, v14, s[72:73]
    v_cndmask_b32 v145, v13, v15, s[72:73]
    s_add_u32 s68, s67, 5
    s_mul_i32 s69, s68, 205
    s_lshr_b32 s69, s69, 10
    s_mul_i32 s70, s69, 5
    s_sub_u32 s68, s68, s70
    s_lshl_b32 s69, s69, 1
    s_mul_i32 s69, s69, s65
    s_add_u32 s69, s69, s64
    s_lshl_b32 s70, s68, 9
    s_add_u32 s69, s69, s70
    s_sub_u32 s70, s65, 1536
    s_cmp_ge_u32 s68, 3
    s_cselect_b32 s70, s70, 0
    s_add_u32 s83, s69, s70
    s_cmp_eq_u32 s68, 2
    s_cselect_b64 s[72:73], -1, 0
    v_cndmask_b32 v146, v12, v14, s[72:73]
    v_cndmask_b32 v147, v13, v15, s[72:73]
    s_add_u32 s68, s67, 6
    s_mul_i32 s69, s68, 205
    s_lshr_b32 s69, s69, 10
    s_mul_i32 s70, s69, 5
    s_sub_u32 s68, s68, s70
    s_lshl_b32 s69, s69, 1
    s_mul_i32 s69, s69, s65
    s_add_u32 s69, s69, s64
    s_lshl_b32 s70, s68, 9
    s_add_u32 s69, s69, s70
    s_sub_u32 s70, s65, 1536
    s_cmp_ge_u32 s68, 3
    s_cselect_b32 s70, s70, 0
    s_add_u32 s84, s69, s70
    s_cmp_eq_u32 s68, 2
    s_cselect_b64 s[72:73], -1, 0
    v_cndmask_b32 v148, v12, v14, s[72:73]
    v_cndmask_b32 v149, v13, v15, s[72:73]
    s_add_u32 s68, s67, 7
    s_mul_i32 s69, s68, 205
    s_lshr_b32 s69, s69, 10
    s_mul_i32 s70, s69, 5
    s_sub_u32 s68, s68, s70
    s_lshl_b32 s69, s69, 1
    s_mul_i32 s69, s69, s65
    s_add_u32 s69, s69, s64
    s_lshl_b32 s70, s68, 9
    s_add_u32 s69, s69, s70
    s_sub_u32 s70, s65, 1536
    s_cmp_ge_u32 s68, 3
    s_cselect_b32 s70, s70, 0
    s_add_u32 s85, s69, s70
    s_cmp_eq_u32 s68, 2
    s_cselect_b64 s[72:73], -1, 0
    v_cndmask_b32 v150, v12, v14, s[72:73]
    v_cndmask_b32 v151, v13, v15, s[72:73]
    s_barrier
    ds_read_b64_tr_b16 v[40:41], v6 offset:0
    ds_read_b64_tr_b16 v[42:43], v6 offset:1024
    ds_read_b128 v[32:35], v2 offset:0
    ds_read_b128 v[36:39], v2 offset:4096
    ds_read_b64_tr_b16 v[44:45], v7 offset:0
    ds_read_b64_tr_b16 v[46:47], v7 offset:1024
    s_waitcnt lgkmcnt(3)
    v_mfma_f32_32x32x16_bf16 v[64:79], v[40:43], v[32:35], 0
    ds_read_b64_tr_b16 v[56:57], v6 offset:4096
    ds_read_b64_tr_b16 v[58:59], v6 offset:5120
    ds_read_b128 v[48:51], v3 offset:0
    s_waitcnt lgkmcnt(5)
    v_mfma_f32_32x32x16_bf16 v[80:95], v[40:43], v[36:39], 0
    ds_read_b128 v[52:55], v3 offset:4096
    ds_read_b64_tr_b16 v[60:61], v7 offset:4096
    ds_read_b64_tr_b16 v[62:63], v7 offset:5120
    s_waitcnt lgkmcnt(6)
    v_mfma_f32_32x32x16_bf16 v[96:111], v[44:47], v[32:35], 0
    v_mfma_f32_32x32x16_bf16 v[112:127], v[44:47], v[36:39], 0
    s_waitcnt lgkmcnt(3)
    v_mfma_f32_32x32x16_bf16 v[64:79], v[56:59], v[48:51], v[64:79]
    ds_read_b64_tr_b16 v[40:41], v6 offset:8192
    ds_read_b64_tr_b16 v[42:43], v6 offset:9216
    ds_read_b128 v[32:35], v4 offset:0
    s_waitcnt lgkmcnt(5)
    v_mfma_f32_32x32x16_bf16 v[80:95], v[56:59], v[52:55], v[80:95]
    ds_read_b128 v[36:39], v4 offset:4096
    ds_read_b64_tr_b16 v[44:45], v7 offset:8192
    ds_read_b64_tr_b16 v[46:47], v7 offset:9216
    s_waitcnt lgkmcnt(6)
    v_mfma_f32_32x32x16_bf16 v[96:111], v[60:63], v[48:51], v[96:111]
    v_mfma_f32_32x32x16_bf16 v[112:127], v[60:63], v[52:55], v[112:127]
    s_waitcnt lgkmcnt(3)
    v_mfma_f32_32x32x16_bf16 v[64:79], v[40:43], v[32:35], v[64:79]
    ds_read_b64_tr_b16 v[56:57], v6 offset:12288
    ds_read_b64_tr_b16 v[58:59], v6 offset:13312
    ds_read_b128 v[48:51], v5 offset:0
    s_waitcnt lgkmcnt(5)
    v_mfma_f32_32x32x16_bf16 v[80:95], v[40:43], v[36:39], v[80:95]
    ds_read_b128 v[52:55], v5 offset:4096
    ds_read_b64_tr_b16 v[60:61], v7 offset:12288
    ds_read_b64_tr_b16 v[62:63], v7 offset:13312
    s_waitcnt lgkmcnt(6)
    v_mfma_f32_32x32x16_bf16 v[96:111], v[44:47], v[32:35], v[96:111]
    v_mfma_f32_32x32x16_bf16 v[112:127], v[44:47], v[36:39], v[112:127]
    s_waitcnt lgkmcnt(0)
    s_barrier
    v_mfma_f32_32x32x16_bf16 v[64:79], v[56:59], v[48:51], v[64:79]
    ds_read_b64_tr_b16 v[40:41], v6 offset:16384
    ds_read_b64_tr_b16 v[42:43], v6 offset:17408
    ds_read_b128 v[32:35], v2 offset:16384
    v_mfma_f32_32x32x16_bf16 v[80:95], v[56:59], v[52:55], v[80:95]
    ds_read_b128 v[36:39], v2 offset:20480
    ds_read_b64_tr_b16 v[44:45], v7 offset:16384
    ds_read_b64_tr_b16 v[46:47], v7 offset:17408
    v_mfma_f32_32x32x16_bf16 v[96:111], v[60:63], v[48:51], v[96:111]
    v_mfma_f32_32x32x16_bf16 v[112:127], v[60:63], v[52:55], v[112:127]
    s_waitcnt lgkmcnt(3)
    v_mfma_f32_32x32x16_bf16 v[64:79], v[40:43], v[32:35], v[64:79]
    ds_read_b64_tr_b16 v[56:57], v6 offset:20480
    ds_read_b64_tr_b16 v[58:59], v6 offset:21504
    ds_read_b128 v[48:51], v3 offset:16384
    s_waitcnt lgkmcnt(5)
    v_mfma_f32_32x32x16_bf16 v[80:95], v[40:43], v[36:39], v[80:95]
    ds_read_b128 v[52:55], v3 offset:20480
    ds_read_b64_tr_b16 v[60:61], v7 offset:20480
    ds_read_b64_tr_b16 v[62:63], v7 offset:21504
    s_waitcnt lgkmcnt(6)
    v_mfma_f32_32x32x16_bf16 v[96:111], v[44:47], v[32:35], v[96:111]
    v_mfma_f32_32x32x16_bf16 v[112:127], v[44:47], v[36:39], v[112:127]
    s_waitcnt lgkmcnt(3)
    v_mfma_f32_32x32x16_bf16 v[64:79], v[56:59], v[48:51], v[64:79]
    ds_read_b64_tr_b16 v[40:41], v6 offset:24576
    ds_read_b64_tr_b16 v[42:43], v6 offset:25600
    ds_read_b128 v[32:35], v4 offset:16384
    s_waitcnt lgkmcnt(5)
    v_mfma_f32_32x32x16_bf16 v[80:95], v[56:59], v[52:55], v[80:95]
    ds_read_b128 v[36:39], v4 offset:20480
    ds_read_b64_tr_b16 v[44:45], v7 offset:24576
    ds_read_b64_tr_b16 v[46:47], v7 offset:25600
    s_waitcnt lgkmcnt(6)
    v_mfma_f32_32x32x16_bf16 v[96:111], v[60:63], v[48:51], v[96:111]
    v_mfma_f32_32x32x16_bf16 v[112:127], v[60:63], v[52:55], v[112:127]
    s_waitcnt lgkmcnt(3)
    v_mfma_f32_32x32x16_bf16 v[64:79], v[40:43], v[32:35], v[64:79]
    ds_read_b64_tr_b16 v[56:57], v6 offset:28672
    ds_read_b64_tr_b16 v[58:59], v6 offset:29696
    ds_read_b128 v[48:51], v5 offset:16384
    s_waitcnt lgkmcnt(5)
    v_mfma_f32_32x32x16_bf16 v[80:95], v[40:43], v[36:39], v[80:95]
    ds_read_b128 v[52:55], v5 offset:20480
    ds_read_b64_tr_b16 v[60:61], v7 offset:28672
    ds_read_b64_tr_b16 v[62:63], v7 offset:29696
    s_waitcnt lgkmcnt(6)
    v_mfma_f32_32x32x16_bf16 v[96:111], v[44:47], v[32:35], v[96:111]
    v_mfma_f32_32x32x16_bf16 v[112:127], v[44:47], v[36:39], v[112:127]
    s_waitcnt lgkmcnt(0)
    s_barrier
    v_mfma_f32_32x32x16_bf16 v[64:79], v[56:59], v[48:51], v[64:79]
    ds_read_b64_tr_b16 v[40:41], v6 offset:32768
    ds_read_b64_tr_b16 v[42:43], v6 offset:33792
    ds_read_b128 v[32:35], v2 offset:32768
    v_mfma_f32_32x32x16_bf16 v[80:95], v[56:59], v[52:55], v[80:95]
    ds_read_b128 v[36:39], v2 offset:36864
    ds_read_b64_tr_b16 v[44:45], v7 offset:32768
    ds_read_b64_tr_b16 v[46:47], v7 offset:33792
    v_mfma_f32_32x32x16_bf16 v[96:111], v[60:63], v[48:51], v[96:111]
    v_mfma_f32_32x32x16_bf16 v[112:127], v[60:63], v[52:55], v[112:127]
    s_waitcnt lgkmcnt(3)
    v_mfma_f32_32x32x16_bf16 v[64:79], v[40:43], v[32:35], v[64:79]
    ds_read_b64_tr_b16 v[56:57], v6 offset:36864
    ds_read_b64_tr_b16 v[58:59], v6 offset:37888
    ds_read_b128 v[48:51], v3 offset:32768
    s_waitcnt lgkmcnt(5)
    v_mfma_f32_32x32x16_bf16 v[80:95], v[40:43], v[36:39], v[80:95]
    ds_read_b128 v[52:55], v3 offset:36864
    ds_read_b64_tr_b16 v[60:61], v7 offset:36864
    ds_read_b64_tr_b16 v[62:63], v7 offset:37888
    s_waitcnt lgkmcnt(6)
    v_mfma_f32_32x32x16_bf16 v[96:111], v[44:47], v[32:35], v[96:111]
    v_mfma_f32_32x32x16_bf16 v[112:127], v[44:47], v[36:39], v[112:127]
    s_waitcnt lgkmcnt(3)
    v_mfma_f32_32x32x16_bf16 v[64:79], v[56:59], v[48:51], v[64:79]
    ds_read_b64_tr_b16 v[40:41], v6 offset:40960
    ds_read_b64_tr_b16 v[42:43], v6 offset:41984
    ds_read_b128 v[32:35], v4 offset:32768
    s_waitcnt lgkmcnt(5)
    v_mfma_f32_32x32x16_bf16 v[80:95], v[56:59], v[52:55], v[80:95]
    ds_read_b128 v[36:39], v4 offset:36864
    ds_read_b64_tr_b16 v[44:45], v7 offset:40960
    ds_read_b64_tr_b16 v[46:47], v7 offset:41984
    s_waitcnt lgkmcnt(6)
    v_mfma_f32_32x32x16_bf16 v[96:111], v[60:63], v[48:51], v[96:111]
    v_mfma_f32_32x32x16_bf16 v[112:127], v[60:63], v[52:55], v[112:127]
    s_waitcnt lgkmcnt(3)
    v_mfma_f32_32x32x16_bf16 v[64:79], v[40:43], v[32:35], v[64:79]
    ds_read_b64_tr_b16 v[56:57], v6 offset:45056
    ds_read_b64_tr_b16 v[58:59], v6 offset:46080
    ds_read_b128 v[48:51], v5 offset:32768
    s_waitcnt lgkmcnt(5)
    v_mfma_f32_32x32x16_bf16 v[80:95], v[40:43], v[36:39], v[80:95]
    ds_read_b128 v[52:55], v5 offset:36864
    ds_read_b64_tr_b16 v[60:61], v7 offset:45056
    ds_read_b64_tr_b16 v[62:63], v7 offset:46080
    s_waitcnt lgkmcnt(6)
    v_mfma_f32_32x32x16_bf16 v[96:111], v[44:47], v[32:35], v[96:111]
    v_mfma_f32_32x32x16_bf16 v[112:127], v[44:47], v[36:39], v[112:127]
    s_waitcnt lgkmcnt(0)
    s_barrier
    v_mfma_f32_32x32x16_bf16 v[64:79], v[56:59], v[48:51], v[64:79]
    ds_read_b64_tr_b16 v[40:41], v6 offset:0
    ds_read_b64_tr_b16 v[42:43], v6 offset:1024
    ds_read_b128 v[32:35], v2 offset:0
    v_mfma_f32_32x32x16_bf16 v[80:95], v[56:59], v[52:55], v[80:95]
    ds_read_b128 v[36:39], v2 offset:4096
    ds_read_b64_tr_b16 v[44:45], v7 offset:0
    ds_read_b64_tr_b16 v[46:47], v7 offset:1024
    v_mfma_f32_32x32x16_bf16 v[96:111], v[60:63], v[48:51], v[96:111]
    v_mfma_f32_32x32x16_bf16 v[112:127], v[60:63], v[52:55], v[112:127]
    s_waitcnt lgkmcnt(3)
    v_mfma_f32_32x32x16_bf16 v[64:79], v[40:43], v[32:35], v[64:79]
    ds_read_b64_tr_b16 v[56:57], v6 offset:4096
    ds_read_b64_tr_b16 v[58:59], v6 offset:5120
    ds_read_b128 v[48:51], v3 offset:0
    s_waitcnt lgkmcnt(5)
    v_mfma_f32_32x32x16_bf16 v[80:95], v[40:43], v[36:39], v[80:95]
    ds_read_b128 v[52:55], v3 offset:4096
    ds_read_b64_tr_b16 v[60:61], v7 offset:4096
    ds_read_b64_tr_b16 v[62:63], v7 offset:5120
    s_waitcnt lgkmcnt(6)
    v_mfma_f32_32x32x16_bf16 v[96:111], v[44:47], v[32:35], v[96:111]
    v_mfma_f32_32x32x16_bf16 v[112:127], v[44:47], v[36:39], v[112:127]
    s_waitcnt lgkmcnt(3)
    v_mfma_f32_32x32x16_bf16 v[64:79], v[56:59], v[48:51], v[64:79]
    ds_read_b64_tr_b16 v[40:41], v6 offset:8192
    ds_read_b64_tr_b16 v[42:43], v6 offset:9216
    ds_read_b128 v[32:35], v4 offset:0
    s_waitcnt lgkmcnt(5)
    v_mfma_f32_32x32x16_bf16 v[80:95], v[56:59], v[52:55], v[80:95]
    ds_read_b128 v[36:39], v4 offset:4096
    ds_read_b64_tr_b16 v[44:45], v7 offset:8192
    ds_read_b64_tr_b16 v[46:47], v7 offset:9216
    s_waitcnt lgkmcnt(6)
    v_mfma_f32_32x32x16_bf16 v[96:111], v[60:63], v[48:51], v[96:111]
    v_mfma_f32_32x32x16_bf16 v[112:127], v[60:63], v[52:55], v[112:127]
    s_waitcnt lgkmcnt(3)
    v_mfma_f32_32x32x16_bf16 v[64:79], v[40:43], v[32:35], v[64:79]
    ds_read_b64_tr_b16 v[56:57], v6 offset:12288
    ds_read_b64_tr_b16 v[58:59], v6 offset:13312
    ds_read_b128 v[48:51], v5 offset:0
    s_waitcnt lgkmcnt(5)
    v_mfma_f32_32x32x16_bf16 v[80:95], v[40:43], v[36:39], v[80:95]
    ds_read_b128 v[52:55], v5 offset:4096
    ds_read_b64_tr_b16 v[60:61], v7 offset:12288
    ds_read_b64_tr_b16 v[62:63], v7 offset:13312
    s_waitcnt lgkmcnt(6)
    v_mfma_f32_32x32x16_bf16 v[96:111], v[44:47], v[32:35], v[96:111]
    v_mfma_f32_32x32x16_bf16 v[112:127], v[44:47], v[36:39], v[112:127]
    s_waitcnt lgkmcnt(0)
    s_barrier
    v_mfma_f32_32x32x16_bf16 v[64:79], v[56:59], v[48:51], v[64:79]
    ds_read_b64_tr_b16 v[40:41], v6 offset:16384
    ds_read_b64_tr_b16 v[42:43], v6 offset:17408
    ds_read_b128 v[32:35], v2 offset:16384
    v_mfma_f32_32x32x16_bf16 v[80:95], v[56:59], v[52:55], v[80:95]
    ds_read_b128 v[36:39], v2 offset:20480
    ds_read_b64_tr_b16 v[44:45], v7 offset:16384
    ds_read_b64_tr_b16 v[46:47], v7 offset:17408
    v_mfma_f32_32x32x16_bf16 v[96:111], v[60:63], v[48:51], v[96:111]
    v_mfma_f32_32x32x16_bf16 v[112:127], v[60:63], v[52:55], v[112:127]
    s_waitcnt lgkmcnt(3)
    v_mfma_f32_32x32x16_bf16 v[64:79], v[40:43], v[32:35], v[64:79]
    ds_read_b64_tr_b16 v[56:57], v6 offset:20480
    ds_read_b64_tr_b16 v[58:59], v6 offset:21504
    ds_read_b128 v[48:51], v3 offset:16384
    s_waitcnt lgkmcnt(5)
    v_mfma_f32_32x32x16_bf16 v[80:95], v[40:43], v[36:39], v[80:95]
    ds_read_b128 v[52:55], v3 offset:20480
    ds_read_b64_tr_b16 v[60:61], v7 offset:20480
    ds_read_b64_tr_b16 v[62:63], v7 offset:21504
    s_waitcnt lgkmcnt(6)
    v_mfma_f32_32x32x16_bf16 v[96:111], v[44:47], v[32:35], v[96:111]
    v_mfma_f32_32x32x16_bf16 v[112:127], v[44:47], v[36:39], v[112:127]
    s_waitcnt lgkmcnt(3)
    v_mfma_f32_32x32x16_bf16 v[64:79], v[56:59], v[48:51], v[64:79]
    ds_read_b64_tr_b16 v[40:41], v6 offset:24576
    ds_read_b64_tr_b16 v[42:43], v6 offset:25600
    ds_read_b128 v[32:35], v4 offset:16384
    s_waitcnt lgkmcnt(5)
    v_mfma_f32_32x32x16_bf16 v[80:95], v[56:59], v[52:55], v[80:95]
    ds_read_b128 v[36:39], v4 offset:20480
    ds_read_b64_tr_b16 v[44:45], v7 offset:24576
    ds_read_b64_tr_b16 v[46:47], v7 offset:25600
    s_waitcnt lgkmcnt(6)
    v_mfma_f32_32x32x16_bf16 v[96:111], v[60:63], v[48:51], v[96:111]
    v_mfma_f32_32x32x16_bf16 v[112:127], v[60:63], v[52:55], v[112:127]
    s_waitcnt lgkmcnt(3)
    v_mfma_f32_32x32x16_bf16 v[64:79], v[40:43], v[32:35], v[64:79]
    ds_read_b64_tr_b16 v[56:57], v6 offset:28672
    ds_read_b64_tr_b16 v[58:59], v6 offset:29696
    ds_read_b128 v[48:51], v5 offset:16384
    s_waitcnt lgkmcnt(5)
    v_mfma_f32_32x32x16_bf16 v[80:95], v[40:43], v[36:39], v[80:95]
    ds_read_b128 v[52:55], v5 offset:20480
    ds_read_b64_tr_b16 v[60:61], v7 offset:28672
    ds_read_b64_tr_b16 v[62:63], v7 offset:29696
    s_waitcnt lgkmcnt(6)
    v_mfma_f32_32x32x16_bf16 v[96:111], v[44:47], v[32:35], v[96:111]
    v_mfma_f32_32x32x16_bf16 v[112:127], v[44:47], v[36:39], v[112:127]
    s_waitcnt lgkmcnt(0)
    s_barrier
    v_mfma_f32_32x32x16_bf16 v[64:79], v[56:59], v[48:51], v[64:79]
    ds_read_b64_tr_b16 v[40:41], v6 offset:32768
    ds_read_b64_tr_b16 v[42:43], v6 offset:33792
    ds_read_b128 v[32:35], v2 offset:32768
    v_mfma_f32_32x32x16_bf16 v[80:95], v[56:59], v[52:55], v[80:95]
    ds_read_b128 v[36:39], v2 offset:36864
    ds_read_b64_tr_b16 v[44:45], v7 offset:32768
    ds_read_b64_tr_b16 v[46:47], v7 offset:33792
    v_mfma_f32_32x32x16_bf16 v[96:111], v[60:63], v[48:51], v[96:111]
    v_mfma_f32_32x32x16_bf16 v[112:127], v[60:63], v[52:55], v[112:127]
    s_waitcnt lgkmcnt(3)
    v_mfma_f32_32x32x16_bf16 v[64:79], v[40:43], v[32:35], v[64:79]
    ds_read_b64_tr_b16 v[56:57], v6 offset:36864
    ds_read_b64_tr_b16 v[58:59], v6 offset:37888
    ds_read_b128 v[48:51], v3 offset:32768
    s_waitcnt lgkmcnt(5)
    v_mfma_f32_32x32x16_bf16 v[80:95], v[40:43], v[36:39], v[80:95]
    ds_read_b128 v[52:55], v3 offset:36864
    ds_read_b64_tr_b16 v[60:61], v7 offset:36864
    ds_read_b64_tr_b16 v[62:63], v7 offset:37888
    s_waitcnt lgkmcnt(6)
    v_mfma_f32_32x32x16_bf16 v[96:111], v[44:47], v[32:35], v[96:111]
    v_mfma_f32_32x32x16_bf16 v[112:127], v[44:47], v[36:39], v[112:127]
    s_waitcnt lgkmcnt(3)
    v_mfma_f32_32x32x16_bf16 v[64:79], v[56:59], v[48:51], v[64:79]
    ds_read_b64_tr_b16 v[40:41], v6 offset:40960
    ds_read_b64_tr_b16 v[42:43], v6 offset:41984
    ds_read_b128 v[32:35], v4 offset:32768
    s_waitcnt lgkmcnt(5)
    v_mfma_f32_32x32x16_bf16 v[80:95], v[56:59], v[52:55], v[80:95]
    ds_read_b128 v[36:39], v4 offset:36864
    ds_read_b64_tr_b16 v[44:45], v7 offset:40960
    ds_read_b64_tr_b16 v[46:47], v7 offset:41984
    s_waitcnt lgkmcnt(6)
    v_mfma_f32_32x32x16_bf16 v[96:111], v[60:63], v[48:51], v[96:111]
    v_mfma_f32_32x32x16_bf16 v[112:127], v[60:63], v[52:55], v[112:127]
    s_waitcnt lgkmcnt(3)
    v_mfma_f32_32x32x16_bf16 v[64:79], v[40:43], v[32:35], v[64:79]
    ds_read_b64_tr_b16 v[56:57], v6 offset:45056
    ds_read_b64_tr_b16 v[58:59], v6 offset:46080
    ds_read_b128 v[48:51], v5 offset:32768
    s_waitcnt lgkmcnt(5)
    v_mfma_f32_32x32x16_bf16 v[80:95], v[40:43], v[36:39], v[80:95]
    ds_read_b128 v[52:55], v5 offset:36864
    ds_read_b64_tr_b16 v[60:61], v7 offset:45056
    ds_read_b64_tr_b16 v[62:63], v7 offset:46080
    s_waitcnt lgkmcnt(6)
    v_mfma_f32_32x32x16_bf16 v[96:111], v[44:47], v[32:35], v[96:111]
    v_mfma_f32_32x32x16_bf16 v[112:127], v[44:47], v[36:39], v[112:127]
    s_waitcnt lgkmcnt(0)
    s_barrier
    v_mfma_f32_32x32x16_bf16 v[64:79], v[56:59], v[48:51], v[64:79]
    ds_read_b64_tr_b16 v[40:41], v6 offset:0
    ds_read_b64_tr_b16 v[42:43], v6 offset:1024
    ds_read_b128 v[32:35], v2 offset:0
    v_mfma_f32_32x32x16_bf16 v[80:95], v[56:59], v[52:55], v[80:95]
    ds_read_b128 v[36:39], v2 offset:4096
    ds_read_b64_tr_b16 v[44:45], v7 offset:0
    ds_read_b64_tr_b16 v[46:47], v7 offset:1024
    v_mfma_f32_32x32x16_bf16 v[96:111], v[60:63], v[48:51], v[96:111]
    v_mfma_f32_32x32x16_bf16 v[112:127], v[60:63], v[52:55], v[112:127]
    s_waitcnt lgkmcnt(3)
    v_mfma_f32_32x32x16_bf16 v[64:79], v[40:43], v[32:35], v[64:79]
    ds_read_b64_tr_b16 v[56:57], v6 offset:4096
    ds_read_b64_tr_b16 v[58:59], v6 offset:5120
    ds_read_b128 v[48:51], v3 offset:0
    s_waitcnt lgkmcnt(5)
    v_mfma_f32_32x32x16_bf16 v[80:95], v[40:43], v[36:39], v[80:95]
    ds_read_b128 v[52:55], v3 offset:4096
    ds_read_b64_tr_b16 v[60:61], v7 offset:4096
    ds_read_b64_tr_b16 v[62:63], v7 offset:5120
    s_waitcnt lgkmcnt(6)
    v_mfma_f32_32x32x16_bf16 v[96:111], v[44:47], v[32:35], v[96:111]
    v_mfma_f32_32x32x16_bf16 v[112:127], v[44:47], v[36:39], v[112:127]
    s_waitcnt lgkmcnt(3)
    v_mfma_f32_32x32x16_bf16 v[64:79], v[56:59], v[48:51], v[64:79]
    ds_read_b64_tr_b16 v[40:41], v6 offset:8192
    ds_read_b64_tr_b16 v[42:43], v6 offset:9216
    ds_read_b128 v[32:35], v4 offset:0
    s_waitcnt lgkmcnt(5)
    v_mfma_f32_32x32x16_bf16 v[80:95], v[56:59], v[52:55], v[80:95]
    ds_read_b128 v[36:39], v4 offset:4096
    ds_read_b64_tr_b16 v[44:45], v7 offset:8192
    ds_read_b64_tr_b16 v[46:47], v7 offset:9216
    s_waitcnt lgkmcnt(6)
    v_mfma_f32_32x32x16_bf16 v[96:111], v[60:63], v[48:51], v[96:111]
    v_mfma_f32_32x32x16_bf16 v[112:127], v[60:63], v[52:55], v[112:127]
    s_waitcnt lgkmcnt(3)
    v_mfma_f32_32x32x16_bf16 v[64:79], v[40:43], v[32:35], v[64:79]
    ds_read_b64_tr_b16 v[56:57], v6 offset:12288
    ds_read_b64_tr_b16 v[58:59], v6 offset:13312
    ds_read_b128 v[48:51], v5 offset:0
    s_waitcnt lgkmcnt(5)
    v_mfma_f32_32x32x16_bf16 v[80:95], v[40:43], v[36:39], v[80:95]
    ds_read_b128 v[52:55], v5 offset:4096
    ds_read_b64_tr_b16 v[60:61], v7 offset:12288
    ds_read_b64_tr_b16 v[62:63], v7 offset:13312
    s_waitcnt lgkmcnt(6)
    v_mfma_f32_32x32x16_bf16 v[96:111], v[44:47], v[32:35], v[96:111]
    v_mfma_f32_32x32x16_bf16 v[112:127], v[44:47], v[36:39], v[112:127]
    s_waitcnt lgkmcnt(0)
    s_barrier
    v_mfma_f32_32x32x16_bf16 v[64:79], v[56:59], v[48:51], v[64:79]
    ds_read_b64_tr_b16 v[40:41], v6 offset:16384
    ds_read_b64_tr_b16 v[42:43], v6 offset:17408
    ds_read_b128 v[32:35], v2 offset:16384
    v_mfma_f32_32x32x16_bf16 v[80:95], v[56:59], v[52:55], v[80:95]
    ds_read_b128 v[36:39], v2 offset:20480
    ds_read_b64_tr_b16 v[44:45], v7 offset:16384
    ds_read_b64_tr_b16 v[46:47], v7 offset:17408
    v_mfma_f32_32x32x16_bf16 v[96:111], v[60:63], v[48:51], v[96:111]
    v_mfma_f32_32x32x16_bf16 v[112:127], v[60:63], v[52:55], v[112:127]
    s_waitcnt lgkmcnt(3)
    v_mfma_f32_32x32x16_bf16 v[64:79], v[40:43], v[32:35], v[64:79]
    ds_read_b64_tr_b16 v[56:57], v6 offset:20480
    ds_read_b64_tr_b16 v[58:59], v6 offset:21504
    ds_read_b128 v[48:51], v3 offset:16384
    s_waitcnt lgkmcnt(5)
    v_mfma_f32_32x32x16_bf16 v[80:95], v[40:43], v[36:39], v[80:95]
    ds_read_b128 v[52:55], v3 offset:20480
    ds_read_b64_tr_b16 v[60:61], v7 offset:20480
    ds_read_b64_tr_b16 v[62:63], v7 offset:21504
    s_waitcnt lgkmcnt(6)
    v_mfma_f32_32x32x16_bf16 v[96:111], v[44:47], v[32:35], v[96:111]
    v_mfma_f32_32x32x16_bf16 v[112:127], v[44:47], v[36:39], v[112:127]
    s_waitcnt lgkmcnt(3)
    v_mfma_f32_32x32x16_bf16 v[64:79], v[56:59], v[48:51], v[64:79]
    ds_read_b64_tr_b16 v[40:41], v6 offset:24576
    ds_read_b64_tr_b16 v[42:43], v6 offset:25600
    ds_read_b128 v[32:35], v4 offset:16384
    s_waitcnt lgkmcnt(5)
    v_mfma_f32_32x32x16_bf16 v[80:95], v[56:59], v[52:55], v[80:95]
    ds_read_b128 v[36:39], v4 offset:20480
    ds_read_b64_tr_b16 v[44:45], v7 offset:24576
    ds_read_b64_tr_b16 v[46:47], v7 offset:25600
    s_waitcnt lgkmcnt(6)
    v_mfma_f32_32x32x16_bf16 v[96:111], v[60:63], v[48:51], v[96:111]
    v_mfma_f32_32x32x16_bf16 v[112:127], v[60:63], v[52:55], v[112:127]
    s_waitcnt lgkmcnt(3)
    v_mfma_f32_32x32x16_bf16 v[64:79], v[40:43], v[32:35], v[64:79]
    ds_read_b64_tr_b16 v[56:57], v6 offset:28672
    ds_read_b64_tr_b16 v[58:59], v6 offset:29696
    ds_read_b128 v[48:51], v5 offset:16384
    s_waitcnt lgkmcnt(5)
    v_mfma_f32_32x32x16_bf16 v[80:95], v[40:43], v[36:39], v[80:95]
    ds_read_b128 v[52:55], v5 offset:20480
    ds_read_b64_tr_b16 v[60:61], v7 offset:28672
    ds_read_b64_tr_b16 v[62:63], v7 offset:29696
    s_waitcnt lgkmcnt(6)
    v_mfma_f32_32x32x16_bf16 v[96:111], v[44:47], v[32:35], v[96:111]
    v_mfma_f32_32x32x16_bf16 v[112:127], v[44:47], v[36:39], v[112:127]
    s_waitcnt lgkmcnt(0)
    s_barrier
    v_mfma_f32_32x32x16_bf16 v[64:79], v[56:59], v[48:51], v[64:79]
    ds_read_b64_tr_b16 v[40:41], v6 offset:32768
    ds_read_b64_tr_b16 v[42:43], v6 offset:33792
    ds_read_b128 v[32:35], v2 offset:32768
    v_mfma_f32_32x32x16_bf16 v[80:95], v[56:59], v[52:55], v[80:95]
    ds_read_b128 v[36:39], v2 offset:36864
    ds_read_b64_tr_b16 v[44:45], v7 offset:32768
    ds_read_b64_tr_b16 v[46:47], v7 offset:33792
    v_mfma_f32_32x32x16_bf16 v[96:111], v[60:63], v[48:51], v[96:111]
    v_mfma_f32_32x32x16_bf16 v[112:127], v[60:63], v[52:55], v[112:127]
    s_waitcnt lgkmcnt(3)
    v_mfma_f32_32x32x16_bf16 v[64:79], v[40:43], v[32:35], v[64:79]
    ds_read_b64_tr_b16 v[56:57], v6 offset:36864
    ds_read_b64_tr_b16 v[58:59], v6 offset:37888
    ds_read_b128 v[48:51], v3 offset:32768
    s_waitcnt lgkmcnt(5)
    v_mfma_f32_32x32x16_bf16 v[80:95], v[40:43], v[36:39], v[80:95]
    ds_read_b128 v[52:55], v3 offset:36864
    ds_read_b64_tr_b16 v[60:61], v7 offset:36864
    ds_read_b64_tr_b16 v[62:63], v7 offset:37888
    s_waitcnt lgkmcnt(6)
    v_mfma_f32_32x32x16_bf16 v[96:111], v[44:47], v[32:35], v[96:111]
    v_mfma_f32_32x32x16_bf16 v[112:127], v[44:47], v[36:39], v[112:127]
    s_waitcnt lgkmcnt(3)
    v_mfma_f32_32x32x16_bf16 v[64:79], v[56:59], v[48:51], v[64:79]
    ds_read_b64_tr_b16 v[40:41], v6 offset:40960
    ds_read_b64_tr_b16 v[42:43], v6 offset:41984
    ds_read_b128 v[32:35], v4 offset:32768
    s_waitcnt lgkmcnt(5)
    v_mfma_f32_32x32x16_bf16 v[80:95], v[56:59], v[52:55], v[80:95]
    ds_read_b128 v[36:39], v4 offset:36864
    ds_read_b64_tr_b16 v[44:45], v7 offset:40960
    ds_read_b64_tr_b16 v[46:47], v7 offset:41984
    s_waitcnt lgkmcnt(6)
    v_mfma_f32_32x32x16_bf16 v[96:111], v[60:63], v[48:51], v[96:111]
    v_mfma_f32_32x32x16_bf16 v[112:127], v[60:63], v[52:55], v[112:127]
    s_waitcnt lgkmcnt(3)
    v_mfma_f32_32x32x16_bf16 v[64:79], v[40:43], v[32:35], v[64:79]
    ds_read_b64_tr_b16 v[56:57], v6 offset:45056
    ds_read_b64_tr_b16 v[58:59], v6 offset:46080
    ds_read_b128 v[48:51], v5 offset:32768
    s_waitcnt lgkmcnt(5)
    v_mfma_f32_32x32x16_bf16 v[80:95], v[40:43], v[36:39], v[80:95]
    ds_read_b128 v[52:55], v5 offset:36864
    ds_read_b64_tr_b16 v[60:61], v7 offset:45056
    ds_read_b64_tr_b16 v[62:63], v7 offset:46080
    s_waitcnt lgkmcnt(6)
    v_mfma_f32_32x32x16_bf16 v[96:111], v[44:47], v[32:35], v[96:111]
    v_mfma_f32_32x32x16_bf16 v[112:127], v[44:47], v[36:39], v[112:127]
    s_waitcnt lgkmcnt(0)
    s_barrier
    v_mfma_f32_32x32x16_bf16 v[64:79], v[56:59], v[48:51], v[64:79]
    ds_read_b64_tr_b16 v[40:41], v6 offset:0
    ds_read_b64_tr_b16 v[42:43], v6 offset:1024
    ds_read_b128 v[32:35], v2 offset:0
    ds_read_b64_tr_b16 v[160:161], v6 offset:4096
    ds_read_b64_tr_b16 v[162:163], v6 offset:5120
    v_mfma_f32_32x32x16_bf16 v[80:95], v[56:59], v[52:55], v[80:95]
    ds_read_b128 v[152:155], v3 offset:0
    ds_read_b64_tr_b16 v[176:177], v6 offset:8192
    ds_read_b64_tr_b16 v[178:179], v6 offset:9216
    ds_read_b128 v[168:171], v4 offset:0
    v_mfma_f32_32x32x16_bf16 v[96:111], v[60:63], v[48:51], v[96:111]
    v_mfma_f32_32x32x16_bf16 v[112:127], v[60:63], v[52:55], v[112:127]
    ds_read_b64_tr_b16 v[16:17], v6 offset:12288
    ds_read_b64_tr_b16 v[18:19], v6 offset:13312
    ds_read_b128 v[8:11], v5 offset:0
    s_waitcnt lgkmcnt(9)
    v_mfma_f32_32x32x16_bf16 v[64:79], v[40:43], v[32:35], v[64:79]
    ds_read_b128 v[36:39], v2 offset:4096
    s_waitcnt lgkmcnt(7)
    v_mfma_f32_32x32x16_bf16 v[64:79], v[160:163], v[152:155], v[64:79]
    ds_read_b128 v[156:159], v3 offset:4096
    s_waitcnt lgkmcnt(5)
    v_mfma_f32_32x32x16_bf16 v[64:79], v[176:179], v[168:171], v[64:79]
    ds_read_b128 v[172:175], v4 offset:4096
    s_waitcnt lgkmcnt(3)
    v_mfma_f32_32x32x16_bf16 v[64:79], v[16:19], v[8:11], v[64:79]
    ds_read_b128 v[12:15], v5 offset:4096
    s_waitcnt lgkmcnt(3)
    v_mfma_f32_32x32x16_bf16 v[80:95], v[40:43], v[36:39], v[80:95]
    ds_read_b64_tr_b16 v[44:45], v7 offset:0
    ds_read_b64_tr_b16 v[46:47], v7 offset:1024
    s_waitcnt lgkmcnt(4)
    v_mfma_f32_32x32x16_bf16 v[80:95], v[160:163], v[156:159], v[80:95]
    ds_read_b64_tr_b16 v[164:165], v7 offset:4096
    ds_read_b64_tr_b16 v[166:167], v7 offset:5120
    s_waitcnt lgkmcnt(5)
    v_mfma_f32_32x32x16_bf16 v[80:95], v[176:179], v[172:175], v[80:95]
    ds_read_b64_tr_b16 v[180:181], v7 offset:8192
    ds_read_b64_tr_b16 v[182:183], v7 offset:9216
    s_waitcnt lgkmcnt(6)
    v_mfma_f32_32x32x16_bf16 v[80:95], v[16:19], v[12:15], v[80:95]
    ds_read_b64_tr_b16 v[20:21], v7 offset:12288
    ds_read_b64_tr_b16 v[22:23], v7 offset:13312
    s_waitcnt lgkmcnt(6)
    v_mfma_f32_32x32x16_bf16 v[96:111], v[44:47], v[32:35], v[96:111]
    v_mul_f32 v64, s86, v64
    v_mul_f32 v65, s86, v65
    v_mul_f32 v66, s86, v66
    v_mul_f32 v67, s86, v67
    v_cvt_pk_bf16_f32 v64, v64, v65
    v_cvt_pk_bf16_f32 v65, v66, v67
    buffer_store_dwordx2 v[64:65], v136, s[28:31], s78 offen sc1
    s_waitcnt lgkmcnt(4)
    v_mfma_f32_32x32x16_bf16 v[96:111], v[164:167], v[152:155], v[96:111]
    v_mul_f32 v68, s86, v68
    v_mul_f32 v69, s86, v69
    v_mul_f32 v70, s86, v70
    v_mul_f32 v71, s86, v71
    v_cvt_pk_bf16_f32 v68, v68, v69
    v_cvt_pk_bf16_f32 v69, v70, v71
    buffer_store_dwordx2 v[68:69], v138, s[28:31], s79 offen sc1
    s_waitcnt lgkmcnt(2)
    v_mfma_f32_32x32x16_bf16 v[96:111], v[180:183], v[168:171], v[96:111]
    v_mul_f32 v72, s86, v72
    v_mul_f32 v73, s86, v73
    v_mul_f32 v74, s86, v74
    v_mul_f32 v75, s86, v75
    v_cvt_pk_bf16_f32 v72, v72, v73
    v_cvt_pk_bf16_f32 v73, v74, v75
    buffer_store_dwordx2 v[72:73], v140, s[28:31], s80 offen sc1
    s_waitcnt lgkmcnt(0)
    v_mfma_f32_32x32x16_bf16 v[96:111], v[20:23], v[8:11], v[96:111]
    v_mul_f32 v76, s86, v76
    v_mul_f32 v77, s86, v77
    v_mul_f32 v78, s86, v78
    v_mul_f32 v79, s86, v79
    v_cvt_pk_bf16_f32 v76, v76, v77
    v_cvt_pk_bf16_f32 v77, v78, v79
    buffer_store_dwordx2 v[76:77], v142, s[28:31], s81 offen sc1
    v_mfma_f32_32x32x16_bf16 v[112:127], v[44:47], v[36:39], v[112:127]
    v_mul_f32 v80, s86, v80
    v_mul_f32 v81, s86, v81
    v_mul_f32 v82, s86, v82
    v_mul_f32 v83, s86, v83
    v_cvt_pk_bf16_f32 v80, v80, v81
    v_cvt_pk_bf16_f32 v81, v82, v83
    buffer_store_dwordx2 v[80:81], v137, s[28:31], s78 offen sc1
    v_mfma_f32_32x32x16_bf16 v[112:127], v[164:167], v[156:159], v[112:127]
    v_mul_f32 v84, s86, v84
    v_mul_f32 v85, s86, v85
    v_mul_f32 v86, s86, v86
    v_mul_f32 v87, s86, v87
    v_cvt_pk_bf16_f32 v84, v84, v85
    v_cvt_pk_bf16_f32 v85, v86, v87
    buffer_store_dwordx2 v[84:85], v139, s[28:31], s79 offen sc1
    v_mfma_f32_32x32x16_bf16 v[112:127], v[180:183], v[172:175], v[112:127]
    v_mul_f32 v88, s86, v88
    v_mul_f32 v89, s86, v89
    v_mul_f32 v90, s86, v90
    v_mul_f32 v91, s86, v91
    v_cvt_pk_bf16_f32 v88, v88, v89
    v_cvt_pk_bf16_f32 v89, v90, v91
    buffer_store_dwordx2 v[88:89], v141, s[28:31], s80 offen sc1
    v_mfma_f32_32x32x16_bf16 v[112:127], v[20:23], v[12:15], v[112:127]
    v_mul_f32 v92, s86, v92
    v_mul_f32 v93, s86, v93
    v_mul_f32 v94, s86, v94
    v_mul_f32 v95, s86, v95
    v_cvt_pk_bf16_f32 v92, v92, v93
    v_cvt_pk_bf16_f32 v93, v94, v95
    buffer_store_dwordx2 v[92:93], v143, s[28:31], s81 offen sc1
    v_mul_f32 v96, s86, v96
    v_mul_f32 v97, s86, v97
    v_mul_f32 v98, s86, v98
    v_mul_f32 v99, s86, v99
    v_cvt_pk_bf16_f32 v96, v96, v97
    v_cvt_pk_bf16_f32 v97, v98, v99
    buffer_store_dwordx2 v[96:97], v144, s[28:31], s82 offen sc1
    v_mul_f32 v100, s86, v100
    v_mul_f32 v101, s86, v101
    v_mul_f32 v102, s86, v102
    v_mul_f32 v103, s86, v103
    v_cvt_pk_bf16_f32 v100, v100, v101
    v_cvt_pk_bf16_f32 v101, v102, v103
    buffer_store_dwordx2 v[100:101], v146, s[28:31], s83 offen sc1
    v_mul_f32 v104, s86, v104
    v_mul_f32 v105, s86, v105
    v_mul_f32 v106, s86, v106
    v_mul_f32 v107, s86, v107
    v_cvt_pk_bf16_f32 v104, v104, v105
    v_cvt_pk_bf16_f32 v105, v106, v107
    buffer_store_dwordx2 v[104:105], v148, s[28:31], s84 offen sc1
    v_mul_f32 v108, s86, v108
    v_mul_f32 v109, s86, v109
    v_mul_f32 v110, s86, v110
    v_mul_f32 v111, s86, v111
    v_cvt_pk_bf16_f32 v108, v108, v109
    v_cvt_pk_bf16_f32 v109, v110, v111
    buffer_store_dwordx2 v[108:109], v150, s[28:31], s85 offen sc1
    v_mul_f32 v112, s86, v112
    v_mul_f32 v113, s86, v113
    v_mul_f32 v114, s86, v114
    v_mul_f32 v115, s86, v115
    v_cvt_pk_bf16_f32 v112, v112, v113
    v_cvt_pk_bf16_f32 v113, v114, v115
    buffer_store_dwordx2 v[112:113], v145, s[28:31], s82 offen sc1
    v_mul_f32 v116, s86, v116
    v_mul_f32 v117, s86, v117
    v_mul_f32 v118, s86, v118
    v_mul_f32 v119, s86, v119
    v_cvt_pk_bf16_f32 v116, v116, v117
    v_cvt_pk_bf16_f32 v117, v118, v119
    buffer_store_dwordx2 v[116:117], v147, s[28:31], s83 offen sc1
    v_mul_f32 v120, s86, v120
    v_mul_f32 v121, s86, v121
    v_mul_f32 v122, s86, v122
    v_mul_f32 v123, s86, v123
    v_cvt_pk_bf16_f32 v120, v120, v121
    v_cvt_pk_bf16_f32 v121, v122, v123
    buffer_store_dwordx2 v[120:121], v149, s[28:31], s84 offen sc1
    v_mul_f32 v124, s86, v124
    v_mul_f32 v125, s86, v125
    v_mul_f32 v126, s86, v126
    v_mul_f32 v127, s86, v127
    v_cvt_pk_bf16_f32 v124, v124, v125
    v_cvt_pk_bf16_f32 v125, v126, v127
    buffer_store_dwordx2 v[124:125], v151, s[28:31], s85 offen sc1
    v_mov_b32 v48, v240
    v_mov_b32 v49, v240
    v_mov_b32 v50, v240
    v_mov_b32 v51, v240
    v_mov_b32 v52, v240
    v_mov_b32 v53, v240
    v_mov_b32 v54, v240
    v_mov_b32 v55, v240
    v_mov_b32 v56, v240
    v_mov_b32 v57, v240
    v_mov_b32 v58, v240
    v_mov_b32 v59, v240
    v_mov_b32 v60, v240
    v_mov_b32 v61, v240
    v_mov_b32 v62, v240
    v_mov_b32 v63, v240
    s_branch L_C_FLAG
L_C_NOTILE:
    s_call_b64 s[52:53], L_SPARE
    v_mov_b32 v14, 162048
    s_mov_b32 s62, 0
SIG_85:
    ds_read_b32 v15, v14 offset:8
    s_waitcnt lgkmcnt(0)
    v_readfirstlane_b32 s64, v15
    s_add_u32 s62, s62, 1
    s_cmp_ge_u32 s64, 8
    s_cbranch_scc1 SIGD_86
    s_sleep 1
    s_cmp_lt_u32 s62, 8000000
    s_cbranch_scc1 SIG_85
SIGD_86:
    s_mov_b32 s32, s4
    s_mov_b32 s33, s5
    s_mov_b32 s34, 0x280000
    s_mov_b32 s35, 0x20000
    s_mov_b32 s36, s22
    s_mov_b32 s37, s23
    s_mov_b32 s38, 0x500
    s_mov_b32 s39, 0x20000
    s_lshl_b32 s64, s71, 7
    s_lshl_b32 s65, s3, 5
    s_add_u32 s70, s64, s65
    v_lshrrev_b32 v10, 4, v0
    v_add_u32 v11, s70, v10
    v_mul_u32_u24 v11, 1280, v11
    v_and_b32 v2, 15, v0
    v_lshlrev_b32 v3, 4, v2
    v_add_u32 v11, v11, v3
    buffer_load_dwordx4 v[12:15], v3, s[36:39], 0 offen offset:0
    buffer_load_dwordx4 v[16:19], v3, s[36:39], 0 offen offset:256
    buffer_load_dwordx4 v[20:23], v3, s[36:39], 0 offen offset:512
    buffer_load_dwordx4 v[24:27], v3, s[36:39], 0 offen offset:768
    buffer_load_dwordx4 v[28:31], v3, s[36:39], 0 offen offset:1024
    s_mov_b32 s64, 0
    buffer_load_dwordx4 v[32:35], v11, s[32:35], s64 offen offset:0
    buffer_load_dwordx4 v[36:39], v11, s[32:35], s64 offen offset:256
    buffer_load_dwordx4 v[40:43], v11, s[32:35], s64 offen offset:512
    buffer_load_dwordx4 v[44:47], v11, s[32:35], s64 offen offset:768
    buffer_load_dwordx4 v[48:51], v11, s[32:35], s64 offen offset:1024
    s_mov_b32 s64, 5120
    buffer_load_dwordx4 v[52:55], v11, s[32:35], s64 offen offset:0
    buffer_load_dwordx4 v[56:59], v11, s[32:35], s64 offen offset:256
    buffer_load_dwordx4 v[60:63], v11, s[32:35], s64 offen offset:512
    buffer_load_dwordx4 v[64:67], v11, s[32:35], s64 offen offset:768
    buffer_load_dwordx4 v[68:71], v11, s[32:35], s64 offen offset:1024
    s_mov_b32 s64, 10240
    buffer_load_dwordx4 v[72:75], v11, s[32:35], s64 offen offset:0
    buffer_load_dwordx4 v[76:79], v11, s[32:35], s64 offen offset:256
    buffer_load_dwordx4 v[80:83], v11, s[32:35], s64 offen offset:512
    buffer_load_dwordx4 v[84:87], v11, s[32:35], s64 offen offset:768
    buffer_load_dwordx4 v[88:91], v11, s[32:35], s64 offen offset:1024
    s_mov_b32 s64, 15360
    buffer_load_dwordx4 v[92:95], v11, s[32:35], s64 offen offset:0
    buffer_load_dwordx4 v[96:99], v11, s[32:35], s64 offen offset:256
    buffer_load_dwordx4 v[100:103], v11, s[32:35], s64 offen offset:512
    buffer_load_dwordx4 v[104:107], v11, s[32:35], s64 offen offset:768
    buffer_load_dwordx4 v[108:111], v11, s[32:35], s64 offen offset:1024
    s_mov_b32 s64, 20480
    buffer_load_dwordx4 v[112:115], v11, s[32:35], s64 offen offset:0
    buffer_load_dwordx4 v[116:119], v11, s[32:35], s64 offen offset:256
    buffer_load_dwordx4 v[120:123], v11, s[32:35], s64 offen offset:512
    buffer_load_dwordx4 v[124:127], v11, s[32:35], s64 offen offset:768
    buffer_load_dwordx4 v[128:131], v11, s[32:35], s64 offen offset:1024
    s_mov_b32 s64, 25600
    buffer_load_dwordx4 v[132:135], v11, s[32:35], s64 offen offset:0
    buffer_load_dwordx4 v[136:139], v11, s[32:35], s64 offen offset:256
    buffer_load_dwordx4 v[140:143], v11, s[32:35], s64 offen offset:512
    buffer_load_dwordx4 v[144:147], v11, s[32:35], s64 offen offset:768
    buffer_load_dwordx4 v[148:151], v11, s[32:35], s64 offen offset:1024
    s_mov_b32 s64, 30720
    buffer_load_dwordx4 v[152:155], v11, s[32:35], s64 offen offset:0
    buffer_load_dwordx4 v[156:159], v11, s[32:35], s64 offen offset:256
    buffer_load_dwordx4 v[160:163], v11, s[32:35], s64 offen offset:512
    buffer_load_dwordx4 v[164:167], v11, s[32:35], s64 offen offset:768
    buffer_load_dwordx4 v[168:171], v11, s[32:35], s64 offen offset:1024
    s_mov_b32 s64, 35840
    buffer_load_dwordx4 v[172:175], v11, s[32:35], s64 offen offset:0
    buffer_load_dwordx4 v[176:179], v11, s[32:35], s64 offen offset:256
    buffer_load_dwordx4 v[180:183], v11, s[32:35], s64 offen offset:512
    buffer_load_dwordx4 v[184:187], v11, s[32:35], s64 offen offset:768
    buffer_load_dwordx4 v[188:191], v11, s[32:35], s64 offen offset:1024
    v_lshl_add_u32 v10, v2, 2, v10
    v_add_u32 v10, s70, v10
    v_lshlrev_b32 v10, 2, v10
    v_add_u32 v10, 0xf0e000, v10
    v_mov_b32 v11, v2
    s_waitcnt vmcnt(35)
    v_dot2_f32_bf16 v2, v32, v12, 0
    v_dot2_f32_bf16 v2, v33, v13, v2
    v_dot2_f32_bf16 v2, v34, v14, v2
    v_dot2_f32_bf16 v2, v35, v15, v2
    v_dot2_f32_bf16 v2, v36, v16, v2
    v_dot2_f32_bf16 v2, v37, v17, v2
    v_dot2_f32_bf16 v2, v38, v18, v2
    v_dot2_f32_bf16 v2, v39, v19, v2
    v_dot2_f32_bf16 v2, v40, v20, v2
    v_dot2_f32_bf16 v2, v41, v21, v2
    v_dot2_f32_bf16 v2, v42, v22, v2
    v_dot2_f32_bf16 v2, v43, v23, v2
    v_dot2_f32_bf16 v2, v44, v24, v2
    v_dot2_f32_bf16 v2, v45, v25, v2
    v_dot2_f32_bf16 v2, v46, v26, v2
    v_dot2_f32_bf16 v2, v47, v27, v2
    v_dot2_f32_bf16 v2, v48, v28, v2
    v_dot2_f32_bf16 v2, v49, v29, v2
    v_dot2_f32_bf16 v2, v50, v30, v2
    v_dot2_f32_bf16 v2, v51, v31, v2
    s_waitcnt vmcnt(30)
    v_dot2_f32_bf16 v3, v52, v12, 0
    v_dot2_f32_bf16 v3, v53, v13, v3
    v_dot2_f32_bf16 v3, v54, v14, v3
    v_dot2_f32_bf16 v3, v55, v15, v3
    v_dot2_f32_bf16 v3, v56, v16, v3
    v_dot2_f32_bf16 v3, v57, v17, v3
    v_dot2_f32_bf16 v3, v58, v18, v3
    v_dot2_f32_bf16 v3, v59, v19, v3
    v_dot2_f32_bf16 v3, v60, v20, v3
    v_dot2_f32_bf16 v3, v61, v21, v3
    v_dot2_f32_bf16 v3, v62, v22, v3
    v_dot2_f32_bf16 v3, v63, v23, v3
    v_dot2_f32_bf16 v3, v64, v24, v3
    v_dot2_f32_bf16 v3, v65, v25, v3
    v_dot2_f32_bf16 v3, v66, v26, v3
    v_dot2_f32_bf16 v3, v67, v27, v3
    v_dot2_f32_bf16 v3, v68, v28, v3
    v_dot2_f32_bf16 v3, v69, v29, v3
    v_dot2_f32_bf16 v3, v70, v30, v3
    v_dot2_f32_bf16 v3, v71, v31, v3
    s_waitcnt vmcnt(25)
    v_dot2_f32_bf16 v4, v72, v12, 0
    v_dot2_f32_bf16 v4, v73, v13, v4
    v_dot2_f32_bf16 v4, v74, v14, v4
    v_dot2_f32_bf16 v4, v75, v15, v4
    v_dot2_f32_bf16 v4, v76, v16, v4
    v_dot2_f32_bf16 v4, v77, v17, v4
    v_dot2_f32_bf16 v4, v78, v18, v4
    v_dot2_f32_bf16 v4, v79, v19, v4
    v_dot2_f32_bf16 v4, v80, v20, v4
    v_dot2_f32_bf16 v4, v81, v21, v4
    v_dot2_f32_bf16 v4, v82, v22, v4
    v_dot2_f32_bf16 v4, v83, v23, v4
    v_dot2_f32_bf16 v4, v84, v24, v4
    v_dot2_f32_bf16 v4, v85, v25, v4
    v_dot2_f32_bf16 v4, v86, v26, v4
    v_dot2_f32_bf16 v4, v87, v27, v4
    v_dot2_f32_bf16 v4, v88, v28, v4
    v_dot2_f32_bf16 v4, v89, v29, v4
    v_dot2_f32_bf16 v4, v90, v30, v4
    v_dot2_f32_bf16 v4, v91, v31, v4
    s_waitcnt vmcnt(20)
    v_dot2_f32_bf16 v5, v92, v12, 0
    v_dot2_f32_bf16 v5, v93, v13, v5
    v_dot2_f32_bf16 v5, v94, v14, v5
    v_dot2_f32_bf16 v5, v95, v15, v5
    v_dot2_f32_bf16 v5, v96, v16, v5
    v_dot2_f32_bf16 v5, v97, v17, v5
    v_dot2_f32_bf16 v5, v98, v18, v5
    v_dot2_f32_bf16 v5, v99, v19, v5
    v_dot2_f32_bf16 v5, v100, v20, v5
    v_dot2_f32_bf16 v5, v101, v21, v5
    v_dot2_f32_bf16 v5, v102, v22, v5
    v_dot2_f32_bf16 v5, v103, v23, v5
    v_dot2_f32_bf16 v5, v104, v24, v5
    v_dot2_f32_bf16 v5, v105, v25, v5
    v_dot2_f32_bf16 v5, v106, v26, v5
    v_dot2_f32_bf16 v5, v107, v27, v5
    v_dot2_f32_bf16 v5, v108, v28, v5
    v_dot2_f32_bf16 v5, v109, v29, v5
    v_dot2_f32_bf16 v5, v110, v30, v5
    v_dot2_f32_bf16 v5, v111, v31, v5
    s_waitcnt vmcnt(15)
    v_dot2_f32_bf16 v6, v112, v12, 0
    v_dot2_f32_bf16 v6, v113, v13, v6
    v_dot2_f32_bf16 v6, v114, v14, v6
    v_dot2_f32_bf16 v6, v115, v15, v6
    v_dot2_f32_bf16 v6, v116, v16, v6
    v_dot2_f32_bf16 v6, v117, v17, v6
    v_dot2_f32_bf16 v6, v118, v18, v6
    v_dot2_f32_bf16 v6, v119, v19, v6
    v_dot2_f32_bf16 v6, v120, v20, v6
    v_dot2_f32_bf16 v6, v121, v21, v6
    v_dot2_f32_bf16 v6, v122, v22, v6
    v_dot2_f32_bf16 v6, v123, v23, v6
    v_dot2_f32_bf16 v6, v124, v24, v6
    v_dot2_f32_bf16 v6, v125, v25, v6
    v_dot2_f32_bf16 v6, v126, v26, v6
    v_dot2_f32_bf16 v6, v127, v27, v6
    v_dot2_f32_bf16 v6, v128, v28, v6
    v_dot2_f32_bf16 v6, v129, v29, v6
    v_dot2_f32_bf16 v6, v130, v30, v6
    v_dot2_f32_bf16 v6, v131, v31, v6
    s_waitcnt vmcnt(10)
    v_dot2_f32_bf16 v7, v132, v12, 0
    v_dot2_f32_bf16 v7, v133, v13, v7
    v_dot2_f32_bf16 v7, v134, v14, v7
    v_dot2_f32_bf16 v7, v135, v15, v7
    v_dot2_f32_bf16 v7, v136, v16, v7
    v_dot2_f32_bf16 v7, v137, v17, v7
    v_dot2_f32_bf16 v7, v138, v18, v7
    v_dot2_f32_bf16 v7, v139, v19, v7
    v_dot2_f32_bf16 v7, v140, v20, v7
    v_dot2_f32_bf16 v7, v141, v21, v7
    v_dot2_f32_bf16 v7, v142, v22, v7
    v_dot2_f32_bf16 v7, v143, v23, v7
    v_dot2_f32_bf16 v7, v144, v24, v7
    v_dot2_f32_bf16 v7, v145, v25, v7
    v_dot2_f32_bf16 v7, v146, v26, v7
    v_dot2_f32_bf16 v7, v147, v27, v7
    v_dot2_f32_bf16 v7, v148, v28, v7
    v_dot2_f32_bf16 v7, v149, v29, v7
    v_dot2_f32_bf16 v7, v150, v30, v7
    v_dot2_f32_bf16 v7, v151, v31, v7
    s_waitcnt vmcnt(5)
    v_dot2_f32_bf16 v8, v152, v12, 0
    v_dot2_f32_bf16 v8, v153, v13, v8
    v_dot2_f32_bf16 v8, v154, v14, v8
    v_dot2_f32_bf16 v8, v155, v15, v8
    v_dot2_f32_bf16 v8, v156, v16, v8
    v_dot2_f32_bf16 v8, v157, v17, v8
    v_dot2_f32_bf16 v8, v158, v18, v8
    v_dot2_f32_bf16 v8, v159, v19, v8
    v_dot2_f32_bf16 v8, v160, v20, v8
    v_dot2_f32_bf16 v8, v161, v21, v8
    v_dot2_f32_bf16 v8, v162, v22, v8
    v_dot2_f32_bf16 v8, v163, v23, v8
    v_dot2_f32_bf16 v8, v164, v24, v8
    v_dot2_f32_bf16 v8, v165, v25, v8
    v_dot2_f32_bf16 v8, v166, v26, v8
    v_dot2_f32_bf16 v8, v167, v27, v8
    v_dot2_f32_bf16 v8, v168, v28, v8
    v_dot2_f32_bf16 v8, v169, v29, v8
    v_dot2_f32_bf16 v8, v170, v30, v8
    v_dot2_f32_bf16 v8, v171, v31, v8
    s_waitcnt vmcnt(0)
    v_dot2_f32_bf16 v9, v172, v12, 0
    v_dot2_f32_bf16 v9, v173, v13, v9
    v_dot2_f32_bf16 v9, v174, v14, v9
    v_dot2_f32_bf16 v9, v175, v15, v9
    v_dot2_f32_bf16 v9, v176, v16, v9
    v_dot2_f32_bf16 v9, v177, v17, v9
    v_dot2_f32_bf16 v9, v178, v18, v9
    v_dot2_f32_bf16 v9, v179, v19, v9
    v_dot2_f32_bf16 v9, v180, v20, v9
    v_dot2_f32_bf16 v9, v181, v21, v9
    v_dot2_f32_bf16 v9, v182, v22, v9
    v_dot2_f32_bf16 v9, v183, v23, v9
    v_dot2_f32_bf16 v9, v184, v24, v9
    v_dot2_f32_bf16 v9, v185, v25, v9
    v_dot2_f32_bf16 v9, v186, v26, v9
    v_dot2_f32_bf16 v9, v187, v27, v9
    v_dot2_f32_bf16 v9, v188, v28, v9
    v_dot2_f32_bf16 v9, v189, v29, v9
    v_dot2_f32_bf16 v9, v190, v30, v9
    v_dot2_f32_bf16 v9, v191, v31, v9
    s_nop 2
    v_add_f32_dpp v2, v2, v2 row_ror:8 row_mask:0xf bank_mask:0xf
    v_add_f32_dpp v3, v3, v3 row_ror:8 row_mask:0xf bank_mask:0xf
    v_add_f32_dpp v4, v4, v4 row_ror:8 row_mask:0xf bank_mask:0xf
    v_add_f32_dpp v5, v5, v5 row_ror:8 row_mask:0xf bank_mask:0xf
    v_add_f32_dpp v6, v6, v6 row_ror:8 row_mask:0xf bank_mask:0xf
    v_add_f32_dpp v7, v7, v7 row_ror:8 row_mask:0xf bank_mask:0xf
    v_add_f32_dpp v8, v8, v8 row_ror:8 row_mask:0xf bank_mask:0xf
    v_add_f32_dpp v9, v9, v9 row_ror:8 row_mask:0xf bank_mask:0xf
    v_add_f32_dpp v2, v2, v2 row_ror:4 row_mask:0xf bank_mask:0xf
    v_add_f32_dpp v3, v3, v3 row_ror:4 row_mask:0xf bank_mask:0xf
    v_add_f32_dpp v4, v4, v4 row_ror:4 row_mask:0xf bank_mask:0xf
    v_add_f32_dpp v5, v5, v5 row_ror:4 row_mask:0xf bank_mask:0xf
    v_add_f32_dpp v6, v6, v6 row_ror:4 row_mask:0xf bank_mask:0xf
    v_add_f32_dpp v7, v7, v7 row_ror:4 row_mask:0xf bank_mask:0xf
    v_add_f32_dpp v8, v8, v8 row_ror:4 row_mask:0xf bank_mask:0xf
    v_add_f32_dpp v9, v9, v9 row_ror:4 row_mask:0xf bank_mask:0xf
    v_add_f32_dpp v2, v2, v2 row_ror:2 row_mask:0xf bank_mask:0xf
    v_add_f32_dpp v3, v3, v3 row_ror:2 row_mask:0xf bank_mask:0xf
    v_add_f32_dpp v4, v4, v4 row_ror:2 row_mask:0xf bank_mask:0xf
    v_add_f32_dpp v5, v5, v5 row_ror:2 row_mask:0xf bank_mask:0xf
    v_add_f32_dpp v6, v6, v6 row_ror:2 row_mask:0xf bank_mask:0xf
    v_add_f32_dpp v7, v7, v7 row_ror:2 row_mask:0xf bank_mask:0xf
    v_add_f32_dpp v8, v8, v8 row_ror:2 row_mask:0xf bank_mask:0xf
    v_add_f32_dpp v9, v9, v9 row_ror:2 row_mask:0xf bank_mask:0xf
    v_add_f32_dpp v2, v2, v2 row_ror:1 row_mask:0xf bank_mask:0xf
    v_add_f32_dpp v3, v3, v3 row_ror:1 row_mask:0xf bank_mask:0xf
    v_add_f32_dpp v4, v4, v4 row_ror:1 row_mask:0xf bank_mask:0xf
    v_add_f32_dpp v5, v5, v5 row_ror:1 row_mask:0xf bank_mask:0xf
    v_add_f32_dpp v6, v6, v6 row_ror:1 row_mask:0xf bank_mask:0xf
    v_add_f32_dpp v7, v7, v7 row_ror:1 row_mask:0xf bank_mask:0xf
    v_add_f32_dpp v8, v8, v8 row_ror:1 row_mask:0xf bank_mask:0xf
    v_add_f32_dpp v9, v9, v9 row_ror:1 row_mask:0xf bank_mask:0xf
    v_cmp_eq_u32 vcc, 1, v11
    s_nop 1
    v_cndmask_b32 v2, v2, v3, vcc
    v_cmp_eq_u32 vcc, 2, v11
    s_nop 1
    v_cndmask_b32 v2, v2, v4, vcc
    v_cmp_eq_u32 vcc, 3, v11
    s_nop 1
    v_cndmask_b32 v2, v2, v5, vcc
    v_cmp_eq_u32 vcc, 4, v11
    s_nop 1
    v_cndmask_b32 v2, v2, v6, vcc
    v_cmp_eq_u32 vcc, 5, v11
    s_nop 1
    v_cndmask_b32 v2, v2, v7, vcc
    v_cmp_eq_u32 vcc, 6, v11
    s_nop 1
    v_cndmask_b32 v2, v2, v8, vcc
    v_cmp_eq_u32 vcc, 7, v11
    s_nop 1
    v_cndmask_b32 v2, v2, v9, vcc
    v_mul_f32 v2, 0xbfb8aa3b, v2
    v_exp_f32 v2, v2
    s_mov_b32 exec_lo, 0x00ff00ff
    v_add_f32 v2, 1.0, v2
    v_rcp_f32 v2, v2
    s_mov_b32 exec_hi, 0x00ff00ff
    buffer_store_dword v2, v10, s[28:31], 0 offen sc1
    s_mov_b64 exec, -1
    v_mov_b32 v48, v240
    v_mov_b32 v49, v240
    v_mov_b32 v50, v240
    v_mov_b32 v51, v240
    v_mov_b32 v52, v240
    v_mov_b32 v53, v240
    v_mov_b32 v54, v240
    v_mov_b32 v55, v240
    v_mov_b32 v56, v240
    v_mov_b32 v57, v240
    v_mov_b32 v58, v240
    v_mov_b32 v59, v240
    v_mov_b32 v60, v240
    v_mov_b32 v61, v240
    v_mov_b32 v62, v240
    v_mov_b32 v63, v240
    s_branch L_C_FLAG
L_C_VTILE:
    s_sub_u32 s64, s50, 10
    s_lshl_b32 s64, s64, 7
    s_and_b32 s65, s3, 2
    s_lshl_b32 s65, s65, 5
    s_add_u32 s64, s64, s65
    s_lshl_b32 s65, s51, 1
    s_and_b32 s66, s3, 1
    s_add_u32 s65, s65, s66
    s_mul_i32 s65, s65, 5120
    s_add_u32 s78, s65, 2560
    s_mov_b32 s66, 163520
    v_and_b32 v8, 31, v0
    v_lshrrev_b32 v9, 5, v0
    v_mul_u32_u24 v9, 320, v9
    v_add_u32 v10, s64, v8
    v_add_u32 v10, 0, v10
    v_mul_u32_u24 v11, 3277, v10
    v_lshrrev_b32 v11, 16, v11
    v_mul_lo_u32 v11, v11, s66
    v_lshl_add_u32 v10, v10, 4, v9
    v_add_u32 v136, v10, v11
    v_add_u32 v10, s64, v8
    v_add_u32 v10, 32, v10
    v_mul_u32_u24 v11, 3277, v10
    v_lshrrev_b32 v11, 16, v11
    v_mul_lo_u32 v11, v11, s66
    v_lshl_add_u32 v10, v10, 4, v9
    v_add_u32 v137, v10, v11
    s_barrier
    ds_read_b128 v[32:35], v2 offset:0
    ds_read_b64_tr_b16 v[40:41], v6 offset:0
    ds_read_b64_tr_b16 v[42:43], v6 offset:1024
    ds_read_b64_tr_b16 v[44:45], v7 offset:0
    ds_read_b64_tr_b16 v[46:47], v7 offset:1024
    ds_read_b128 v[36:39], v2 offset:4096
    s_waitcnt lgkmcnt(3)
    v_mfma_f32_32x32x16_bf16 v[64:79], v[32:35], v[40:43], 0
    ds_read_b128 v[48:51], v3 offset:0
    ds_read_b64_tr_b16 v[56:57], v6 offset:4096
    ds_read_b64_tr_b16 v[58:59], v6 offset:5120
    s_waitcnt lgkmcnt(4)
    v_mfma_f32_32x32x16_bf16 v[80:95], v[32:35], v[44:47], 0
    ds_read_b64_tr_b16 v[60:61], v7 offset:4096
    ds_read_b64_tr_b16 v[62:63], v7 offset:5120
    ds_read_b128 v[52:55], v3 offset:4096
    s_waitcnt lgkmcnt(6)
    v_mfma_f32_32x32x16_bf16 v[96:111], v[36:39], v[40:43], 0
    v_mfma_f32_32x32x16_bf16 v[112:127], v[36:39], v[44:47], 0
    s_waitcnt lgkmcnt(3)
    v_mfma_f32_32x32x16_bf16 v[64:79], v[48:51], v[56:59], v[64:79]
    ds_read_b128 v[32:35], v4 offset:0
    ds_read_b64_tr_b16 v[40:41], v6 offset:8192
    ds_read_b64_tr_b16 v[42:43], v6 offset:9216
    s_waitcnt lgkmcnt(4)
    v_mfma_f32_32x32x16_bf16 v[80:95], v[48:51], v[60:63], v[80:95]
    ds_read_b64_tr_b16 v[44:45], v7 offset:8192
    ds_read_b64_tr_b16 v[46:47], v7 offset:9216
    ds_read_b128 v[36:39], v4 offset:4096
    s_waitcnt lgkmcnt(6)
    v_mfma_f32_32x32x16_bf16 v[96:111], v[52:55], v[56:59], v[96:111]
    v_mfma_f32_32x32x16_bf16 v[112:127], v[52:55], v[60:63], v[112:127]
    s_waitcnt lgkmcnt(3)
    v_mfma_f32_32x32x16_bf16 v[64:79], v[32:35], v[40:43], v[64:79]
    ds_read_b128 v[48:51], v5 offset:0
    ds_read_b64_tr_b16 v[56:57], v6 offset:12288
    ds_read_b64_tr_b16 v[58:59], v6 offset:13312
    s_waitcnt lgkmcnt(4)
    v_mfma_f32_32x32x16_bf16 v[80:95], v[32:35], v[44:47], v[80:95]
    ds_read_b64_tr_b16 v[60:61], v7 offset:12288
    ds_read_b64_tr_b16 v[62:63], v7 offset:13312
    ds_read_b128 v[52:55], v5 offset:4096
    s_waitcnt lgkmcnt(6)
    v_mfma_f32_32x32x16_bf16 v[96:111], v[36:39], v[40:43], v[96:111]
    v_mfma_f32_32x32x16_bf16 v[112:127], v[36:39], v[44:47], v[112:127]
    s_waitcnt lgkmcnt(0)
    s_barrier
    v_mfma_f32_32x32x16_bf16 v[64:79], v[48:51], v[56:59], v[64:79]
    ds_read_b128 v[32:35], v2 offset:16384
    ds_read_b64_tr_b16 v[40:41], v6 offset:16384
    ds_read_b64_tr_b16 v[42:43], v6 offset:17408
    v_mfma_f32_32x32x16_bf16 v[80:95], v[48:51], v[60:63], v[80:95]
    ds_read_b64_tr_b16 v[44:45], v7 offset:16384
    ds_read_b64_tr_b16 v[46:47], v7 offset:17408
    ds_read_b128 v[36:39], v2 offset:20480
    v_mfma_f32_32x32x16_bf16 v[96:111], v[52:55], v[56:59], v[96:111]
    v_mfma_f32_32x32x16_bf16 v[112:127], v[52:55], v[60:63], v[112:127]
    s_waitcnt lgkmcnt(3)
    v_mfma_f32_32x32x16_bf16 v[64:79], v[32:35], v[40:43], v[64:79]
    ds_read_b128 v[48:51], v3 offset:16384
    ds_read_b64_tr_b16 v[56:57], v6 offset:20480
    ds_read_b64_tr_b16 v[58:59], v6 offset:21504
    s_waitcnt lgkmcnt(4)
    v_mfma_f32_32x32x16_bf16 v[80:95], v[32:35], v[44:47], v[80:95]
    ds_read_b64_tr_b16 v[60:61], v7 offset:20480
    ds_read_b64_tr_b16 v[62:63], v7 offset:21504
    ds_read_b128 v[52:55], v3 offset:20480
    s_waitcnt lgkmcnt(6)
    v_mfma_f32_32x32x16_bf16 v[96:111], v[36:39], v[40:43], v[96:111]
    v_mfma_f32_32x32x16_bf16 v[112:127], v[36:39], v[44:47], v[112:127]
    s_waitcnt lgkmcnt(3)
    v_mfma_f32_32x32x16_bf16 v[64:79], v[48:51], v[56:59], v[64:79]
    ds_read_b128 v[32:35], v4 offset:16384
    ds_read_b64_tr_b16 v[40:41], v6 offset:24576
    ds_read_b64_tr_b16 v[42:43], v6 offset:25600
    s_waitcnt lgkmcnt(4)
    v_mfma_f32_32x32x16_bf16 v[80:95], v[48:51], v[60:63], v[80:95]
    ds_read_b64_tr_b16 v[44:45], v7 offset:24576
    ds_read_b64_tr_b16 v[46:47], v7 offset:25600
    ds_read_b128 v[36:39], v4 offset:20480
    s_waitcnt lgkmcnt(6)
    v_mfma_f32_32x32x16_bf16 v[96:111], v[52:55], v[56:59], v[96:111]
    v_mfma_f32_32x32x16_bf16 v[112:127], v[52:55], v[60:63], v[112:127]
    s_waitcnt lgkmcnt(3)
    v_mfma_f32_32x32x16_bf16 v[64:79], v[32:35], v[40:43], v[64:79]
    ds_read_b128 v[48:51], v5 offset:16384
    ds_read_b64_tr_b16 v[56:57], v6 offset:28672
    ds_read_b64_tr_b16 v[58:59], v6 offset:29696
    s_waitcnt lgkmcnt(4)
    v_mfma_f32_32x32x16_bf16 v[80:95], v[32:35], v[44:47], v[80:95]
    ds_read_b64_tr_b16 v[60:61], v7 offset:28672
    ds_read_b64_tr_b16 v[62:63], v7 offset:29696
    ds_read_b128 v[52:55], v5 offset:20480
    s_waitcnt lgkmcnt(6)
    v_mfma_f32_32x32x16_bf16 v[96:111], v[36:39], v[40:43], v[96:111]
    v_mfma_f32_32x32x16_bf16 v[112:127], v[36:39], v[44:47], v[112:127]
    s_waitcnt lgkmcnt(0)
    s_barrier
    v_mfma_f32_32x32x16_bf16 v[64:79], v[48:51], v[56:59], v[64:79]
    ds_read_b128 v[32:35], v2 offset:32768
    ds_read_b64_tr_b16 v[40:41], v6 offset:32768
    ds_read_b64_tr_b16 v[42:43], v6 offset:33792
    v_mfma_f32_32x32x16_bf16 v[80:95], v[48:51], v[60:63], v[80:95]
    ds_read_b64_tr_b16 v[44:45], v7 offset:32768
    ds_read_b64_tr_b16 v[46:47], v7 offset:33792
    ds_read_b128 v[36:39], v2 offset:36864
    v_mfma_f32_32x32x16_bf16 v[96:111], v[52:55], v[56:59], v[96:111]
    v_mfma_f32_32x32x16_bf16 v[112:127], v[52:55], v[60:63], v[112:127]
    s_waitcnt lgkmcnt(3)
    v_mfma_f32_32x32x16_bf16 v[64:79], v[32:35], v[40:43], v[64:79]
    ds_read_b128 v[48:51], v3 offset:32768
    ds_read_b64_tr_b16 v[56:57], v6 offset:36864
    ds_read_b64_tr_b16 v[58:59], v6 offset:37888
    s_waitcnt lgkmcnt(4)
    v_mfma_f32_32x32x16_bf16 v[80:95], v[32:35], v[44:47], v[80:95]
    ds_read_b64_tr_b16 v[60:61], v7 offset:36864
    ds_read_b64_tr_b16 v[62:63], v7 offset:37888
    ds_read_b128 v[52:55], v3 offset:36864
    s_waitcnt lgkmcnt(6)
    v_mfma_f32_32x32x16_bf16 v[96:111], v[36:39], v[40:43], v[96:111]
    v_mfma_f32_32x32x16_bf16 v[112:127], v[36:39], v[44:47], v[112:127]
    s_waitcnt lgkmcnt(3)
    v_mfma_f32_32x32x16_bf16 v[64:79], v[48:51], v[56:59], v[64:79]
    ds_read_b128 v[32:35], v4 offset:32768
    ds_read_b64_tr_b16 v[40:41], v6 offset:40960
    ds_read_b64_tr_b16 v[42:43], v6 offset:41984
    s_waitcnt lgkmcnt(4)
    v_mfma_f32_32x32x16_bf16 v[80:95], v[48:51], v[60:63], v[80:95]
    ds_read_b64_tr_b16 v[44:45], v7 offset:40960
    ds_read_b64_tr_b16 v[46:47], v7 offset:41984
    ds_read_b128 v[36:39], v4 offset:36864
    s_waitcnt lgkmcnt(6)
    v_mfma_f32_32x32x16_bf16 v[96:111], v[52:55], v[56:59], v[96:111]
    v_mfma_f32_32x32x16_bf16 v[112:127], v[52:55], v[60:63], v[112:127]
    s_waitcnt lgkmcnt(3)
    v_mfma_f32_32x32x16_bf16 v[64:79], v[32:35], v[40:43], v[64:79]
    ds_read_b128 v[48:51], v5 offset:32768
    ds_read_b64_tr_b16 v[56:57], v6 offset:45056
    ds_read_b64_tr_b16 v[58:59], v6 offset:46080
    s_waitcnt lgkmcnt(4)
    v_mfma_f32_32x32x16_bf16 v[80:95], v[32:35], v[44:47], v[80:95]
    ds_read_b64_tr_b16 v[60:61], v7 offset:45056
    ds_read_b64_tr_b16 v[62:63], v7 offset:46080
    ds_read_b128 v[52:55], v5 offset:36864
    s_waitcnt lgkmcnt(6)
    v_mfma_f32_32x32x16_bf16 v[96:111], v[36:39], v[40:43], v[96:111]
    v_mfma_f32_32x32x16_bf16 v[112:127], v[36:39], v[44:47], v[112:127]
    s_waitcnt lgkmcnt(0)
    s_barrier
    v_mfma_f32_32x32x16_bf16 v[64:79], v[48:51], v[56:59], v[64:79]
    ds_read_b128 v[32:35], v2 offset:0
    ds_read_b64_tr_b16 v[40:41], v6 offset:0
    ds_read_b64_tr_b16 v[42:43], v6 offset:1024
    v_mfma_f32_32x32x16_bf16 v[80:95], v[48:51], v[60:63], v[80:95]
    ds_read_b64_tr_b16 v[44:45], v7 offset:0
    ds_read_b64_tr_b16 v[46:47], v7 offset:1024
    ds_read_b128 v[36:39], v2 offset:4096
    v_mfma_f32_32x32x16_bf16 v[96:111], v[52:55], v[56:59], v[96:111]
    v_mfma_f32_32x32x16_bf16 v[112:127], v[52:55], v[60:63], v[112:127]
    s_waitcnt lgkmcnt(3)
    v_mfma_f32_32x32x16_bf16 v[64:79], v[32:35], v[40:43], v[64:79]
    ds_read_b128 v[48:51], v3 offset:0
    ds_read_b64_tr_b16 v[56:57], v6 offset:4096
    ds_read_b64_tr_b16 v[58:59], v6 offset:5120
    s_waitcnt lgkmcnt(4)
    v_mfma_f32_32x32x16_bf16 v[80:95], v[32:35], v[44:47], v[80:95]
    ds_read_b64_tr_b16 v[60:61], v7 offset:4096
    ds_read_b64_tr_b16 v[62:63], v7 offset:5120
    ds_read_b128 v[52:55], v3 offset:4096
    s_waitcnt lgkmcnt(6)
    v_mfma_f32_32x32x16_bf16 v[96:111], v[36:39], v[40:43], v[96:111]
    v_mfma_f32_32x32x16_bf16 v[112:127], v[36:39], v[44:47], v[112:127]
    s_waitcnt lgkmcnt(3)
    v_mfma_f32_32x32x16_bf16 v[64:79], v[48:51], v[56:59], v[64:79]
    ds_read_b128 v[32:35], v4 offset:0
    ds_read_b64_tr_b16 v[40:41], v6 offset:8192
    ds_read_b64_tr_b16 v[42:43], v6 offset:9216
    s_waitcnt lgkmcnt(4)
    v_mfma_f32_32x32x16_bf16 v[80:95], v[48:51], v[60:63], v[80:95]
    ds_read_b64_tr_b16 v[44:45], v7 offset:8192
    ds_read_b64_tr_b16 v[46:47], v7 offset:9216
    ds_read_b128 v[36:39], v4 offset:4096
    s_waitcnt lgkmcnt(6)
    v_mfma_f32_32x32x16_bf16 v[96:111], v[52:55], v[56:59], v[96:111]
    v_mfma_f32_32x32x16_bf16 v[112:127], v[52:55], v[60:63], v[112:127]
    s_waitcnt lgkmcnt(3)
    v_mfma_f32_32x32x16_bf16 v[64:79], v[32:35], v[40:43], v[64:79]
    ds_read_b128 v[48:51], v5 offset:0
    ds_read_b64_tr_b16 v[56:57], v6 offset:12288
    ds_read_b64_tr_b16 v[58:59], v6 offset:13312
    s_waitcnt lgkmcnt(4)
    v_mfma_f32_32x32x16_bf16 v[80:95], v[32:35], v[44:47], v[80:95]
    ds_read_b64_tr_b16 v[60:61], v7 offset:12288
    ds_read_b64_tr_b16 v[62:63], v7 offset:13312
    ds_read_b128 v[52:55], v5 offset:4096
    s_waitcnt lgkmcnt(6)
    v_mfma_f32_32x32x16_bf16 v[96:111], v[36:39], v[40:43], v[96:111]
    v_mfma_f32_32x32x16_bf16 v[112:127], v[36:39], v[44:47], v[112:127]
    s_waitcnt lgkmcnt(0)
    s_barrier
    v_mfma_f32_32x32x16_bf16 v[64:79], v[48:51], v[56:59], v[64:79]
    ds_read_b128 v[32:35], v2 offset:16384
    ds_read_b64_tr_b16 v[40:41], v6 offset:16384
    ds_read_b64_tr_b16 v[42:43], v6 offset:17408
    v_mfma_f32_32x32x16_bf16 v[80:95], v[48:51], v[60:63], v[80:95]
    ds_read_b64_tr_b16 v[44:45], v7 offset:16384
    ds_read_b64_tr_b16 v[46:47], v7 offset:17408
    ds_read_b128 v[36:39], v2 offset:20480
    v_mfma_f32_32x32x16_bf16 v[96:111], v[52:55], v[56:59], v[96:111]
    v_mfma_f32_32x32x16_bf16 v[112:127], v[52:55], v[60:63], v[112:127]
    s_waitcnt lgkmcnt(3)
    v_mfma_f32_32x32x16_bf16 v[64:79], v[32:35], v[40:43], v[64:79]
    ds_read_b128 v[48:51], v3 offset:16384
    ds_read_b64_tr_b16 v[56:57], v6 offset:20480
    ds_read_b64_tr_b16 v[58:59], v6 offset:21504
    s_waitcnt lgkmcnt(4)
    v_mfma_f32_32x32x16_bf16 v[80:95], v[32:35], v[44:47], v[80:95]
    ds_read_b64_tr_b16 v[60:61], v7 offset:20480
    ds_read_b64_tr_b16 v[62:63], v7 offset:21504
    ds_read_b128 v[52:55], v3 offset:20480
    s_waitcnt lgkmcnt(6)
    v_mfma_f32_32x32x16_bf16 v[96:111], v[36:39], v[40:43], v[96:111]
    v_mfma_f32_32x32x16_bf16 v[112:127], v[36:39], v[44:47], v[112:127]
    s_waitcnt lgkmcnt(3)
    v_mfma_f32_32x32x16_bf16 v[64:79], v[48:51], v[56:59], v[64:79]
    ds_read_b128 v[32:35], v4 offset:16384
    ds_read_b64_tr_b16 v[40:41], v6 offset:24576
    ds_read_b64_tr_b16 v[42:43], v6 offset:25600
    s_waitcnt lgkmcnt(4)
    v_mfma_f32_32x32x16_bf16 v[80:95], v[48:51], v[60:63], v[80:95]
    ds_read_b64_tr_b16 v[44:45], v7 offset:24576
    ds_read_b64_tr_b16 v[46:47], v7 offset:25600
    ds_read_b128 v[36:39], v4 offset:20480
    s_waitcnt lgkmcnt(6)
    v_mfma_f32_32x32x16_bf16 v[96:111], v[52:55], v[56:59], v[96:111]
    v_mfma_f32_32x32x16_bf16 v[112:127], v[52:55], v[60:63], v[112:127]
    s_waitcnt lgkmcnt(3)
    v_mfma_f32_32x32x16_bf16 v[64:79], v[32:35], v[40:43], v[64:79]
    ds_read_b128 v[48:51], v5 offset:16384
    ds_read_b64_tr_b16 v[56:57], v6 offset:28672
    ds_read_b64_tr_b16 v[58:59], v6 offset:29696
    s_waitcnt lgkmcnt(4)
    v_mfma_f32_32x32x16_bf16 v[80:95], v[32:35], v[44:47], v[80:95]
    ds_read_b64_tr_b16 v[60:61], v7 offset:28672
    ds_read_b64_tr_b16 v[62:63], v7 offset:29696
    ds_read_b128 v[52:55], v5 offset:20480
    s_waitcnt lgkmcnt(6)
    v_mfma_f32_32x32x16_bf16 v[96:111], v[36:39], v[40:43], v[96:111]
    v_mfma_f32_32x32x16_bf16 v[112:127], v[36:39], v[44:47], v[112:127]
    s_waitcnt lgkmcnt(0)
    s_barrier
    v_mfma_f32_32x32x16_bf16 v[64:79], v[48:51], v[56:59], v[64:79]
    ds_read_b128 v[32:35], v2 offset:32768
    ds_read_b64_tr_b16 v[40:41], v6 offset:32768
    ds_read_b64_tr_b16 v[42:43], v6 offset:33792
    v_mfma_f32_32x32x16_bf16 v[80:95], v[48:51], v[60:63], v[80:95]
    ds_read_b64_tr_b16 v[44:45], v7 offset:32768
    ds_read_b64_tr_b16 v[46:47], v7 offset:33792
    ds_read_b128 v[36:39], v2 offset:36864
    v_mfma_f32_32x32x16_bf16 v[96:111], v[52:55], v[56:59], v[96:111]
    v_mfma_f32_32x32x16_bf16 v[112:127], v[52:55], v[60:63], v[112:127]
    s_waitcnt lgkmcnt(3)
    v_mfma_f32_32x32x16_bf16 v[64:79], v[32:35], v[40:43], v[64:79]
    ds_read_b128 v[48:51], v3 offset:32768
    ds_read_b64_tr_b16 v[56:57], v6 offset:36864
    ds_read_b64_tr_b16 v[58:59], v6 offset:37888
    s_waitcnt lgkmcnt(4)
    v_mfma_f32_32x32x16_bf16 v[80:95], v[32:35], v[44:47], v[80:95]
    ds_read_b64_tr_b16 v[60:61], v7 offset:36864
    ds_read_b64_tr_b16 v[62:63], v7 offset:37888
    ds_read_b128 v[52:55], v3 offset:36864
    s_waitcnt lgkmcnt(6)
    v_mfma_f32_32x32x16_bf16 v[96:111], v[36:39], v[40:43], v[96:111]
    v_mfma_f32_32x32x16_bf16 v[112:127], v[36:39], v[44:47], v[112:127]
    s_waitcnt lgkmcnt(3)
    v_mfma_f32_32x32x16_bf16 v[64:79], v[48:51], v[56:59], v[64:79]
    ds_read_b128 v[32:35], v4 offset:32768
    ds_read_b64_tr_b16 v[40:41], v6 offset:40960
    ds_read_b64_tr_b16 v[42:43], v6 offset:41984
    s_waitcnt lgkmcnt(4)
    v_mfma_f32_32x32x16_bf16 v[80:95], v[48:51], v[60:63], v[80:95]
    ds_read_b64_tr_b16 v[44:45], v7 offset:40960
    ds_read_b64_tr_b16 v[46:47], v7 offset:41984
    ds_read_b128 v[36:39], v4 offset:36864
    s_waitcnt lgkmcnt(6)
    v_mfma_f32_32x32x16_bf16 v[96:111], v[52:55], v[56:59], v[96:111]
    v_mfma_f32_32x32x16_bf16 v[112:127], v[52:55], v[60:63], v[112:127]
    s_waitcnt lgkmcnt(3)
    v_mfma_f32_32x32x16_bf16 v[64:79], v[32:35], v[40:43], v[64:79]
    ds_read_b128 v[48:51], v5 offset:32768
    ds_read_b64_tr_b16 v[56:57], v6 offset:45056
    ds_read_b64_tr_b16 v[58:59], v6 offset:46080
    s_waitcnt lgkmcnt(4)
    v_mfma_f32_32x32x16_bf16 v[80:95], v[32:35], v[44:47], v[80:95]
    ds_read_b64_tr_b16 v[60:61], v7 offset:45056
    ds_read_b64_tr_b16 v[62:63], v7 offset:46080
    ds_read_b128 v[52:55], v5 offset:36864
    s_waitcnt lgkmcnt(6)
    v_mfma_f32_32x32x16_bf16 v[96:111], v[36:39], v[40:43], v[96:111]
    v_mfma_f32_32x32x16_bf16 v[112:127], v[36:39], v[44:47], v[112:127]
    s_waitcnt lgkmcnt(0)
    s_barrier
    v_mfma_f32_32x32x16_bf16 v[64:79], v[48:51], v[56:59], v[64:79]
    ds_read_b128 v[32:35], v2 offset:0
    ds_read_b64_tr_b16 v[40:41], v6 offset:0
    ds_read_b64_tr_b16 v[42:43], v6 offset:1024
    v_mfma_f32_32x32x16_bf16 v[80:95], v[48:51], v[60:63], v[80:95]
    ds_read_b64_tr_b16 v[44:45], v7 offset:0
    ds_read_b64_tr_b16 v[46:47], v7 offset:1024
    ds_read_b128 v[36:39], v2 offset:4096
    v_mfma_f32_32x32x16_bf16 v[96:111], v[52:55], v[56:59], v[96:111]
    v_mfma_f32_32x32x16_bf16 v[112:127], v[52:55], v[60:63], v[112:127]
    s_waitcnt lgkmcnt(3)
    v_mfma_f32_32x32x16_bf16 v[64:79], v[32:35], v[40:43], v[64:79]
    ds_read_b128 v[48:51], v3 offset:0
    ds_read_b64_tr_b16 v[56:57], v6 offset:4096
    ds_read_b64_tr_b16 v[58:59], v6 offset:5120
    s_waitcnt lgkmcnt(4)
    v_mfma_f32_32x32x16_bf16 v[80:95], v[32:35], v[44:47], v[80:95]
    ds_read_b64_tr_b16 v[60:61], v7 offset:4096
    ds_read_b64_tr_b16 v[62:63], v7 offset:5120
    ds_read_b128 v[52:55], v3 offset:4096
    s_waitcnt lgkmcnt(6)
    v_mfma_f32_32x32x16_bf16 v[96:111], v[36:39], v[40:43], v[96:111]
    v_mfma_f32_32x32x16_bf16 v[112:127], v[36:39], v[44:47], v[112:127]
    s_waitcnt lgkmcnt(3)
    v_mfma_f32_32x32x16_bf16 v[64:79], v[48:51], v[56:59], v[64:79]
    ds_read_b128 v[32:35], v4 offset:0
    ds_read_b64_tr_b16 v[40:41], v6 offset:8192
    ds_read_b64_tr_b16 v[42:43], v6 offset:9216
    s_waitcnt lgkmcnt(4)
    v_mfma_f32_32x32x16_bf16 v[80:95], v[48:51], v[60:63], v[80:95]
    ds_read_b64_tr_b16 v[44:45], v7 offset:8192
    ds_read_b64_tr_b16 v[46:47], v7 offset:9216
    ds_read_b128 v[36:39], v4 offset:4096
    s_waitcnt lgkmcnt(6)
    v_mfma_f32_32x32x16_bf16 v[96:111], v[52:55], v[56:59], v[96:111]
    v_mfma_f32_32x32x16_bf16 v[112:127], v[52:55], v[60:63], v[112:127]
    s_waitcnt lgkmcnt(3)
    v_mfma_f32_32x32x16_bf16 v[64:79], v[32:35], v[40:43], v[64:79]
    ds_read_b128 v[48:51], v5 offset:0
    ds_read_b64_tr_b16 v[56:57], v6 offset:12288
    ds_read_b64_tr_b16 v[58:59], v6 offset:13312
    s_waitcnt lgkmcnt(4)
    v_mfma_f32_32x32x16_bf16 v[80:95], v[32:35], v[44:47], v[80:95]
    ds_read_b64_tr_b16 v[60:61], v7 offset:12288
    ds_read_b64_tr_b16 v[62:63], v7 offset:13312
    ds_read_b128 v[52:55], v5 offset:4096
    s_waitcnt lgkmcnt(6)
    v_mfma_f32_32x32x16_bf16 v[96:111], v[36:39], v[40:43], v[96:111]
    v_mfma_f32_32x32x16_bf16 v[112:127], v[36:39], v[44:47], v[112:127]
    s_waitcnt lgkmcnt(0)
    s_barrier
    v_mfma_f32_32x32x16_bf16 v[64:79], v[48:51], v[56:59], v[64:79]
    ds_read_b128 v[32:35], v2 offset:16384
    ds_read_b64_tr_b16 v[40:41], v6 offset:16384
    ds_read_b64_tr_b16 v[42:43], v6 offset:17408
    v_mfma_f32_32x32x16_bf16 v[80:95], v[48:51], v[60:63], v[80:95]
    ds_read_b64_tr_b16 v[44:45], v7 offset:16384
    ds_read_b64_tr_b16 v[46:47], v7 offset:17408
    ds_read_b128 v[36:39], v2 offset:20480
    v_mfma_f32_32x32x16_bf16 v[96:111], v[52:55], v[56:59], v[96:111]
    v_mfma_f32_32x32x16_bf16 v[112:127], v[52:55], v[60:63], v[112:127]
    s_waitcnt lgkmcnt(3)
    v_mfma_f32_32x32x16_bf16 v[64:79], v[32:35], v[40:43], v[64:79]
    ds_read_b128 v[48:51], v3 offset:16384
    ds_read_b64_tr_b16 v[56:57], v6 offset:20480
    ds_read_b64_tr_b16 v[58:59], v6 offset:21504
    s_waitcnt lgkmcnt(4)
    v_mfma_f32_32x32x16_bf16 v[80:95], v[32:35], v[44:47], v[80:95]
    ds_read_b64_tr_b16 v[60:61], v7 offset:20480
    ds_read_b64_tr_b16 v[62:63], v7 offset:21504
    ds_read_b128 v[52:55], v3 offset:20480
    s_waitcnt lgkmcnt(6)
    v_mfma_f32_32x32x16_bf16 v[96:111], v[36:39], v[40:43], v[96:111]
    v_mfma_f32_32x32x16_bf16 v[112:127], v[36:39], v[44:47], v[112:127]
    s_waitcnt lgkmcnt(3)
    v_mfma_f32_32x32x16_bf16 v[64:79], v[48:51], v[56:59], v[64:79]
    ds_read_b128 v[32:35], v4 offset:16384
    ds_read_b64_tr_b16 v[40:41], v6 offset:24576
    ds_read_b64_tr_b16 v[42:43], v6 offset:25600
    s_waitcnt lgkmcnt(4)
    v_mfma_f32_32x32x16_bf16 v[80:95], v[48:51], v[60:63], v[80:95]
    ds_read_b64_tr_b16 v[44:45], v7 offset:24576
    ds_read_b64_tr_b16 v[46:47], v7 offset:25600
    ds_read_b128 v[36:39], v4 offset:20480
    s_waitcnt lgkmcnt(6)
    v_mfma_f32_32x32x16_bf16 v[96:111], v[52:55], v[56:59], v[96:111]
    v_mfma_f32_32x32x16_bf16 v[112:127], v[52:55], v[60:63], v[112:127]
    s_waitcnt lgkmcnt(3)
    v_mfma_f32_32x32x16_bf16 v[64:79], v[32:35], v[40:43], v[64:79]
    ds_read_b128 v[48:51], v5 offset:16384
    ds_read_b64_tr_b16 v[56:57], v6 offset:28672
    ds_read_b64_tr_b16 v[58:59], v6 offset:29696
    s_waitcnt lgkmcnt(4)
    v_mfma_f32_32x32x16_bf16 v[80:95], v[32:35], v[44:47], v[80:95]
    ds_read_b64_tr_b16 v[60:61], v7 offset:28672
    ds_read_b64_tr_b16 v[62:63], v7 offset:29696
    ds_read_b128 v[52:55], v5 offset:20480
    s_waitcnt lgkmcnt(6)
    v_mfma_f32_32x32x16_bf16 v[96:111], v[36:39], v[40:43], v[96:111]
    v_mfma_f32_32x32x16_bf16 v[112:127], v[36:39], v[44:47], v[112:127]
    s_waitcnt lgkmcnt(0)
    s_barrier
    v_mfma_f32_32x32x16_bf16 v[64:79], v[48:51], v[56:59], v[64:79]
    ds_read_b128 v[32:35], v2 offset:32768
    ds_read_b64_tr_b16 v[40:41], v6 offset:32768
    ds_read_b64_tr_b16 v[42:43], v6 offset:33792
    v_mfma_f32_32x32x16_bf16 v[80:95], v[48:51], v[60:63], v[80:95]
    ds_read_b64_tr_b16 v[44:45], v7 offset:32768
    ds_read_b64_tr_b16 v[46:47], v7 offset:33792
    ds_read_b128 v[36:39], v2 offset:36864
    v_mfma_f32_32x32x16_bf16 v[96:111], v[52:55], v[56:59], v[96:111]
    v_mfma_f32_32x32x16_bf16 v[112:127], v[52:55], v[60:63], v[112:127]
    s_waitcnt lgkmcnt(3)
    v_mfma_f32_32x32x16_bf16 v[64:79], v[32:35], v[40:43], v[64:79]
    ds_read_b128 v[48:51], v3 offset:32768
    ds_read_b64_tr_b16 v[56:57], v6 offset:36864
    ds_read_b64_tr_b16 v[58:59], v6 offset:37888
    s_waitcnt lgkmcnt(4)
    v_mfma_f32_32x32x16_bf16 v[80:95], v[32:35], v[44:47], v[80:95]
    ds_read_b64_tr_b16 v[60:61], v7 offset:36864
    ds_read_b64_tr_b16 v[62:63], v7 offset:37888
    ds_read_b128 v[52:55], v3 offset:36864
    s_waitcnt lgkmcnt(6)
    v_mfma_f32_32x32x16_bf16 v[96:111], v[36:39], v[40:43], v[96:111]
    v_mfma_f32_32x32x16_bf16 v[112:127], v[36:39], v[44:47], v[112:127]
    s_waitcnt lgkmcnt(3)
    v_mfma_f32_32x32x16_bf16 v[64:79], v[48:51], v[56:59], v[64:79]
    ds_read_b128 v[32:35], v4 offset:32768
    ds_read_b64_tr_b16 v[40:41], v6 offset:40960
    ds_read_b64_tr_b16 v[42:43], v6 offset:41984
    s_waitcnt lgkmcnt(4)
    v_mfma_f32_32x32x16_bf16 v[80:95], v[48:51], v[60:63], v[80:95]
    ds_read_b64_tr_b16 v[44:45], v7 offset:40960
    ds_read_b64_tr_b16 v[46:47], v7 offset:41984
    ds_read_b128 v[36:39], v4 offset:36864
    s_waitcnt lgkmcnt(6)
    v_mfma_f32_32x32x16_bf16 v[96:111], v[52:55], v[56:59], v[96:111]
    v_mfma_f32_32x32x16_bf16 v[112:127], v[52:55], v[60:63], v[112:127]
    s_waitcnt lgkmcnt(3)
    v_mfma_f32_32x32x16_bf16 v[64:79], v[32:35], v[40:43], v[64:79]
    ds_read_b128 v[48:51], v5 offset:32768
    ds_read_b64_tr_b16 v[56:57], v6 offset:45056
    ds_read_b64_tr_b16 v[58:59], v6 offset:46080
    s_waitcnt lgkmcnt(4)
    v_mfma_f32_32x32x16_bf16 v[80:95], v[32:35], v[44:47], v[80:95]
    ds_read_b64_tr_b16 v[60:61], v7 offset:45056
    ds_read_b64_tr_b16 v[62:63], v7 offset:46080
    ds_read_b128 v[52:55], v5 offset:36864
    s_waitcnt lgkmcnt(6)
    v_mfma_f32_32x32x16_bf16 v[96:111], v[36:39], v[40:43], v[96:111]
    v_mfma_f32_32x32x16_bf16 v[112:127], v[36:39], v[44:47], v[112:127]
    s_waitcnt lgkmcnt(0)
    s_barrier
    v_mfma_f32_32x32x16_bf16 v[64:79], v[48:51], v[56:59], v[64:79]
    ds_read_b128 v[32:35], v2 offset:0
    ds_read_b64_tr_b16 v[40:41], v6 offset:0
    ds_read_b64_tr_b16 v[42:43], v6 offset:1024
    ds_read_b128 v[152:155], v3 offset:0
    v_mfma_f32_32x32x16_bf16 v[80:95], v[48:51], v[60:63], v[80:95]
    ds_read_b64_tr_b16 v[160:161], v6 offset:4096
    ds_read_b64_tr_b16 v[162:163], v6 offset:5120
    ds_read_b128 v[168:171], v4 offset:0
    ds_read_b64_tr_b16 v[176:177], v6 offset:8192
    ds_read_b64_tr_b16 v[178:179], v6 offset:9216
    v_mfma_f32_32x32x16_bf16 v[96:111], v[52:55], v[56:59], v[96:111]
    v_mfma_f32_32x32x16_bf16 v[112:127], v[52:55], v[60:63], v[112:127]
    ds_read_b128 v[8:11], v5 offset:0
    ds_read_b64_tr_b16 v[16:17], v6 offset:12288
    ds_read_b64_tr_b16 v[18:19], v6 offset:13312
    s_waitcnt lgkmcnt(9)
    v_mfma_f32_32x32x16_bf16 v[64:79], v[32:35], v[40:43], v[64:79]
    ds_read_b64_tr_b16 v[44:45], v7 offset:0
    ds_read_b64_tr_b16 v[46:47], v7 offset:1024
    s_waitcnt lgkmcnt(8)
    v_mfma_f32_32x32x16_bf16 v[64:79], v[152:155], v[160:163], v[64:79]
    ds_read_b64_tr_b16 v[164:165], v7 offset:4096
    ds_read_b64_tr_b16 v[166:167], v7 offset:5120
    s_waitcnt lgkmcnt(7)
    v_mfma_f32_32x32x16_bf16 v[64:79], v[168:171], v[176:179], v[64:79]
    ds_read_b64_tr_b16 v[180:181], v7 offset:8192
    ds_read_b64_tr_b16 v[182:183], v7 offset:9216
    s_waitcnt lgkmcnt(6)
    v_mfma_f32_32x32x16_bf16 v[64:79], v[8:11], v[16:19], v[64:79]
    ds_read_b64_tr_b16 v[20:21], v7 offset:12288
    ds_read_b64_tr_b16 v[22:23], v7 offset:13312
    s_waitcnt lgkmcnt(6)
    v_mfma_f32_32x32x16_bf16 v[80:95], v[32:35], v[44:47], v[80:95]
    ds_read_b128 v[36:39], v2 offset:4096
    s_waitcnt lgkmcnt(5)
    v_mfma_f32_32x32x16_bf16 v[80:95], v[152:155], v[164:167], v[80:95]
    ds_read_b128 v[156:159], v3 offset:4096
    s_waitcnt lgkmcnt(4)
    v_mfma_f32_32x32x16_bf16 v[80:95], v[168:171], v[180:183], v[80:95]
    ds_read_b128 v[172:175], v4 offset:4096
    s_waitcnt lgkmcnt(3)
    v_mfma_f32_32x32x16_bf16 v[80:95], v[8:11], v[20:23], v[80:95]
    ds_read_b128 v[12:15], v5 offset:4096
    s_waitcnt lgkmcnt(3)
    v_mfma_f32_32x32x16_bf16 v[96:111], v[36:39], v[40:43], v[96:111]
    v_cvt_pk_bf16_f32 v64, v64, v65
    v_cvt_pk_bf16_f32 v65, v66, v67
    v_cvt_pk_bf16_f32 v66, v68, v69
    s_waitcnt lgkmcnt(2)
    v_mfma_f32_32x32x16_bf16 v[96:111], v[156:159], v[160:163], v[96:111]
    v_cvt_pk_bf16_f32 v67, v70, v71
    buffer_store_dwordx4 v[64:67], v136, s[28:31], s78 offen offset:0 sc1
    v_cvt_pk_bf16_f32 v72, v72, v73
    s_waitcnt lgkmcnt(1)
    v_mfma_f32_32x32x16_bf16 v[96:111], v[172:175], v[176:179], v[96:111]
    v_cvt_pk_bf16_f32 v73, v74, v75
    v_cvt_pk_bf16_f32 v74, v76, v77
    v_cvt_pk_bf16_f32 v75, v78, v79
    s_waitcnt lgkmcnt(0)
    v_mfma_f32_32x32x16_bf16 v[96:111], v[12:15], v[16:19], v[96:111]
    buffer_store_dwordx4 v[72:75], v136, s[28:31], s78 offen offset:640 sc1
    v_cvt_pk_bf16_f32 v80, v80, v81
    v_cvt_pk_bf16_f32 v81, v82, v83
    v_mfma_f32_32x32x16_bf16 v[112:127], v[36:39], v[44:47], v[112:127]
    v_cvt_pk_bf16_f32 v82, v84, v85
    v_cvt_pk_bf16_f32 v83, v86, v87
    v_mfma_f32_32x32x16_bf16 v[112:127], v[156:159], v[164:167], v[112:127]
    buffer_store_dwordx4 v[80:83], v137, s[28:31], s78 offen offset:0 sc1
    v_cvt_pk_bf16_f32 v88, v88, v89
    v_mfma_f32_32x32x16_bf16 v[112:127], v[172:175], v[180:183], v[112:127]
    v_cvt_pk_bf16_f32 v89, v90, v91
    v_cvt_pk_bf16_f32 v90, v92, v93
    v_mfma_f32_32x32x16_bf16 v[112:127], v[12:15], v[20:23], v[112:127]
    v_cvt_pk_bf16_f32 v91, v94, v95
    buffer_store_dwordx4 v[88:91], v137, s[28:31], s78 offen offset:640 sc1
    v_cvt_pk_bf16_f32 v96, v96, v97
    v_cvt_pk_bf16_f32 v97, v98, v99
    v_cvt_pk_bf16_f32 v98, v100, v101
    v_cvt_pk_bf16_f32 v99, v102, v103
    buffer_store_dwordx4 v[96:99], v136, s[28:31], s78 offen offset:1280 sc1
    v_cvt_pk_bf16_f32 v104, v104, v105
    v_cvt_pk_bf16_f32 v105, v106, v107
    v_cvt_pk_bf16_f32 v106, v108, v109
    v_cvt_pk_bf16_f32 v107, v110, v111
    buffer_store_dwordx4 v[104:107], v136, s[28:31], s78 offen offset:1920 sc1
    v_cvt_pk_bf16_f32 v112, v112, v113
    v_cvt_pk_bf16_f32 v113, v114, v115
    v_cvt_pk_bf16_f32 v114, v116, v117
    v_cvt_pk_bf16_f32 v115, v118, v119
    buffer_store_dwordx4 v[112:115], v137, s[28:31], s78 offen offset:1280 sc1
    v_cvt_pk_bf16_f32 v120, v120, v121
    v_cvt_pk_bf16_f32 v121, v122, v123
    v_cvt_pk_bf16_f32 v122, v124, v125
    v_cvt_pk_bf16_f32 v123, v126, v127
    buffer_store_dwordx4 v[120:123], v137, s[28:31], s78 offen offset:1920 sc1
    v_mov_b32 v48, v240
    v_mov_b32 v49, v240
    v_mov_b32 v50, v240
    v_mov_b32 v51, v240
    v_mov_b32 v52, v240
    v_mov_b32 v53, v240
    v_mov_b32 v54, v240
    v_mov_b32 v55, v240
    v_mov_b32 v56, v240
    v_mov_b32 v57, v240
    v_mov_b32 v58, v240
    v_mov_b32 v59, v240
    v_mov_b32 v60, v240
    v_mov_b32 v61, v240
    v_mov_b32 v62, v240
    v_mov_b32 v63, v240
L_C_FLAG:
    s_cmp_eq_u32 s3, 3
    s_cbranch_scc1 KVW_87
    s_waitcnt vmcnt(0)
    v_mov_b32 v2, 162048
    v_mov_b32 v3, 1
    s_mov_b64 exec, 1
    ds_add_rtn_u32 v3, v2, v3 offset:12
    s_waitcnt lgkmcnt(0)
    v_readfirstlane_b32 s64, v3
    s_mov_b64 exec, -1
    s_add_u32 s64, s64, 1
    s_cmp_lg_u32 s64, 4
    s_cbranch_scc1 NL_88
    v_lshl_add_u32 v2, v0, 2, s92
    v_mov_b32 v3, 1
    s_mov_b64 exec, 3
    buffer_store_dword v3, v2, s[28:31], 0 offen sc1
    s_mov_b64 exec, -1
NL_88:
    s_branch L_ATT
KVW_87:
    s_mov_b32 s40, s26
    s_mov_b32 s41, s27
    s_mov_b32 s42, 0x100
    s_mov_b32 s43, 0x20000
    s_mul_i32 s64, s56, 20
    v_and_b32 v28, 15, v0
    v_lshrrev_b32 v30, 4, v0
    v_and_b32 v31, 1, v30
    v_mul_u32_u24 v31, 19, v31
    v_add_u32 v31, s64, v31
    v_lshrrev_b32 v31, 7, v31
    v_lshrrev_b32 v30, 1, v30
    v_mul_u32_u24 v30, 5, v30
    v_add3_u32 v30, v30, v31, 5
    v_lshl_add_u32 v30, v30, 4, v28
    v_lshlrev_b32 v30, 6, v30
    v_add_u32 v30, 0xf04000, v30
    v_lshl_add_u32 v31, v31, 4, s57
    v_add_u32 v31, s57, v31
    v_and_b32 v28, 1, v0
    v_add_u32 v31, v31, v28
    v_lshlrev_b32 v31, 6, v31
    v_add_u32 v31, 0xf04000, v31
    v_lshlrev_b32 v28, 7, v28
    buffer_load_dword v29, v28, s[40:43], 0 offen sc1
    s_waitcnt vmcnt(0)
    v_mov_b32 v2, 162048
    v_mov_b32 v3, 1
    s_mov_b64 exec, 1
    ds_add_rtn_u32 v3, v2, v3 offset:12
    s_waitcnt lgkmcnt(0)
    v_readfirstlane_b32 s64, v3
    s_mov_b64 exec, -1
    s_add_u32 s64, s64, 1
    s_cmp_lg_u32 s64, 4
    s_cbranch_scc1 NL_89
    v_lshl_add_u32 v2, v0, 2, s92
    v_mov_b32 v3, 1
    s_mov_b64 exec, 3
    buffer_store_dword v3, v2, s[28:31], 0 offen sc1
    s_mov_b64 exec, -1
NL_89:
    v_cmp_le_u32 vcc, 0x80, v29
    s_nop 1
    s_cmp_eq_u64 vcc, exec
    s_cbranch_scc1 CNTOK_90
    s_mov_b32 s62, 0
POLL_91:
    buffer_load_dword v29, v28, s[40:43], 0 offen offset:0 sc1
    s_waitcnt vmcnt(0)
    v_cmp_le_u32 vcc, 0x80, v29
    s_nop 1
    s_cmp_eq_u64 vcc, exec
    s_cbranch_scc1 POLLD_92
    s_add_u32 s62, s62, 1
    s_cmp_lt_u32 s62, 200000
    s_cbranch_scc0 POLLD_92
    s_sleep 1
    s_branch POLL_91
POLLD_92:
CNTOK_90:
    v_mov_b32 v14, 162048
    s_mov_b32 s62, 0
SIG_93:
    ds_read_b32 v15, v14 offset:12
    s_waitcnt lgkmcnt(0)
    v_readfirstlane_b32 s64, v15
    s_add_u32 s62, s62, 1
    s_cmp_ge_u32 s64, 4
    s_cbranch_scc1 SIGD_94
    s_sleep 1
    s_cmp_lt_u32 s62, 8000000
    s_cbranch_scc1 SIG_93
SIGD_94:
    v_mov_b32 v14, 162048
    s_mov_b32 s62, 0
SIG_95:
    ds_read_b32 v15, v14 offset:8
    s_waitcnt lgkmcnt(0)
    v_readfirstlane_b32 s64, v15
    s_add_u32 s62, s62, 1
    s_cmp_ge_u32 s64, s101
    s_cbranch_scc1 SIGD_96
    s_sleep 1
    s_cmp_lt_u32 s62, 8000000
    s_cbranch_scc1 SIG_95
SIGD_96:
    s_mov_b32 s62, 0
    s_mov_b64 s[72:73], -1
    s_mov_b64 s[98:99], -1
MP_97:
    s_mov_b64 exec, s[72:73]
    s_cbranch_execz MS_99
    buffer_load_dword v16, v30, s[28:31], 0 offen sc1
MS_99:
    s_mov_b64 exec, s[98:99]
    s_cbranch_execz MS_100
    buffer_load_dword v17, v31, s[28:31], 0 offen sc1
MS_100:
    s_mov_b64 exec, -1
    s_waitcnt vmcnt(0)
    v_cmp_eq_u32 vcc, 0, v16
    s_nop 1
    s_and_b64 s[72:73], s[72:73], vcc
    v_cmp_eq_u32 vcc, 0, v17
    s_nop 1
    s_and_b64 s[98:99], s[98:99], vcc
    s_or_b64 vcc, s[72:73], s[98:99]
    s_cbranch_scc0 MPD_98
    s_add_u32 s62, s62, 1
    s_cmp_lt_u32 s62, 200000
    s_cbranch_scc0 MPD_98
    s_sleep 2
    s_branch MP_97
MPD_98:
    s_mul_i32 s64, s56, 81920
    s_mul_i32 s65, s57, 10240
    s_add_u32 s64, s64, s65
    s_add_u32 s64, s64, 0x500000
    s_mov_b32 m0, 81920
    s_add_u32 s65, s64, 0
    buffer_load_dwordx4 v228, s[28:31], s65 offen offset:0 sc1 lds
    buffer_load_dwordx4 v228, s[28:31], s65 offen offset:1024 sc1 lds
    buffer_load_dwordx4 v228, s[28:31], s65 offen offset:2048 sc1 lds
    buffer_load_dwordx4 v228, s[28:31], s65 offen offset:3072 sc1 lds
    s_mov_b32 m0, 86016
    s_add_u32 s65, s64, 4096
    buffer_load_dwordx4 v228, s[28:31], s65 offen offset:0 sc1 lds
    buffer_load_dwordx4 v228, s[28:31], s65 offen offset:1024 sc1 lds
    buffer_load_dwordx4 v228, s[28:31], s65 offen offset:2048 sc1 lds
    buffer_load_dwordx4 v228, s[28:31], s65 offen offset:3072 sc1 lds
    s_mov_b32 m0, 90112
    s_add_u32 s65, s64, 8192
    buffer_load_dwordx4 v228, s[28:31], s65 offen offset:0 sc1 lds
    buffer_load_dwordx4 v228, s[28:31], s65 offen offset:1024 sc1 lds
    s_mov_b32 m0, 0
    s_add_u32 s65, s87, 0
    buffer_load_dwordx4 v228, s[28:31], s65 offen offset:0 sc1 lds
    buffer_load_dwordx4 v228, s[28:31], s65 offen offset:1024 sc1 lds
    buffer_load_dwordx4 v228, s[28:31], s65 offen offset:2048 sc1 lds
    buffer_load_dwordx4 v228, s[28:31], s65 offen offset:3072 sc1 lds
    s_mov_b32 m0, 4096
    s_add_u32 s65, s87, 4096
    buffer_load_dwordx4 v228, s[28:31], s65 offen offset:0 sc1 lds
    buffer_load_dwordx4 v228, s[28:31], s65 offen offset:1024 sc1 lds
    buffer_load_dwordx4 v228, s[28:31], s65 offen offset:2048 sc1 lds
    buffer_load_dwordx4 v228, s[28:31], s65 offen offset:3072 sc1 lds
    s_mov_b32 m0, 8192
    s_add_u32 s65, s87, 8192
    buffer_load_dwordx4 v228, s[28:31], s65 offen offset:0 sc1 lds
    buffer_load_dwordx4 v228, s[28:31], s65 offen offset:1024 sc1 lds
    buffer_load_dwordx4 v228, s[28:31], s65 offen offset:2048 sc1 lds
    buffer_load_dwordx4 v228, s[28:31], s65 offen offset:3072 sc1 lds
    s_mov_b32 m0, 12288
    s_add_u32 s65, s87, 12288
    buffer_load_dwordx4 v228, s[28:31], s65 offen offset:0 sc1 lds
    buffer_load_dwordx4 v228, s[28:31], s65 offen offset:1024 sc1 lds
    buffer_load_dwordx4 v228, s[28:31], s65 offen offset:2048 sc1 lds
    buffer_load_dwordx4 v228, s[28:31], s65 offen offset:3072 sc1 lds
    s_mov_b32 m0, 16384
    s_add_u32 s65, s87, 16384
    buffer_load_dwordx4 v228, s[28:31], s65 offen offset:0 sc1 lds
    buffer_load_dwordx4 v228, s[28:31], s65 offen offset:1024 sc1 lds
    buffer_load_dwordx4 v228, s[28:31], s65 offen offset:2048 sc1 lds
    buffer_load_dwordx4 v228, s[28:31], s65 offen offset:3072 sc1 lds
    s_mov_b32 m0, 20480
    s_add_u32 s65, s87, 20480
    buffer_load_dwordx4 v228, s[28:31], s65 offen offset:0 sc1 lds
    buffer_load_dwordx4 v228, s[28:31], s65 offen offset:1024 sc1 lds
    buffer_load_dwordx4 v228, s[28:31], s65 offen offset:2048 sc1 lds
    buffer_load_dwordx4 v228, s[28:31], s65 offen offset:3072 sc1 lds
    s_mov_b32 m0, 24576
    s_add_u32 s65, s87, 24576
    buffer_load_dwordx4 v228, s[28:31], s65 offen offset:0 sc1 lds
    buffer_load_dwordx4 v228, s[28:31], s65 offen offset:1024 sc1 lds
    buffer_load_dwordx4 v228, s[28:31], s65 offen offset:2048 sc1 lds
    buffer_load_dwordx4 v228, s[28:31], s65 offen offset:3072 sc1 lds
    s_mov_b32 m0, 28672
    s_add_u32 s65, s87, 28672
    buffer_load_dwordx4 v228, s[28:31], s65 offen offset:0 sc1 lds
    buffer_load_dwordx4 v228, s[28:31], s65 offen offset:1024 sc1 lds
    buffer_load_dwordx4 v228, s[28:31], s65 offen offset:2048 sc1 lds
    buffer_load_dwordx4 v228, s[28:31], s65 offen offset:3072 sc1 lds
    s_mov_b32 m0, 32768
    s_add_u32 s65, s87, 32768
    buffer_load_dwordx4 v228, s[28:31], s65 offen offset:0 sc1 lds
    buffer_load_dwordx4 v228, s[28:31], s65 offen offset:1024 sc1 lds
    buffer_load_dwordx4 v228, s[28:31], s65 offen offset:2048 sc1 lds
    buffer_load_dwordx4 v228, s[28:31], s65 offen offset:3072 sc1 lds
    s_mov_b32 m0, 36864
    s_add_u32 s65, s87, 36864
    buffer_load_dwordx4 v228, s[28:31], s65 offen offset:0 sc1 lds
    buffer_load_dwordx4 v228, s[28:31], s65 offen offset:1024 sc1 lds
    buffer_load_dwordx4 v228, s[28:31], s65 offen offset:2048 sc1 lds
    buffer_load_dwordx4 v228, s[28:31], s65 offen offset:3072 sc1 lds
    v_mov_b32 v16, 162048
    v_mov_b32 v17, 1
    v_mov_b32 v18, 2
    s_waitcnt vmcnt(30)
    ds_write_b32 v16, v17 offset:4
    s_waitcnt vmcnt(20)
    ds_write_b32 v16, v18 offset:4
    s_branch L_ATT
L_SLOW:
    s_mov_b32 s63, 1
    v_and_b32 v96, 31, v0
    v_lshrrev_b32 v98, 5, v0
    v_mul_u32_u24 v98, 320, v98
    v_lshl_add_u32 v98, v96, 4, v98
    v_add_u32 v98, 2560, v98
    v_mov_b32 v96, 0xff800000
    s_mov_b32 s70, s87
    s_mov_b32 s62, 0
L_SLOW1:
    buffer_load_dwordx2 v[38:39], v2, s[28:31], s70 offen offset:2048 sc1
    buffer_load_dwordx4 v[40:43], v228, s[28:31], s70 offen sc1
    buffer_load_dwordx4 v[44:47], v228, s[28:31], s70 offen offset:1024 sc1
    s_waitcnt vmcnt(0)
    v_mfma_f32_32x32x4_2b_bf16 v[64:95], v[38:39], v[36:37], 0
    s_nop 15
    s_nop 1
    v_mfma_f32_32x32x16_bf16 v[64:79], v[40:43], v[32:35], v[64:79]
    v_mfma_f32_32x32x16_bf16 v[80:95], v[44:47], v[32:35], v[80:95]
    s_nop 11
    v_max3_f32 v96, v96, v64, v65
    v_max3_f32 v96, v96, v66, v67
    v_max3_f32 v96, v96, v68, v69
    v_max3_f32 v96, v96, v70, v71
    v_max3_f32 v96, v96, v72, v73
    v_max3_f32 v96, v96, v74, v75
    v_max3_f32 v96, v96, v76, v77
    v_max3_f32 v96, v96, v78, v79
    v_max3_f32 v96, v96, v80, v81
    v_max3_f32 v96, v96, v82, v83
    v_max3_f32 v96, v96, v84, v85
    v_max3_f32 v96, v96, v86, v87
    v_max3_f32 v96, v96, v88, v89
    v_max3_f32 v96, v96, v90, v91
    v_max3_f32 v96, v96, v92, v93
    v_max3_f32 v96, v96, v94, v95
    s_add_u32 s70, s70, 5120
    s_add_u32 s62, s62, 1
    s_cmp_lt_u32 s62, 32
    s_cbranch_scc1 L_SLOW1
    v_mov_b32 v97, v96
    s_nop 1
    v_permlane32_swap_b32 v96, v97
    s_nop 1
    v_max_f32 v96, v96, v97
    v_mov_b32 v192, 0
    v_mov_b32 v193, 0
    v_mov_b32 v194, 0
    v_mov_b32 v195, 0
    v_mov_b32 v196, 0
    v_mov_b32 v197, 0
    v_mov_b32 v198, 0
    v_mov_b32 v199, 0
    v_mov_b32 v200, 0
    v_mov_b32 v201, 0
    v_mov_b32 v202, 0
    v_mov_b32 v203, 0
    v_mov_b32 v204, 0
    v_mov_b32 v205, 0
    v_mov_b32 v206, 0
    v_mov_b32 v207, 0
    s_mov_b32 s70, s87
    s_mov_b32 s62, 0
L_SLOW2:
    s_mov_b64 exec, s[74:75]
    buffer_load_dwordx4 v[48:51], v98, s[28:31], s70 offen offset:0 sc1
    buffer_load_dwordx4 v[52:55], v98, s[28:31], s70 offen offset:640 sc1
    buffer_load_dwordx4 v[56:59], v98, s[28:31], s70 offen offset:1280 sc1
    buffer_load_dwordx4 v[60:63], v98, s[28:31], s70 offen offset:1920 sc1
    s_mov_b64 exec, -1
    buffer_load_dwordx2 v[38:39], v2, s[28:31], s70 offen offset:2048 sc1
    buffer_load_dwordx4 v[40:43], v228, s[28:31], s70 offen sc1
    buffer_load_dwordx4 v[44:47], v228, s[28:31], s70 offen offset:1024 sc1
    s_waitcnt vmcnt(0)
    v_mfma_f32_32x32x4_2b_bf16 v[64:95], v[38:39], v[36:37], 0
    s_nop 15
    s_nop 1
    v_mfma_f32_32x32x16_bf16 v[64:79], v[40:43], v[32:35], v[64:79]
    v_mfma_f32_32x32x16_bf16 v[80:95], v[44:47], v[32:35], v[80:95]
    s_nop 11
    v_sub_f32 v64, v64, v96
    v_sub_f32 v65, v65, v96
    v_sub_f32 v66, v66, v96
    v_sub_f32 v67, v67, v96
    v_sub_f32 v68, v68, v96
    v_sub_f32 v69, v69, v96
    v_sub_f32 v70, v70, v96
    v_sub_f32 v71, v71, v96
    v_sub_f32 v72, v72, v96
    v_sub_f32 v73, v73, v96
    v_sub_f32 v74, v74, v96
    v_sub_f32 v75, v75, v96
    v_sub_f32 v76, v76, v96
    v_sub_f32 v77, v77, v96
    v_sub_f32 v78, v78, v96
    v_sub_f32 v79, v79, v96
    v_sub_f32 v80, v80, v96
    v_sub_f32 v81, v81, v96
    v_sub_f32 v82, v82, v96
    v_sub_f32 v83, v83, v96
    v_sub_f32 v84, v84, v96
    v_sub_f32 v85, v85, v96
    v_sub_f32 v86, v86, v96
    v_sub_f32 v87, v87, v96
    v_sub_f32 v88, v88, v96
    v_sub_f32 v89, v89, v96
    v_sub_f32 v90, v90, v96
    v_sub_f32 v91, v91, v96
    v_sub_f32 v92, v92, v96
    v_sub_f32 v93, v93, v96
    v_sub_f32 v94, v94, v96
    v_sub_f32 v95, v95, v96
    v_exp_f32 v64, v64
    v_exp_f32 v65, v65
    v_exp_f32 v66, v66
    v_exp_f32 v67, v67
    v_exp_f32 v68, v68
    v_exp_f32 v69, v69
    v_exp_f32 v70, v70
    v_exp_f32 v71, v71
    v_exp_f32 v72, v72
    v_exp_f32 v73, v73
    v_exp_f32 v74, v74
    v_exp_f32 v75, v75
    v_exp_f32 v76, v76
    v_exp_f32 v77, v77
    v_exp_f32 v78, v78
    v_exp_f32 v79, v79
    v_exp_f32 v80, v80
    v_exp_f32 v81, v81
    v_exp_f32 v82, v82
    v_exp_f32 v83, v83
    v_exp_f32 v84, v84
    v_exp_f32 v85, v85
    v_exp_f32 v86, v86
    v_exp_f32 v87, v87
    v_exp_f32 v88, v88
    v_exp_f32 v89, v89
    v_exp_f32 v90, v90
    v_exp_f32 v91, v91
    v_exp_f32 v92, v92
    v_exp_f32 v93, v93
    v_exp_f32 v94, v94
    v_exp_f32 v95, v95
    s_nop 1
    v_smfmac_f32_32x32x32_bf16 v[192:207], v[48:51], v[64:71], v224
    v_smfmac_f32_32x32x32_bf16 v[192:207], v[52:55], v[72:79], v224
    v_smfmac_f32_32x32x32_bf16 v[192:207], v[56:59], v[80:87], v224
    v_smfmac_f32_32x32x32_bf16 v[192:207], v[60:63], v[88:95], v224
    s_add_u32 s70, s70, 5120
    s_add_u32 s62, s62, 1
    s_cmp_lt_u32 s62, 32
    s_cbranch_scc1 L_SLOW2
    s_nop 11
    s_branch L_NORM
L_CODE_END:
.section .rodata,"a"
.p2align 6
.amdhsa_kernel gated_mix__mha_block__ssm_conv_h3__prompt_kernel
  .amdhsa_next_free_vgpr 256
  .amdhsa_next_free_sgpr 102
  .amdhsa_accum_offset 256
  .amdhsa_group_segment_fixed_size 0
  .amdhsa_kernarg_size 104
  .amdhsa_user_sgpr_count 2
  .amdhsa_user_sgpr_kernarg_segment_ptr 1
  .amdhsa_system_sgpr_workgroup_id_x 1
  .amdhsa_float_denorm_mode_32 3
.end_amdhsa_kernel
```
